```python
import torch

def _softmax(x, axis=-1):
    return torch.softmax(x, dim=axis)
def _gelu(x):
    return torch.nn.functional.gelu(x, approximate="tanh")
def _silu(x):
    return torch.nn.functional.silu(x)
def _sigmoid(x):
    return torch.sigmoid(x)
def _layernorm(x, axis=-1, eps=1e-5):
    m = x.mean(dim=axis, keepdim=True)
    v = x.var(dim=axis, keepdim=True, unbiased=False)
    return (x - m) / torch.sqrt(v + eps)
def _scatter_add(tgt, idx, src, axis=0):
    return tgt.clone().index_add_(axis, idx, src)
def _segment_sum(src, seg, n):
    out = torch.zeros((n,) + src.shape[1:], dtype=src.dtype)
    return out.index_add_(0, seg, src)
def _pad(x, pw):
    flat = tuple(v for pair in reversed(pw) for v in pair)
    return torch.nn.functional.pad(x, flat)

kernel_name = 'gated_mix__linear_attn_block__mixer_token_mlp__prompt'

def setup_inputs():

    _w = (lambda a: (lambda t: t.to(torch.bfloat16) if t.is_floating_point() else t)(torch.as_tensor(a)))
    def _A_setup():
        B, S, D = 1, 2048, 512
        return {
            "x": _w((lambda *s: torch.randn(*s, dtype=torch.bfloat16) * 0.05)(B, S, D)),
            "wqkv": _w((lambda *s: torch.randn(*s, dtype=torch.bfloat16) * 0.4)(D, 3 * D)),
            "wo": _w((lambda *s: torch.randn(*s, dtype=torch.bfloat16) * 0.05)(D, D)),
        }
    _A_in = _A_setup()

    def _B_setup():
        B, S, D, F = 1, 2048, 512, 1792
        return {
            "x": _w((lambda *s: torch.randn(*s, dtype=torch.bfloat16) * 0.05)(B, S, D)),
            "w1": _w((lambda *s: torch.randn(*s, dtype=torch.bfloat16) * 0.4)(S, F) * (S ** -0.5)),
            "b1": _w((lambda *s: torch.randn(*s, dtype=torch.bfloat16) * 3.2)(F) * 0.02),
            "w2": _w((lambda *s: torch.randn(*s, dtype=torch.bfloat16) * 0.05)(F, S) * (F ** -0.5)),
            "b2": _w((lambda *s: torch.randn(*s, dtype=torch.bfloat16) * 0.1)(S) * 0.02),
        }
    _B_in = _B_setup()

    return {
        "A_x": _A_in["x"],
        "A_wqkv": _A_in["wqkv"],
        "A_wo": _A_in["wo"],
        "B_x": _B_in["x"],
        "B_w1": _B_in["w1"],
        "B_b1": _B_in["b1"],
        "B_w2": _B_in["w2"],
        "B_b2": _B_in["b2"],
        "gate_w": _w((lambda *s: torch.randn(*s, dtype=torch.bfloat16) * 0.05)(512) * 16.0),
    }

def reference(A_x, A_wqkv, A_wo, B_x, B_w1, B_b1, B_w2, B_b2, gate_w):
    def _A_ref(x, wqkv, wo):
        B, S, D = x.shape
        H = 32; Dh = D // H
        qkv = (lambda x, *d: x.permute(*d))((x @ wqkv).reshape(B, S, 3, H, Dh), 2, 0, 3, 1, 4)
        q, k, v = qkv[0], qkv[1], qkv[2]
        phi = lambda t: torch.where(t > 0, t + 1, torch.exp(t)) + 1e-6
        pq, pk = phi(q), phi(k)
        kv = torch.einsum("bhsd,bhse->bhde", pk, v)
        z = torch.einsum("bhsd->bhd", pk)
        num = torch.einsum("bhqd,bhde->bhqe", pq, kv)
        den = torch.einsum("bhqd,bhd->bhq", pq, z)[..., None] + 1e-6
        o = num / den
        return (lambda x, *d: x.permute(*d))(o, 0, 2, 1, 3).reshape(B, S, D) @ wo

    def _B_ref(x, w1, b1, w2, b2):
        B, S, D = x.shape
        h = _layernorm(x, axis=-1)
        u = torch.einsum("bsd,sf->bdf", h, w1) + b1
        u = _gelu(u)
        y = torch.einsum("bdf,fs->bds", u, w2) + b2
        return (lambda x, *d: x.permute(*d))(y, 0, 2, 1)

    x = A_x
    g = _sigmoid((x * gate_w).sum(-1, keepdims=True))
    a = _A_ref(x, A_wqkv, A_wo)
    b = _B_ref(x, B_w1, B_b1, B_w2, B_b2)
    return g * a + (1 - g) * b
```

```asm
; @launch grid=(256,1,1) block=(256,1,1) lds=163840
.amdgcn_target "amdgcn-amd-amdhsa--gfx950"
.text
.globl gated_mix__linear_attn_block__mixer_token_mlp__prompt_kernel
.p2align 8
.type gated_mix__linear_attn_block__mixer_token_mlp__prompt_kernel,@function
gated_mix__linear_attn_block__mixer_token_mlp__prompt_kernel:
    s_cmp_ge_u32 s2, 256
    s_cbranch_scc1 k_end
    s_load_dwordx2 s[12:13], s[0:1], 0
    s_load_dwordx2 s[16:17], s[0:1], 8
    s_load_dwordx2 s[8:9], s[0:1], 88
    s_load_dwordx2 s[24:25], s[0:1], 32
    s_load_dwordx2 s[20:21], s[0:1], 64
    s_load_dwordx2 s[44:45], s[0:1], 48
    s_load_dwordx2 s[48:49], s[0:1], 40
    s_load_dwordx2 s[52:53], s[0:1], 56
    s_load_dwordx2 s[56:57], s[0:1], 72
    s_load_dwordx2 s[60:61], s[0:1], 16
    s_getpc_b64 s[42:43]
pc_anchor:
    s_lshr_b32 s5, s2, 3
    s_lshl_b32 s5, s5, 11
    v_lshrrev_b32 v1, 4, v0
    v_lshlrev_b32 v1, 7, v1
    v_add_u32_e64 v1, s5, v1
    v_min_u32 v1, 0xa38c, v1
        global_load_dword v175, v1, s[42:43]
    v_lshrrev_b32 v1, 6, v0
    v_and_b32 v2, 63, v0
    v_readfirstlane_b32 s28, v1
    s_mov_b32 s14, 0x200000
    s_mov_b32 s15, 0x20000
    s_mov_b32 s18, 0x180000
    s_mov_b32 s19, 0x20000
    s_mov_b32 s10, 0x2000000
    s_mov_b32 s11, 0x20000
    s_mov_b32 s22, 0x400
    s_mov_b32 s23, 0x20000
    s_mov_b32 s26, 0x700000
    s_mov_b32 s27, 0x20000
    s_mov_b32 s46, 0x700000
    s_mov_b32 s47, 0x20000
    s_mov_b32 s50, 0xe00
    s_mov_b32 s51, 0x20000
    s_mov_b32 s54, 0x1000
    s_mov_b32 s55, 0x20000
    s_mov_b32 s58, 0x200000
    s_mov_b32 s59, 0x20000
    s_mov_b32 s62, 0x80000
    s_mov_b32 s63, 0x20000
    s_and_b32 s3, s2, 7
    s_lshr_b32 s4, s2, 3
    s_lshr_b32 s5, s3, 1
    s_lshl_b32 s5, s5, 2
    s_and_b32 s6, s4, 3
    s_add_u32 s30, s5, s6
    v_and_b32 v3, 15, v2
    v_lshrrev_b32 v4, 4, v2
    v_lshlrev_b32 v5, 4, v2
    v_and_b32 v173, 31, v2
    v_lshrrev_b32 v174, 5, v2
    v_mov_b32 v230, 10092544
    s_lshl_b32 s33, s3, 5
    s_sub_u32 s5, s4, 16
    s_lshl_b32 s6, s5, 2
    s_add_u32 s33, s33, s6
    s_lshl_b32 s32, s33, 13
    s_lshl_b32 s6, s28, 11
    s_add_u32 s32, s32, s6
    s_cmp_lt_u32 s5, 8
    s_cbranch_scc0 no_ln
    s_waitcnt lgkmcnt(0)
    buffer_load_dwordx4 v[16:19], v5, s[12:15], s32 offen offset:0
    buffer_load_dwordx4 v[20:23], v5, s[12:15], s32 offen offset:1024
    s_add_u32 s32, s32, 8192
    buffer_load_dwordx4 v[24:27], v5, s[12:15], s32 offen offset:0
    buffer_load_dwordx4 v[28:31], v5, s[12:15], s32 offen offset:1024
    buffer_load_dwordx4 v[48:51], v5, s[20:23], 0 offen
    s_add_u32 s32, s32, 8192
    buffer_load_dwordx4 v[32:35], v5, s[12:15], s32 offen offset:0
    buffer_load_dwordx4 v[36:39], v5, s[12:15], s32 offen offset:1024
    s_add_u32 s32, s32, 8192
    buffer_load_dwordx4 v[40:43], v5, s[12:15], s32 offen offset:0
    buffer_load_dwordx4 v[44:47], v5, s[12:15], s32 offen offset:1024
    s_branch role_ln
no_ln:
    v_lshrrev_b32 v10, 3, v2
    v_and_b32 v11, 7, v2
    v_xor_b32 v1, v11, v4
    v_lshlrev_b32_e64 v6, 10, v10
    v_lshl_add_u32 v6, v1, 4, v6
    v_xor_b32_e64 v7, 64, v6
    v_add_u32 v7, 7168, v7
    v_add_u32 v8, 14336, v6
    v_add_u32 v9, 14336, v7
    s_lshl_b32 s34, s30, 17
    s_lshl_b32 s6, s28, 15
    s_add_u32 s34, s34, s6
    s_lshl_b32 s37, s28, 12
    s_cmp_ge_u32 s4, 28
    s_cbranch_scc1 role_q
    s_cmp_ge_u32 s4, 16
    s_cbranch_scc1 role_pf
    s_and_b32 s5, s3, 1
    s_lshl_b32 s5, s5, 2
    s_lshr_b32 s7, s4, 2
    s_add_u32 s31, s5, s7
    s_add_u32 s39, s4, s7
    s_and_b32 s39, s39, 3
    s_lshl_b32 s39, s39, 1
    s_mul_i32 s36, s28, 49152
    s_lshl_b32 s6, s31, 7
    s_add_u32 s36, s36, s6
    s_add_u32 s36, s36, 1024
    s_add_u32 s38, s37, 16384
    v_and_b32 v1, 1, v4
    v_lshlrev_b32 v1, 1, v1
    v_xor_b32 v1, v11, v1
    v_mul_u32_u24 v10, 3072, v10
    v_lshl_add_u32 v10, v1, 4, v10
    v_xor_b32_e64 v11, 64, v10
    v_add_u32 v11, 24576, v11
    s_waitcnt lgkmcnt(0)
    s_add_u32 s40, s39, 0
    s_and_b32 s40, s40, 7
    s_mul_i32 s41, s40, 196608
    s_add_u32 s41, s41, s36
    s_lshl_b32 s40, s40, 7
    s_add_u32 s40, s40, s34
    s_add_u32 m0, s38, 0
    s_nop 0
    buffer_load_dwordx4 v10, s[16:19], s41 offen offset:0 lds
    buffer_load_dwordx4 v10, s[16:19], s41 offen offset:1024 lds
    s_add_u32 m0, s38, 2048
    s_nop 0
    buffer_load_dwordx4 v11, s[16:19], s41 offen offset:0 lds
    buffer_load_dwordx4 v11, s[16:19], s41 offen offset:1024 lds
    s_add_u32 m0, s37, 0
    s_nop 0
    buffer_load_dwordx4 v6, s[12:15], s40 offen offset:0 lds
    buffer_load_dwordx4 v7, s[12:15], s40 offen offset:1024 lds
    buffer_load_dwordx4 v8, s[12:15], s40 offen offset:2048 lds
    buffer_load_dwordx4 v9, s[12:15], s40 offen offset:3072 lds
    buffer_load_dword v170, v230, s[8:11], 0 offen sc1
    v_mov_b32 v1, 0
    v_cmp_eq_u32 vcc, 0, v2
    v_mov_b32 v169, 1073741824
    s_nop 0
    v_cndmask_b32 v169, v169, v1, vcc
    s_and_b32 s78, s3, 1
    s_and_b32 s6, s4, 3
    s_lshl_b32 s5, s6, 1
    s_add_u32 s76, s5, s78
    s_lshr_b32 s7, s4, 2
    s_mul_i32 s66, s7, 1
    s_add_u32 s66, s66, s5
    s_and_b32 s66, s66, 7
    s_mul_i32 s72, s6, 7
    s_lshr_b32 s72, s72, 2
    s_mul_i32 s5, s7, 1
    s_add_u32 s72, s72, s5
    s_sub_u32 s5, s72, 7
    s_cmp_ge_u32 s72, 7
    s_cselect_b32 s72, s5, s72
    s_lshr_b32 s5, s3, 1
    s_mul_i32 s77, s5, 7
    s_add_u32 s77, s77, s7
    s_lshl_b32 s79, s5, 3
    s_add_u32 s79, s79, s7
    s_lshl_b32 s67, s28, 13
    s_lshl_b32 s80, s76, 18
    s_lshl_b32 s5, s78, 17
    s_add_u32 s80, s80, s5
    s_lshl_b32 s7, s28, 12
    s_add_u32 s80, s80, s7
    s_xor_b32 s64, s80, 0x40000
    s_mul_i32 s65, s28, 114688
    s_mul_i32 s5, s78, 3670016
    s_add_u32 s65, s65, s5
    s_lshl_b32 s5, s77, 7
    s_add_u32 s65, s65, s5
    s_mul_i32 s73, s76, 294912
    s_add_u32 s73, s73, s7
    s_add_u32 s73, s73, 6291456
    s_mul_i32 s5, s78, 114688
    s_add_u32 s81, s73, s5
    s_add_u32 s70, s81, 294912
    s_sub_u32 s5, s81, 294912
    s_cmp_eq_u32 s78, 0
    s_cselect_b32 s70, s70, s5
    s_add_u32 s73, s73, 229376
    s_lshl_b32 s71, s28, 17
    s_mul_i32 s5, s78, 3670016
    s_add_u32 s71, s71, s5
    s_lshl_b32 s5, s79, 7
    s_add_u32 s71, s71, s5
    v_lshlrev_b32 v136, 4, v173
    v_lshl_add_u32 v136, v174, 10, v136
    s_lshr_b32 s5, s28, 1
    s_lshl_b32 s5, s5, 9
    v_or_b32_e64 v136, s5, v136
    v_xor_b32 v137, 512, v136
    v_lshrrev_b32_e64 v1, 3, v2
    v_mul_u32_u24 v138, 3584, v1
    v_bfe_u32 v1, v2, 4, 1
    v_lshlrev_b32 v1, 2, v1
    v_and_b32 v139, 7, v2
    v_xor_b32_e64 v1, v1, v139
    v_lshl_add_u32 v138, v1, 4, v138
    v_add_u32 v139, 27648, v138
    v_add_u32 v140, 55296, v138
    v_add_u32 v141, 82944, v138
    v_bfe_u32 v1, v2, 2, 2
    v_lshl_add_u32 v1, v174, 3, v1
    v_lshlrev_b32_e64 v142, 7, v1
    v_bfe_u32 v1, v2, 3, 1
    v_lshl_add_u32 v142, v1, 6, v142
    v_bfe_u32 v1, v2, 4, 1
    v_lshl_add_u32 v142, v1, 4, v142
    v_and_b32_e64 v1, 1, v2
    v_lshl_add_u32 v142, v1, 5, v142
    v_bfe_u32 v1, v2, 1, 1
    v_lshl_add_u32 v142, v1, 3, v142
    s_and_b32 s5, s28, 1
    s_lshl_b32 s5, s5, 6
    v_xor_b32 v142, s5, v142
    v_add_u32 v142, s67, v142
    v_xor_b32_e64 v143, 64, v142
    v_add_u32 v244, 65536, v142
    v_add_u32 v245, 65536, v143
    v_bfe_u32 v152, v173, 2, 1
    v_lshlrev_b32 v152, 4, v152
    v_and_b32 v1, 3, v173
    v_add_u32 v152, v152, v1
    v_lshrrev_b32 v1, 3, v173
    v_lshl_add_u32 v152, v1, 2, v152
    v_lshlrev_b32_e64 v152, 4, v152
    v_lshl_add_u32 v152, v174, 10, v152
    s_lshr_b32 s5, s28, 1
    s_lshl_b32 s5, s5, 9
    v_or_b32_e64 v152, s5, v152
    v_xor_b32 v153, 512, v152
    v_lshrrev_b32_e64 v1, 3, v2
    v_mul_u32_u24 v154, 4096, v1
    v_bfe_u32 v1, v2, 4, 1
    v_lshlrev_b32 v1, 2, v1
    v_and_b32 v155, 7, v2
    v_xor_b32_e64 v1, v1, v155
    v_lshl_add_u32 v154, v1, 4, v154
    v_add_u32 v155, 31744, v154
    v_add_u32 v156, 63488, v154
    v_add_u32 v157, 95232, v154
    v_bfe_u32 v1, v2, 2, 2
    v_lshl_add_u32 v1, v174, 3, v1
    v_lshlrev_b32_e64 v158, 7, v1
    v_bfe_u32 v1, v2, 3, 1
    v_lshl_add_u32 v158, v1, 6, v158
    v_bfe_u32 v1, v2, 4, 1
    v_lshl_add_u32 v158, v1, 5, v158
    v_and_b32_e64 v1, 3, v2
    v_lshl_add_u32 v158, v1, 3, v158
    s_and_b32 s5, s28, 1
    s_lshl_b32 s5, s5, 6
    v_xor_b32 v158, s5, v158
    v_add_u32 v158, s67, v158
    v_xor_b32_e64 v159, 64, v158
    v_add_u32 v246, 102400, v158
    v_add_u32 v158, 36864, v158
    v_add_u32 v247, 102400, v159
    v_add_u32 v159, 36864, v159
    v_lshlrev_b32_e64 v160, 4, v173
    v_lshl_add_u32 v160, v174, 10, v160
    s_and_b32 s6, s28, 1
    s_lshl_b32 s7, s6, 9
    v_or_b32_e64 v160, s7, v160
    v_xor_b32 v161, 512, v160
    s_lshl_b32 s7, s6, 5
    v_or_b32 v162, s7, v173
    v_lshrrev_b32 v1, 1, v3
    v_xor_b32 v1, v1, v4
    v_lshlrev_b32_e64 v12, 7, v3
    v_lshl_add_u32 v12, v1, 4, v12
    v_xor_b32_e64 v13, 64, v12
    v_add_u32 v14, 0x10000, v12
    v_add_u32 v15, 0x10000, v13
    v_lshlrev_b32 v128, 11, v4
    v_lshrrev_b32 v1, 2, v3
    v_lshl_add_u32 v128, v1, 7, v128
    v_and_b32_e64 v1, 3, v3
    v_lshl_add_u32 v128, v1, 3, v128
    v_bfe_u32 v1, v2, 3, 2
    v_xor_b32_e64 v1, s28, v1
    v_lshl_add_u32 v128, v1, 5, v128
    v_add_u32 v128, 16384, v128
    v_add_u32 v129, 0x10000, v128
    v_lshlrev_b32 v130, 2, v2
    s_add_u32 s40, s39, 1
    s_and_b32 s40, s40, 7
    s_mul_i32 s41, s40, 196608
    s_add_u32 s41, s41, s36
    s_lshl_b32 s40, s40, 7
    s_add_u32 s40, s40, s34
    s_add_u32 m0, s38, 32768
    s_nop 0
    buffer_load_dwordx4 v10, s[16:19], s41 offen offset:0 lds
    buffer_load_dwordx4 v10, s[16:19], s41 offen offset:1024 lds
    s_add_u32 m0, s38, 34816
    s_nop 0
    buffer_load_dwordx4 v11, s[16:19], s41 offen offset:0 lds
    buffer_load_dwordx4 v11, s[16:19], s41 offen offset:1024 lds
    s_add_u32 m0, s37, 32768
    s_nop 0
    buffer_load_dwordx4 v6, s[12:15], s40 offen offset:0 lds
    buffer_load_dwordx4 v7, s[12:15], s40 offen offset:1024 lds
    buffer_load_dwordx4 v8, s[12:15], s40 offen offset:2048 lds
    buffer_load_dwordx4 v9, s[12:15], s40 offen offset:3072 lds
    s_waitcnt vmcnt(9)
    s_barrier
    ds_read_b64_tr_b16 v[48:49], v128 offset:0
    ds_read_b64_tr_b16 v[50:51], v128 offset:512
    ds_read_b64_tr_b16 v[52:53], v128 offset:1024
    ds_read_b64_tr_b16 v[54:55], v128 offset:1536
    ds_read_b128 v[16:19], v12 offset:0
    ds_read_b128 v[20:23], v12 offset:2048
    ds_read_b128 v[24:27], v12 offset:4096
    ds_read_b128 v[28:31], v12 offset:6144
    ds_read_b128 v[32:35], v12 offset:8192
    ds_read_b128 v[36:39], v12 offset:10240
    ds_read_b128 v[40:43], v12 offset:12288
    ds_read_b128 v[44:47], v12 offset:14336
    s_waitcnt lgkmcnt(7)
    v_mfma_f32_16x16x32_bf16 v[176:179], v[16:19], v[48:51], 0
    v_mfma_f32_16x16x32_bf16 v[208:211], v[16:19], v[52:55], 0
    s_waitcnt lgkmcnt(6)
    v_mfma_f32_16x16x32_bf16 v[180:183], v[20:23], v[48:51], 0
    v_mfma_f32_16x16x32_bf16 v[212:215], v[20:23], v[52:55], 0
    s_add_u32 s40, s39, 2
    s_and_b32 s40, s40, 7
    s_mul_i32 s41, s40, 196608
    s_add_u32 s41, s41, s36
    s_lshl_b32 s40, s40, 7
    s_add_u32 s40, s40, s34
    s_add_u32 m0, s38, 65536
    s_nop 0
    buffer_load_dwordx4 v10, s[16:19], s41 offen offset:0 lds
    s_waitcnt lgkmcnt(5)
    v_mfma_f32_16x16x32_bf16 v[184:187], v[24:27], v[48:51], 0
    ds_read_b64_tr_b16 v[88:89], v128 offset:8192
    v_mfma_f32_16x16x32_bf16 v[216:219], v[24:27], v[52:55], 0
    ds_read_b64_tr_b16 v[90:91], v128 offset:8704
    s_waitcnt lgkmcnt(6)
    v_mfma_f32_16x16x32_bf16 v[188:191], v[28:31], v[48:51], 0
    ds_read_b64_tr_b16 v[92:93], v128 offset:9216
    v_mfma_f32_16x16x32_bf16 v[220:223], v[28:31], v[52:55], 0
    ds_read_b64_tr_b16 v[94:95], v128 offset:9728
    buffer_load_dwordx4 v10, s[16:19], s41 offen offset:1024 lds
    s_waitcnt lgkmcnt(7)
    v_mfma_f32_16x16x32_bf16 v[192:195], v[32:35], v[48:51], 0
    ds_read_b128 v[56:59], v13 offset:0
    v_mfma_f32_16x16x32_bf16 v[224:227], v[32:35], v[52:55], 0
    ds_read_b128 v[60:63], v13 offset:2048
    s_waitcnt lgkmcnt(8)
    v_mfma_f32_16x16x32_bf16 v[196:199], v[36:39], v[48:51], 0
    ds_read_b128 v[64:67], v13 offset:4096
    v_mfma_f32_16x16x32_bf16 v[228:231], v[36:39], v[52:55], 0
    ds_read_b128 v[68:71], v13 offset:6144
    s_add_u32 m0, s38, 67584
    s_nop 0
    buffer_load_dwordx4 v11, s[16:19], s41 offen offset:0 lds
    s_waitcnt lgkmcnt(9)
    v_mfma_f32_16x16x32_bf16 v[200:203], v[40:43], v[48:51], 0
    ds_read_b128 v[72:75], v13 offset:8192
    v_mfma_f32_16x16x32_bf16 v[232:235], v[40:43], v[52:55], 0
    ds_read_b128 v[76:79], v13 offset:10240
    s_waitcnt lgkmcnt(10)
    v_mfma_f32_16x16x32_bf16 v[204:207], v[44:47], v[48:51], 0
    ds_read_b128 v[80:83], v13 offset:12288
    v_mfma_f32_16x16x32_bf16 v[236:239], v[44:47], v[52:55], 0
    ds_read_b128 v[84:87], v13 offset:14336
    buffer_load_dwordx4 v11, s[16:19], s41 offen offset:1024 lds
    s_waitcnt vmcnt(4) lgkmcnt(0)
    s_barrier
    v_mfma_f32_16x16x32_bf16 v[176:179], v[56:59], v[88:91], v[176:179]
    ds_read_b64_tr_b16 v[48:49], v128 offset:32768
    v_mfma_f32_16x16x32_bf16 v[208:211], v[56:59], v[92:95], v[208:211]
    ds_read_b64_tr_b16 v[50:51], v128 offset:33280
    s_add_u32 m0, s37, 65536
    s_nop 0
    buffer_load_dwordx4 v6, s[12:15], s40 offen offset:0 lds
    v_mfma_f32_16x16x32_bf16 v[180:183], v[60:63], v[88:91], v[180:183]
    ds_read_b64_tr_b16 v[52:53], v128 offset:33792
    v_mfma_f32_16x16x32_bf16 v[212:215], v[60:63], v[92:95], v[212:215]
    ds_read_b64_tr_b16 v[54:55], v128 offset:34304
    buffer_load_dwordx4 v7, s[12:15], s40 offen offset:1024 lds
    v_mfma_f32_16x16x32_bf16 v[184:187], v[64:67], v[88:91], v[184:187]
    ds_read_b128 v[16:19], v12 offset:32768
    v_mfma_f32_16x16x32_bf16 v[216:219], v[64:67], v[92:95], v[216:219]
    ds_read_b128 v[20:23], v12 offset:34816
    buffer_load_dwordx4 v8, s[12:15], s40 offen offset:2048 lds
    v_mfma_f32_16x16x32_bf16 v[188:191], v[68:71], v[88:91], v[188:191]
    ds_read_b128 v[24:27], v12 offset:36864
    v_mfma_f32_16x16x32_bf16 v[220:223], v[68:71], v[92:95], v[220:223]
    ds_read_b128 v[28:31], v12 offset:38912
    buffer_load_dwordx4 v9, s[12:15], s40 offen offset:3072 lds
    v_mfma_f32_16x16x32_bf16 v[192:195], v[72:75], v[88:91], v[192:195]
    ds_read_b128 v[32:35], v12 offset:40960
    v_mfma_f32_16x16x32_bf16 v[224:227], v[72:75], v[92:95], v[224:227]
    ds_read_b128 v[36:39], v12 offset:43008
    v_mfma_f32_16x16x32_bf16 v[196:199], v[76:79], v[88:91], v[196:199]
    ds_read_b128 v[40:43], v12 offset:45056
    v_mfma_f32_16x16x32_bf16 v[228:231], v[76:79], v[92:95], v[228:231]
    ds_read_b128 v[44:47], v12 offset:47104
    s_add_u32 s40, s39, 3
    s_and_b32 s40, s40, 7
    s_mul_i32 s41, s40, 196608
    s_add_u32 s41, s41, s36
    s_lshl_b32 s40, s40, 7
    s_add_u32 s40, s40, s34
    s_add_u32 m0, s38, 98304
    s_nop 0
    buffer_load_dwordx4 v10, s[16:19], s41 offen offset:0 lds
    v_mfma_f32_16x16x32_bf16 v[200:203], v[80:83], v[88:91], v[200:203]
    v_mfma_f32_16x16x32_bf16 v[232:235], v[80:83], v[92:95], v[232:235]
    v_mfma_f32_16x16x32_bf16 v[204:207], v[84:87], v[88:91], v[204:207]
    v_mfma_f32_16x16x32_bf16 v[236:239], v[84:87], v[92:95], v[236:239]
    buffer_load_dwordx4 v10, s[16:19], s41 offen offset:1024 lds
    s_waitcnt lgkmcnt(7)
    v_mfma_f32_16x16x32_bf16 v[176:179], v[16:19], v[48:51], v[176:179]
    v_mfma_f32_16x16x32_bf16 v[208:211], v[16:19], v[52:55], v[208:211]
    s_waitcnt lgkmcnt(6)
    v_mfma_f32_16x16x32_bf16 v[180:183], v[20:23], v[48:51], v[180:183]
    v_mfma_f32_16x16x32_bf16 v[212:215], v[20:23], v[52:55], v[212:215]
    s_add_u32 m0, s38, 100352
    s_nop 0
    buffer_load_dwordx4 v11, s[16:19], s41 offen offset:0 lds
    s_waitcnt lgkmcnt(5)
    v_mfma_f32_16x16x32_bf16 v[184:187], v[24:27], v[48:51], v[184:187]
    ds_read_b64_tr_b16 v[88:89], v128 offset:40960
    v_mfma_f32_16x16x32_bf16 v[216:219], v[24:27], v[52:55], v[216:219]
    ds_read_b64_tr_b16 v[90:91], v128 offset:41472
    s_waitcnt lgkmcnt(6)
    v_mfma_f32_16x16x32_bf16 v[188:191], v[28:31], v[48:51], v[188:191]
    ds_read_b64_tr_b16 v[92:93], v128 offset:41984
    v_mfma_f32_16x16x32_bf16 v[220:223], v[28:31], v[52:55], v[220:223]
    ds_read_b64_tr_b16 v[94:95], v128 offset:42496
    buffer_load_dwordx4 v11, s[16:19], s41 offen offset:1024 lds
    s_waitcnt lgkmcnt(7)
    v_mfma_f32_16x16x32_bf16 v[192:195], v[32:35], v[48:51], v[192:195]
    ds_read_b128 v[56:59], v13 offset:32768
    v_mfma_f32_16x16x32_bf16 v[224:227], v[32:35], v[52:55], v[224:227]
    ds_read_b128 v[60:63], v13 offset:34816
    s_waitcnt lgkmcnt(8)
    v_mfma_f32_16x16x32_bf16 v[196:199], v[36:39], v[48:51], v[196:199]
    ds_read_b128 v[64:67], v13 offset:36864
    v_mfma_f32_16x16x32_bf16 v[228:231], v[36:39], v[52:55], v[228:231]
    ds_read_b128 v[68:71], v13 offset:38912
    s_add_u32 m0, s37, 98304
    s_nop 0
    buffer_load_dwordx4 v6, s[12:15], s40 offen offset:0 lds
    s_waitcnt lgkmcnt(9)
    v_mfma_f32_16x16x32_bf16 v[200:203], v[40:43], v[48:51], v[200:203]
    ds_read_b128 v[72:75], v13 offset:40960
    v_mfma_f32_16x16x32_bf16 v[232:235], v[40:43], v[52:55], v[232:235]
    ds_read_b128 v[76:79], v13 offset:43008
    s_waitcnt lgkmcnt(10)
    v_mfma_f32_16x16x32_bf16 v[204:207], v[44:47], v[48:51], v[204:207]
    ds_read_b128 v[80:83], v13 offset:45056
    v_mfma_f32_16x16x32_bf16 v[236:239], v[44:47], v[52:55], v[236:239]
    ds_read_b128 v[84:87], v13 offset:47104
    buffer_load_dwordx4 v7, s[12:15], s40 offen offset:1024 lds
    s_waitcnt vmcnt(6) lgkmcnt(0)
    s_barrier
    v_readfirstlane_b32 s29, v170
    s_nop 0
    s_mul_i32 s29, s29, 0x9E3779B1
    s_add_u32 s29, s29, 0x7F4A7C15
    v_mov_b32 v170, s29
    v_mfma_f32_16x16x32_bf16 v[176:179], v[56:59], v[88:91], v[176:179]
    ds_read_b64_tr_b16 v[48:49], v129 offset:0
    v_mfma_f32_16x16x32_bf16 v[208:211], v[56:59], v[92:95], v[208:211]
    ds_read_b64_tr_b16 v[50:51], v129 offset:512
    buffer_load_dwordx4 v8, s[12:15], s40 offen offset:2048 lds
    v_mfma_f32_16x16x32_bf16 v[180:183], v[60:63], v[88:91], v[180:183]
    ds_read_b64_tr_b16 v[52:53], v129 offset:1024
    v_mfma_f32_16x16x32_bf16 v[212:215], v[60:63], v[92:95], v[212:215]
    ds_read_b64_tr_b16 v[54:55], v129 offset:1536
    buffer_load_dwordx4 v9, s[12:15], s40 offen offset:3072 lds
    v_mfma_f32_16x16x32_bf16 v[184:187], v[64:67], v[88:91], v[184:187]
    ds_read_b128 v[16:19], v14 offset:0
    v_mfma_f32_16x16x32_bf16 v[216:219], v[64:67], v[92:95], v[216:219]
    ds_read_b128 v[20:23], v14 offset:2048
    v_mfma_f32_16x16x32_bf16 v[188:191], v[68:71], v[88:91], v[188:191]
    ds_read_b128 v[24:27], v14 offset:4096
    v_mfma_f32_16x16x32_bf16 v[220:223], v[68:71], v[92:95], v[220:223]
    ds_read_b128 v[28:31], v14 offset:6144
    s_add_u32 s40, s39, 4
    s_and_b32 s40, s40, 7
    s_mul_i32 s41, s40, 196608
    s_add_u32 s41, s41, s36
    s_lshl_b32 s40, s40, 7
    s_add_u32 s40, s40, s34
    s_add_u32 m0, s38, 0
    s_nop 0
    buffer_load_dwordx4 v10, s[16:19], s41 offen offset:0 lds
    v_mfma_f32_16x16x32_bf16 v[192:195], v[72:75], v[88:91], v[192:195]
    ds_read_b128 v[32:35], v14 offset:8192
    v_mfma_f32_16x16x32_bf16 v[224:227], v[72:75], v[92:95], v[224:227]
    ds_read_b128 v[36:39], v14 offset:10240
    v_mfma_f32_16x16x32_bf16 v[196:199], v[76:79], v[88:91], v[196:199]
    ds_read_b128 v[40:43], v14 offset:12288
    v_mfma_f32_16x16x32_bf16 v[228:231], v[76:79], v[92:95], v[228:231]
    ds_read_b128 v[44:47], v14 offset:14336
    buffer_load_dwordx4 v10, s[16:19], s41 offen offset:1024 lds
    v_mfma_f32_16x16x32_bf16 v[200:203], v[80:83], v[88:91], v[200:203]
    v_mfma_f32_16x16x32_bf16 v[232:235], v[80:83], v[92:95], v[232:235]
    v_mfma_f32_16x16x32_bf16 v[204:207], v[84:87], v[88:91], v[204:207]
    v_mfma_f32_16x16x32_bf16 v[236:239], v[84:87], v[92:95], v[236:239]
    s_add_u32 m0, s38, 2048
    s_nop 0
    buffer_load_dwordx4 v11, s[16:19], s41 offen offset:0 lds
    s_waitcnt lgkmcnt(7)
    v_mfma_f32_16x16x32_bf16 v[176:179], v[16:19], v[48:51], v[176:179]
    v_mfma_f32_16x16x32_bf16 v[208:211], v[16:19], v[52:55], v[208:211]
    s_waitcnt lgkmcnt(6)
    v_mfma_f32_16x16x32_bf16 v[180:183], v[20:23], v[48:51], v[180:183]
    v_mfma_f32_16x16x32_bf16 v[212:215], v[20:23], v[52:55], v[212:215]
    buffer_load_dwordx4 v11, s[16:19], s41 offen offset:1024 lds
    s_waitcnt lgkmcnt(5)
    v_mfma_f32_16x16x32_bf16 v[184:187], v[24:27], v[48:51], v[184:187]
    ds_read_b64_tr_b16 v[88:89], v129 offset:8192
    v_mfma_f32_16x16x32_bf16 v[216:219], v[24:27], v[52:55], v[216:219]
    ds_read_b64_tr_b16 v[90:91], v129 offset:8704
    s_waitcnt lgkmcnt(6)
    v_mfma_f32_16x16x32_bf16 v[188:191], v[28:31], v[48:51], v[188:191]
    ds_read_b64_tr_b16 v[92:93], v129 offset:9216
    v_mfma_f32_16x16x32_bf16 v[220:223], v[28:31], v[52:55], v[220:223]
    ds_read_b64_tr_b16 v[94:95], v129 offset:9728
    s_add_u32 m0, s37, 0
    s_nop 0
    buffer_load_dwordx4 v6, s[12:15], s40 offen offset:0 lds
    s_waitcnt lgkmcnt(7)
    v_mfma_f32_16x16x32_bf16 v[192:195], v[32:35], v[48:51], v[192:195]
    ds_read_b128 v[56:59], v15 offset:0
    v_mfma_f32_16x16x32_bf16 v[224:227], v[32:35], v[52:55], v[224:227]
    ds_read_b128 v[60:63], v15 offset:2048
    s_waitcnt lgkmcnt(8)
    v_mfma_f32_16x16x32_bf16 v[196:199], v[36:39], v[48:51], v[196:199]
    ds_read_b128 v[64:67], v15 offset:4096
    v_mfma_f32_16x16x32_bf16 v[228:231], v[36:39], v[52:55], v[228:231]
    ds_read_b128 v[68:71], v15 offset:6144
    buffer_load_dwordx4 v7, s[12:15], s40 offen offset:1024 lds
    s_waitcnt lgkmcnt(9)
    v_mfma_f32_16x16x32_bf16 v[200:203], v[40:43], v[48:51], v[200:203]
    ds_read_b128 v[72:75], v15 offset:8192
    v_mfma_f32_16x16x32_bf16 v[232:235], v[40:43], v[52:55], v[232:235]
    ds_read_b128 v[76:79], v15 offset:10240
    s_waitcnt lgkmcnt(10)
    v_mfma_f32_16x16x32_bf16 v[204:207], v[44:47], v[48:51], v[204:207]
    ds_read_b128 v[80:83], v15 offset:12288
    v_mfma_f32_16x16x32_bf16 v[236:239], v[44:47], v[52:55], v[236:239]
    ds_read_b128 v[84:87], v15 offset:14336
    buffer_load_dwordx4 v8, s[12:15], s40 offen offset:2048 lds
    s_waitcnt vmcnt(7) lgkmcnt(0)
    s_barrier
    v_mfma_f32_16x16x32_bf16 v[176:179], v[56:59], v[88:91], v[176:179]
    ds_read_b64_tr_b16 v[48:49], v129 offset:32768
    v_mfma_f32_16x16x32_bf16 v[208:211], v[56:59], v[92:95], v[208:211]
    ds_read_b64_tr_b16 v[50:51], v129 offset:33280
    buffer_load_dwordx4 v9, s[12:15], s40 offen offset:3072 lds
    v_mfma_f32_16x16x32_bf16 v[180:183], v[60:63], v[88:91], v[180:183]
    ds_read_b64_tr_b16 v[52:53], v129 offset:33792
    v_mfma_f32_16x16x32_bf16 v[212:215], v[60:63], v[92:95], v[212:215]
    ds_read_b64_tr_b16 v[54:55], v129 offset:34304
    s_add_u32 s40, s39, 5
    s_and_b32 s40, s40, 7
    s_mul_i32 s41, s40, 196608
    s_add_u32 s41, s41, s36
    s_lshl_b32 s40, s40, 7
    s_add_u32 s40, s40, s34
    s_add_u32 m0, s38, 32768
    s_nop 0
    buffer_load_dwordx4 v10, s[16:19], s41 offen offset:0 lds
    v_mfma_f32_16x16x32_bf16 v[184:187], v[64:67], v[88:91], v[184:187]
    ds_read_b128 v[16:19], v14 offset:32768
    v_mfma_f32_16x16x32_bf16 v[216:219], v[64:67], v[92:95], v[216:219]
    ds_read_b128 v[20:23], v14 offset:34816
    v_mfma_f32_16x16x32_bf16 v[188:191], v[68:71], v[88:91], v[188:191]
    ds_read_b128 v[24:27], v14 offset:36864
    v_mfma_f32_16x16x32_bf16 v[220:223], v[68:71], v[92:95], v[220:223]
    ds_read_b128 v[28:31], v14 offset:38912
    buffer_load_dwordx4 v10, s[16:19], s41 offen offset:1024 lds
    v_mfma_f32_16x16x32_bf16 v[192:195], v[72:75], v[88:91], v[192:195]
    ds_read_b128 v[32:35], v14 offset:40960
    v_mfma_f32_16x16x32_bf16 v[224:227], v[72:75], v[92:95], v[224:227]
    ds_read_b128 v[36:39], v14 offset:43008
    v_mfma_f32_16x16x32_bf16 v[196:199], v[76:79], v[88:91], v[196:199]
    ds_read_b128 v[40:43], v14 offset:45056
    v_mfma_f32_16x16x32_bf16 v[228:231], v[76:79], v[92:95], v[228:231]
    ds_read_b128 v[44:47], v14 offset:47104
    s_add_u32 m0, s38, 34816
    s_nop 0
    buffer_load_dwordx4 v11, s[16:19], s41 offen offset:0 lds
    v_mfma_f32_16x16x32_bf16 v[200:203], v[80:83], v[88:91], v[200:203]
    v_mfma_f32_16x16x32_bf16 v[232:235], v[80:83], v[92:95], v[232:235]
    v_mfma_f32_16x16x32_bf16 v[204:207], v[84:87], v[88:91], v[204:207]
    v_mfma_f32_16x16x32_bf16 v[236:239], v[84:87], v[92:95], v[236:239]
    buffer_load_dwordx4 v11, s[16:19], s41 offen offset:1024 lds
    s_waitcnt lgkmcnt(7)
    v_mfma_f32_16x16x32_bf16 v[176:179], v[16:19], v[48:51], v[176:179]
    v_mfma_f32_16x16x32_bf16 v[208:211], v[16:19], v[52:55], v[208:211]
    s_waitcnt lgkmcnt(6)
    v_mfma_f32_16x16x32_bf16 v[180:183], v[20:23], v[48:51], v[180:183]
    v_mfma_f32_16x16x32_bf16 v[212:215], v[20:23], v[52:55], v[212:215]
    s_add_u32 m0, s37, 32768
    s_nop 0
    buffer_load_dwordx4 v6, s[12:15], s40 offen offset:0 lds
    s_waitcnt lgkmcnt(5)
    v_mfma_f32_16x16x32_bf16 v[184:187], v[24:27], v[48:51], v[184:187]
    ds_read_b64_tr_b16 v[88:89], v129 offset:40960
    v_mfma_f32_16x16x32_bf16 v[216:219], v[24:27], v[52:55], v[216:219]
    ds_read_b64_tr_b16 v[90:91], v129 offset:41472
    s_waitcnt lgkmcnt(6)
    v_mfma_f32_16x16x32_bf16 v[188:191], v[28:31], v[48:51], v[188:191]
    ds_read_b64_tr_b16 v[92:93], v129 offset:41984
    v_mfma_f32_16x16x32_bf16 v[220:223], v[28:31], v[52:55], v[220:223]
    ds_read_b64_tr_b16 v[94:95], v129 offset:42496
    buffer_load_dwordx4 v7, s[12:15], s40 offen offset:1024 lds
    s_waitcnt lgkmcnt(7)
    v_mfma_f32_16x16x32_bf16 v[192:195], v[32:35], v[48:51], v[192:195]
    ds_read_b128 v[56:59], v15 offset:32768
    v_mfma_f32_16x16x32_bf16 v[224:227], v[32:35], v[52:55], v[224:227]
    ds_read_b128 v[60:63], v15 offset:34816
    s_waitcnt lgkmcnt(8)
    v_mfma_f32_16x16x32_bf16 v[196:199], v[36:39], v[48:51], v[196:199]
    ds_read_b128 v[64:67], v15 offset:36864
    v_mfma_f32_16x16x32_bf16 v[228:231], v[36:39], v[52:55], v[228:231]
    ds_read_b128 v[68:71], v15 offset:38912
    buffer_load_dwordx4 v8, s[12:15], s40 offen offset:2048 lds
    s_waitcnt lgkmcnt(9)
    v_mfma_f32_16x16x32_bf16 v[200:203], v[40:43], v[48:51], v[200:203]
    ds_read_b128 v[72:75], v15 offset:40960
    v_mfma_f32_16x16x32_bf16 v[232:235], v[40:43], v[52:55], v[232:235]
    ds_read_b128 v[76:79], v15 offset:43008
    s_waitcnt lgkmcnt(10)
    v_mfma_f32_16x16x32_bf16 v[204:207], v[44:47], v[48:51], v[204:207]
    ds_read_b128 v[80:83], v15 offset:45056
    v_mfma_f32_16x16x32_bf16 v[236:239], v[44:47], v[52:55], v[236:239]
    ds_read_b128 v[84:87], v15 offset:47104
    buffer_load_dwordx4 v9, s[12:15], s40 offen offset:3072 lds
    s_waitcnt vmcnt(8) lgkmcnt(0)
    s_barrier
    v_mfma_f32_16x16x32_bf16 v[176:179], v[56:59], v[88:91], v[176:179]
    ds_read_b64_tr_b16 v[48:49], v128 offset:0
    v_mfma_f32_16x16x32_bf16 v[208:211], v[56:59], v[92:95], v[208:211]
    ds_read_b64_tr_b16 v[50:51], v128 offset:512
    v_mfma_f32_16x16x32_bf16 v[180:183], v[60:63], v[88:91], v[180:183]
    ds_read_b64_tr_b16 v[52:53], v128 offset:1024
    v_mfma_f32_16x16x32_bf16 v[212:215], v[60:63], v[92:95], v[212:215]
    ds_read_b64_tr_b16 v[54:55], v128 offset:1536
    s_add_u32 s40, s39, 6
    s_and_b32 s40, s40, 7
    s_mul_i32 s41, s40, 196608
    s_add_u32 s41, s41, s36
    s_lshl_b32 s40, s40, 7
    s_add_u32 s40, s40, s34
    s_add_u32 m0, s38, 65536
    s_nop 0
    buffer_load_dwordx4 v10, s[16:19], s41 offen offset:0 lds
    v_mfma_f32_16x16x32_bf16 v[184:187], v[64:67], v[88:91], v[184:187]
    ds_read_b128 v[16:19], v12 offset:0
    v_mfma_f32_16x16x32_bf16 v[216:219], v[64:67], v[92:95], v[216:219]
    ds_read_b128 v[20:23], v12 offset:2048
    v_mfma_f32_16x16x32_bf16 v[188:191], v[68:71], v[88:91], v[188:191]
    ds_read_b128 v[24:27], v12 offset:4096
    v_mfma_f32_16x16x32_bf16 v[220:223], v[68:71], v[92:95], v[220:223]
    ds_read_b128 v[28:31], v12 offset:6144
    buffer_load_dwordx4 v10, s[16:19], s41 offen offset:1024 lds
    v_mfma_f32_16x16x32_bf16 v[192:195], v[72:75], v[88:91], v[192:195]
    ds_read_b128 v[32:35], v12 offset:8192
    v_mfma_f32_16x16x32_bf16 v[224:227], v[72:75], v[92:95], v[224:227]
    ds_read_b128 v[36:39], v12 offset:10240
    v_mfma_f32_16x16x32_bf16 v[196:199], v[76:79], v[88:91], v[196:199]
    ds_read_b128 v[40:43], v12 offset:12288
    v_mfma_f32_16x16x32_bf16 v[228:231], v[76:79], v[92:95], v[228:231]
    ds_read_b128 v[44:47], v12 offset:14336
    s_add_u32 m0, s38, 67584
    s_nop 0
    buffer_load_dwordx4 v11, s[16:19], s41 offen offset:0 lds
    v_mfma_f32_16x16x32_bf16 v[200:203], v[80:83], v[88:91], v[200:203]
    v_mfma_f32_16x16x32_bf16 v[232:235], v[80:83], v[92:95], v[232:235]
    v_mfma_f32_16x16x32_bf16 v[204:207], v[84:87], v[88:91], v[204:207]
    v_mfma_f32_16x16x32_bf16 v[236:239], v[84:87], v[92:95], v[236:239]
    buffer_load_dwordx4 v11, s[16:19], s41 offen offset:1024 lds
    s_waitcnt lgkmcnt(7)
    v_mfma_f32_16x16x32_bf16 v[176:179], v[16:19], v[48:51], v[176:179]
    v_mfma_f32_16x16x32_bf16 v[208:211], v[16:19], v[52:55], v[208:211]
    s_waitcnt lgkmcnt(6)
    v_mfma_f32_16x16x32_bf16 v[180:183], v[20:23], v[48:51], v[180:183]
    v_mfma_f32_16x16x32_bf16 v[212:215], v[20:23], v[52:55], v[212:215]
    s_add_u32 m0, s37, 65536
    s_nop 0
    buffer_load_dwordx4 v6, s[12:15], s40 offen offset:0 lds
    s_waitcnt lgkmcnt(5)
    v_mfma_f32_16x16x32_bf16 v[184:187], v[24:27], v[48:51], v[184:187]
    ds_read_b64_tr_b16 v[88:89], v128 offset:8192
    v_mfma_f32_16x16x32_bf16 v[216:219], v[24:27], v[52:55], v[216:219]
    ds_read_b64_tr_b16 v[90:91], v128 offset:8704
    s_waitcnt lgkmcnt(6)
    v_mfma_f32_16x16x32_bf16 v[188:191], v[28:31], v[48:51], v[188:191]
    ds_read_b64_tr_b16 v[92:93], v128 offset:9216
    v_mfma_f32_16x16x32_bf16 v[220:223], v[28:31], v[52:55], v[220:223]
    ds_read_b64_tr_b16 v[94:95], v128 offset:9728
    buffer_load_dwordx4 v7, s[12:15], s40 offen offset:1024 lds
    s_waitcnt lgkmcnt(7)
    v_mfma_f32_16x16x32_bf16 v[192:195], v[32:35], v[48:51], v[192:195]
    ds_read_b128 v[56:59], v13 offset:0
    v_mfma_f32_16x16x32_bf16 v[224:227], v[32:35], v[52:55], v[224:227]
    ds_read_b128 v[60:63], v13 offset:2048
    s_waitcnt lgkmcnt(8)
    v_mfma_f32_16x16x32_bf16 v[196:199], v[36:39], v[48:51], v[196:199]
    ds_read_b128 v[64:67], v13 offset:4096
    v_mfma_f32_16x16x32_bf16 v[228:231], v[36:39], v[52:55], v[228:231]
    ds_read_b128 v[68:71], v13 offset:6144
    buffer_load_dwordx4 v8, s[12:15], s40 offen offset:2048 lds
    s_waitcnt lgkmcnt(9)
    v_mfma_f32_16x16x32_bf16 v[200:203], v[40:43], v[48:51], v[200:203]
    ds_read_b128 v[72:75], v13 offset:8192
    v_mfma_f32_16x16x32_bf16 v[232:235], v[40:43], v[52:55], v[232:235]
    ds_read_b128 v[76:79], v13 offset:10240
    s_waitcnt lgkmcnt(10)
    v_mfma_f32_16x16x32_bf16 v[204:207], v[44:47], v[48:51], v[204:207]
    ds_read_b128 v[80:83], v13 offset:12288
    v_mfma_f32_16x16x32_bf16 v[236:239], v[44:47], v[52:55], v[236:239]
    ds_read_b128 v[84:87], v13 offset:14336
    buffer_load_dwordx4 v9, s[12:15], s40 offen offset:3072 lds
    s_waitcnt vmcnt(8) lgkmcnt(0)
    s_barrier
    v_mfma_f32_16x16x32_bf16 v[176:179], v[56:59], v[88:91], v[176:179]
    ds_read_b64_tr_b16 v[48:49], v128 offset:32768
    v_mfma_f32_16x16x32_bf16 v[208:211], v[56:59], v[92:95], v[208:211]
    ds_read_b64_tr_b16 v[50:51], v128 offset:33280
    v_mfma_f32_16x16x32_bf16 v[180:183], v[60:63], v[88:91], v[180:183]
    ds_read_b64_tr_b16 v[52:53], v128 offset:33792
    v_mfma_f32_16x16x32_bf16 v[212:215], v[60:63], v[92:95], v[212:215]
    ds_read_b64_tr_b16 v[54:55], v128 offset:34304
    s_add_u32 s40, s39, 7
    s_and_b32 s40, s40, 7
    s_mul_i32 s41, s40, 196608
    s_add_u32 s41, s41, s36
    s_lshl_b32 s40, s40, 7
    s_add_u32 s40, s40, s34
    s_add_u32 m0, s38, 98304
    s_nop 0
    buffer_load_dwordx4 v10, s[16:19], s41 offen offset:0 lds
    v_mfma_f32_16x16x32_bf16 v[184:187], v[64:67], v[88:91], v[184:187]
    ds_read_b128 v[16:19], v12 offset:32768
    v_mfma_f32_16x16x32_bf16 v[216:219], v[64:67], v[92:95], v[216:219]
    ds_read_b128 v[20:23], v12 offset:34816
    v_mfma_f32_16x16x32_bf16 v[188:191], v[68:71], v[88:91], v[188:191]
    ds_read_b128 v[24:27], v12 offset:36864
    v_mfma_f32_16x16x32_bf16 v[220:223], v[68:71], v[92:95], v[220:223]
    ds_read_b128 v[28:31], v12 offset:38912
    buffer_load_dwordx4 v10, s[16:19], s41 offen offset:1024 lds
    v_mfma_f32_16x16x32_bf16 v[192:195], v[72:75], v[88:91], v[192:195]
    ds_read_b128 v[32:35], v12 offset:40960
    v_mfma_f32_16x16x32_bf16 v[224:227], v[72:75], v[92:95], v[224:227]
    ds_read_b128 v[36:39], v12 offset:43008
    v_mfma_f32_16x16x32_bf16 v[196:199], v[76:79], v[88:91], v[196:199]
    ds_read_b128 v[40:43], v12 offset:45056
    v_mfma_f32_16x16x32_bf16 v[228:231], v[76:79], v[92:95], v[228:231]
    ds_read_b128 v[44:47], v12 offset:47104
    s_add_u32 m0, s38, 100352
    s_nop 0
    buffer_load_dwordx4 v11, s[16:19], s41 offen offset:0 lds
    v_mfma_f32_16x16x32_bf16 v[200:203], v[80:83], v[88:91], v[200:203]
    v_mfma_f32_16x16x32_bf16 v[232:235], v[80:83], v[92:95], v[232:235]
    v_mfma_f32_16x16x32_bf16 v[204:207], v[84:87], v[88:91], v[204:207]
    v_mfma_f32_16x16x32_bf16 v[236:239], v[84:87], v[92:95], v[236:239]
    buffer_load_dwordx4 v11, s[16:19], s41 offen offset:1024 lds
    s_waitcnt lgkmcnt(7)
    v_mfma_f32_16x16x32_bf16 v[176:179], v[16:19], v[48:51], v[176:179]
    v_mfma_f32_16x16x32_bf16 v[208:211], v[16:19], v[52:55], v[208:211]
    s_waitcnt lgkmcnt(6)
    v_mfma_f32_16x16x32_bf16 v[180:183], v[20:23], v[48:51], v[180:183]
    v_mfma_f32_16x16x32_bf16 v[212:215], v[20:23], v[52:55], v[212:215]
    s_add_u32 m0, s37, 98304
    s_nop 0
    buffer_load_dwordx4 v6, s[12:15], s40 offen offset:0 lds
    s_waitcnt lgkmcnt(5)
    v_mfma_f32_16x16x32_bf16 v[184:187], v[24:27], v[48:51], v[184:187]
    ds_read_b64_tr_b16 v[88:89], v128 offset:40960
    v_mfma_f32_16x16x32_bf16 v[216:219], v[24:27], v[52:55], v[216:219]
    ds_read_b64_tr_b16 v[90:91], v128 offset:41472
    s_waitcnt lgkmcnt(6)
    v_mfma_f32_16x16x32_bf16 v[188:191], v[28:31], v[48:51], v[188:191]
    ds_read_b64_tr_b16 v[92:93], v128 offset:41984
    v_mfma_f32_16x16x32_bf16 v[220:223], v[28:31], v[52:55], v[220:223]
    ds_read_b64_tr_b16 v[94:95], v128 offset:42496
    buffer_load_dwordx4 v7, s[12:15], s40 offen offset:1024 lds
    s_waitcnt lgkmcnt(7)
    v_mfma_f32_16x16x32_bf16 v[192:195], v[32:35], v[48:51], v[192:195]
    ds_read_b128 v[56:59], v13 offset:32768
    v_mfma_f32_16x16x32_bf16 v[224:227], v[32:35], v[52:55], v[224:227]
    ds_read_b128 v[60:63], v13 offset:34816
    s_waitcnt lgkmcnt(8)
    v_mfma_f32_16x16x32_bf16 v[196:199], v[36:39], v[48:51], v[196:199]
    ds_read_b128 v[64:67], v13 offset:36864
    v_mfma_f32_16x16x32_bf16 v[228:231], v[36:39], v[52:55], v[228:231]
    ds_read_b128 v[68:71], v13 offset:38912
    buffer_load_dwordx4 v8, s[12:15], s40 offen offset:2048 lds
    s_waitcnt lgkmcnt(9)
    v_mfma_f32_16x16x32_bf16 v[200:203], v[40:43], v[48:51], v[200:203]
    ds_read_b128 v[72:75], v13 offset:40960
    v_mfma_f32_16x16x32_bf16 v[232:235], v[40:43], v[52:55], v[232:235]
    ds_read_b128 v[76:79], v13 offset:43008
    s_waitcnt lgkmcnt(10)
    v_mfma_f32_16x16x32_bf16 v[204:207], v[44:47], v[48:51], v[204:207]
    ds_read_b128 v[80:83], v13 offset:45056
    v_mfma_f32_16x16x32_bf16 v[236:239], v[44:47], v[52:55], v[236:239]
    ds_read_b128 v[84:87], v13 offset:47104
    buffer_load_dwordx4 v9, s[12:15], s40 offen offset:3072 lds
    s_waitcnt vmcnt(8) lgkmcnt(0)
    s_barrier
    v_mfma_f32_16x16x32_bf16 v[176:179], v[56:59], v[88:91], v[176:179]
    ds_read_b64_tr_b16 v[48:49], v129 offset:0
    v_mfma_f32_16x16x32_bf16 v[208:211], v[56:59], v[92:95], v[208:211]
    ds_read_b64_tr_b16 v[50:51], v129 offset:512
    s_add_u32 s68, s66, 0
    s_and_b32 s68, s68, 7
    s_mul_i32 s68, s68, 458752
    s_add_u32 s68, s68, s65
    s_add_u32 m0, s67, 0
    s_nop 0
    buffer_load_dwordx4 v138, s[24:27], s68 offen offset:0 lds
    v_mfma_f32_16x16x32_bf16 v[180:183], v[60:63], v[88:91], v[180:183]
    ds_read_b64_tr_b16 v[52:53], v129 offset:1024
    v_mfma_f32_16x16x32_bf16 v[212:215], v[60:63], v[92:95], v[212:215]
    ds_read_b64_tr_b16 v[54:55], v129 offset:1536
    buffer_load_dwordx4 v139, s[24:27], s68 offen offset:1024 lds
    v_mfma_f32_16x16x32_bf16 v[184:187], v[64:67], v[88:91], v[184:187]
    ds_read_b128 v[16:19], v14 offset:0
    v_mfma_f32_16x16x32_bf16 v[216:219], v[64:67], v[92:95], v[216:219]
    ds_read_b128 v[20:23], v14 offset:2048
    buffer_load_dwordx4 v140, s[24:27], s68 offen offset:2048 lds
    v_mfma_f32_16x16x32_bf16 v[188:191], v[68:71], v[88:91], v[188:191]
    ds_read_b128 v[24:27], v14 offset:4096
    v_mfma_f32_16x16x32_bf16 v[220:223], v[68:71], v[92:95], v[220:223]
    ds_read_b128 v[28:31], v14 offset:6144
    buffer_load_dwordx4 v141, s[24:27], s68 offen offset:3072 lds
    v_mfma_f32_16x16x32_bf16 v[192:195], v[72:75], v[88:91], v[192:195]
    ds_read_b128 v[32:35], v14 offset:8192
    v_mfma_f32_16x16x32_bf16 v[224:227], v[72:75], v[92:95], v[224:227]
    ds_read_b128 v[36:39], v14 offset:10240
    s_add_u32 s68, s66, 1
    s_and_b32 s68, s68, 7
    s_mul_i32 s68, s68, 458752
    s_add_u32 s68, s68, s65
    s_add_u32 m0, s67, 4096
    s_nop 0
    buffer_load_dwordx4 v138, s[24:27], s68 offen offset:0 lds
    v_mfma_f32_16x16x32_bf16 v[196:199], v[76:79], v[88:91], v[196:199]
    ds_read_b128 v[40:43], v14 offset:12288
    v_mfma_f32_16x16x32_bf16 v[228:231], v[76:79], v[92:95], v[228:231]
    ds_read_b128 v[44:47], v14 offset:14336
    buffer_load_dwordx4 v139, s[24:27], s68 offen offset:1024 lds
    v_mfma_f32_16x16x32_bf16 v[200:203], v[80:83], v[88:91], v[200:203]
    v_mfma_f32_16x16x32_bf16 v[232:235], v[80:83], v[92:95], v[232:235]
    buffer_load_dwordx4 v140, s[24:27], s68 offen offset:2048 lds
    v_mfma_f32_16x16x32_bf16 v[204:207], v[84:87], v[88:91], v[204:207]
    v_mfma_f32_16x16x32_bf16 v[236:239], v[84:87], v[92:95], v[236:239]
    buffer_load_dwordx4 v141, s[24:27], s68 offen offset:3072 lds
    s_waitcnt lgkmcnt(7)
    v_mfma_f32_16x16x32_bf16 v[176:179], v[16:19], v[48:51], v[176:179]
    v_mfma_f32_16x16x32_bf16 v[208:211], v[16:19], v[52:55], v[208:211]
    s_waitcnt lgkmcnt(6)
    v_mfma_f32_16x16x32_bf16 v[180:183], v[20:23], v[48:51], v[180:183]
    v_mfma_f32_16x16x32_bf16 v[212:215], v[20:23], v[52:55], v[212:215]
    s_add_u32 s68, s66, 2
    s_and_b32 s68, s68, 7
    s_mul_i32 s68, s68, 458752
    s_add_u32 s68, s68, s65
    s_add_u32 m0, s67, 32768
    s_nop 0
    buffer_load_dwordx4 v138, s[24:27], s68 offen offset:0 lds
    s_waitcnt lgkmcnt(5)
    v_mfma_f32_16x16x32_bf16 v[184:187], v[24:27], v[48:51], v[184:187]
    ds_read_b64_tr_b16 v[88:89], v129 offset:8192
    v_mfma_f32_16x16x32_bf16 v[216:219], v[24:27], v[52:55], v[216:219]
    ds_read_b64_tr_b16 v[90:91], v129 offset:8704
    s_waitcnt lgkmcnt(6)
    v_mfma_f32_16x16x32_bf16 v[188:191], v[28:31], v[48:51], v[188:191]
    ds_read_b64_tr_b16 v[92:93], v129 offset:9216
    v_mfma_f32_16x16x32_bf16 v[220:223], v[28:31], v[52:55], v[220:223]
    ds_read_b64_tr_b16 v[94:95], v129 offset:9728
    buffer_load_dwordx4 v139, s[24:27], s68 offen offset:1024 lds
    s_waitcnt lgkmcnt(7)
    v_mfma_f32_16x16x32_bf16 v[192:195], v[32:35], v[48:51], v[192:195]
    ds_read_b128 v[56:59], v15 offset:0
    v_mfma_f32_16x16x32_bf16 v[224:227], v[32:35], v[52:55], v[224:227]
    ds_read_b128 v[60:63], v15 offset:2048
    s_waitcnt lgkmcnt(8)
    v_mfma_f32_16x16x32_bf16 v[196:199], v[36:39], v[48:51], v[196:199]
    ds_read_b128 v[64:67], v15 offset:4096
    v_mfma_f32_16x16x32_bf16 v[228:231], v[36:39], v[52:55], v[228:231]
    ds_read_b128 v[68:71], v15 offset:6144
    buffer_load_dwordx4 v140, s[24:27], s68 offen offset:2048 lds
    s_waitcnt lgkmcnt(9)
    v_mfma_f32_16x16x32_bf16 v[200:203], v[40:43], v[48:51], v[200:203]
    ds_read_b128 v[72:75], v15 offset:8192
    v_mfma_f32_16x16x32_bf16 v[232:235], v[40:43], v[52:55], v[232:235]
    ds_read_b128 v[76:79], v15 offset:10240
    s_waitcnt lgkmcnt(10)
    v_mfma_f32_16x16x32_bf16 v[204:207], v[44:47], v[48:51], v[204:207]
    ds_read_b128 v[80:83], v15 offset:12288
    v_mfma_f32_16x16x32_bf16 v[236:239], v[44:47], v[52:55], v[236:239]
    ds_read_b128 v[84:87], v15 offset:14336
    buffer_load_dwordx4 v141, s[24:27], s68 offen offset:3072 lds
    s_waitcnt vmcnt(12) lgkmcnt(0)
    s_barrier
    v_lshrrev_b32 v171, 2, v173
    v_lshlrev_b32 v171, 11, v171
    v_and_b32 v1, 3, v2
    v_lshl_add_u32 v171, v1, 7, v171
    s_lshl_b32 s34, s28, 9
    s_add_u32 s34, s34, 10158080
    s_lshl_b32 s5, s78, 14
    s_add_u32 s34, s34, s5
    v_mfma_f32_16x16x32_bf16 v[176:179], v[56:59], v[88:91], v[176:179]
    ds_read_b64_tr_b16 v[48:49], v129 offset:32768
    v_mfma_f32_16x16x32_bf16 v[208:211], v[56:59], v[92:95], v[208:211]
    ds_read_b64_tr_b16 v[50:51], v129 offset:33280
    v_mfma_f32_16x16x32_bf16 v[180:183], v[60:63], v[88:91], v[180:183]
    ds_read_b64_tr_b16 v[52:53], v129 offset:33792
    v_mfma_f32_16x16x32_bf16 v[212:215], v[60:63], v[92:95], v[212:215]
    ds_read_b64_tr_b16 v[54:55], v129 offset:34304
    s_add_u32 s68, s66, 3
    s_and_b32 s68, s68, 7
    s_mul_i32 s68, s68, 458752
    s_add_u32 s68, s68, s65
    s_add_u32 m0, s67, 36864
    s_nop 0
    buffer_load_dwordx4 v138, s[24:27], s68 offen offset:0 lds
    v_mfma_f32_16x16x32_bf16 v[184:187], v[64:67], v[88:91], v[184:187]
    ds_read_b128 v[16:19], v14 offset:32768
    v_mfma_f32_16x16x32_bf16 v[216:219], v[64:67], v[92:95], v[216:219]
    ds_read_b128 v[20:23], v14 offset:34816
    v_mfma_f32_16x16x32_bf16 v[188:191], v[68:71], v[88:91], v[188:191]
    ds_read_b128 v[24:27], v14 offset:36864
    v_mfma_f32_16x16x32_bf16 v[220:223], v[68:71], v[92:95], v[220:223]
    ds_read_b128 v[28:31], v14 offset:38912
    buffer_load_dwordx4 v139, s[24:27], s68 offen offset:1024 lds
    v_mfma_f32_16x16x32_bf16 v[192:195], v[72:75], v[88:91], v[192:195]
    ds_read_b128 v[32:35], v14 offset:40960
    v_mfma_f32_16x16x32_bf16 v[224:227], v[72:75], v[92:95], v[224:227]
    ds_read_b128 v[36:39], v14 offset:43008
    v_mfma_f32_16x16x32_bf16 v[196:199], v[76:79], v[88:91], v[196:199]
    ds_read_b128 v[40:43], v14 offset:45056
    v_mfma_f32_16x16x32_bf16 v[228:231], v[76:79], v[92:95], v[228:231]
    ds_read_b128 v[44:47], v14 offset:47104
    buffer_load_dwordx4 v140, s[24:27], s68 offen offset:2048 lds
    v_mfma_f32_16x16x32_bf16 v[200:203], v[80:83], v[88:91], v[200:203]
    v_mfma_f32_16x16x32_bf16 v[232:235], v[80:83], v[92:95], v[232:235]
    v_mfma_f32_16x16x32_bf16 v[204:207], v[84:87], v[88:91], v[204:207]
    v_mfma_f32_16x16x32_bf16 v[236:239], v[84:87], v[92:95], v[236:239]
    buffer_load_dwordx4 v141, s[24:27], s68 offen offset:3072 lds
    s_waitcnt lgkmcnt(7)
    v_mfma_f32_16x16x32_bf16 v[176:179], v[16:19], v[48:51], v[176:179]
    v_mfma_f32_16x16x32_bf16 v[208:211], v[16:19], v[52:55], v[208:211]
    s_waitcnt lgkmcnt(6)
    v_mfma_f32_16x16x32_bf16 v[180:183], v[20:23], v[48:51], v[180:183]
    v_mfma_f32_16x16x32_bf16 v[212:215], v[20:23], v[52:55], v[212:215]
    buffer_load_dword v172, v171, s[8:11], s34 offen sc1
    s_waitcnt lgkmcnt(5)
    v_mfma_f32_16x16x32_bf16 v[184:187], v[24:27], v[48:51], v[184:187]
    ds_read_b64_tr_b16 v[88:89], v129 offset:40960
    v_mfma_f32_16x16x32_bf16 v[216:219], v[24:27], v[52:55], v[216:219]
    ds_read_b64_tr_b16 v[90:91], v129 offset:41472
    s_waitcnt lgkmcnt(6)
    v_mfma_f32_16x16x32_bf16 v[188:191], v[28:31], v[48:51], v[188:191]
    ds_read_b64_tr_b16 v[92:93], v129 offset:41984
    v_mfma_f32_16x16x32_bf16 v[220:223], v[28:31], v[52:55], v[220:223]
    ds_read_b64_tr_b16 v[94:95], v129 offset:42496
    v_lshlrev_b32 v1, 5, v174
    s_lshl_b32 s5, s77, 7
    s_and_b32 s6, s28, 1
    s_lshl_b32 s6, s6, 6
    s_add_u32 s32, s5, s6
    buffer_load_dwordx4 v[144:147], v1, s[48:51], s32 offen
    s_waitcnt lgkmcnt(7)
    v_mfma_f32_16x16x32_bf16 v[192:195], v[32:35], v[48:51], v[192:195]
    ds_read_b128 v[56:59], v15 offset:32768
    v_mfma_f32_16x16x32_bf16 v[224:227], v[32:35], v[52:55], v[224:227]
    ds_read_b128 v[60:63], v15 offset:34816
    s_waitcnt lgkmcnt(8)
    v_mfma_f32_16x16x32_bf16 v[196:199], v[36:39], v[48:51], v[196:199]
    ds_read_b128 v[64:67], v15 offset:36864
    v_mfma_f32_16x16x32_bf16 v[228:231], v[36:39], v[52:55], v[228:231]
    ds_read_b128 v[68:71], v15 offset:38912
    buffer_load_dwordx4 v[148:151], v1, s[48:51], s32 offen offset:16
    s_waitcnt lgkmcnt(9)
    v_mfma_f32_16x16x32_bf16 v[200:203], v[40:43], v[48:51], v[200:203]
    ds_read_b128 v[72:75], v15 offset:40960
    v_mfma_f32_16x16x32_bf16 v[232:235], v[40:43], v[52:55], v[232:235]
    ds_read_b128 v[76:79], v15 offset:43008
    s_waitcnt lgkmcnt(10)
    v_mfma_f32_16x16x32_bf16 v[204:207], v[44:47], v[48:51], v[204:207]
    ds_read_b128 v[80:83], v15 offset:45056
    v_mfma_f32_16x16x32_bf16 v[236:239], v[44:47], v[52:55], v[236:239]
    ds_read_b128 v[84:87], v15 offset:47104
    s_waitcnt lgkmcnt(7)
    v_mfma_f32_16x16x32_bf16 v[176:179], v[56:59], v[88:91], v[176:179]
    v_mfma_f32_16x16x32_bf16 v[208:211], v[56:59], v[92:95], v[208:211]
    s_waitcnt lgkmcnt(6)
    v_mfma_f32_16x16x32_bf16 v[180:183], v[60:63], v[88:91], v[180:183]
    v_mfma_f32_16x16x32_bf16 v[212:215], v[60:63], v[92:95], v[212:215]
    s_waitcnt lgkmcnt(5)
    v_mfma_f32_16x16x32_bf16 v[184:187], v[64:67], v[88:91], v[184:187]
    v_mfma_f32_16x16x32_bf16 v[216:219], v[64:67], v[92:95], v[216:219]
    s_waitcnt lgkmcnt(4)
    v_mfma_f32_16x16x32_bf16 v[188:191], v[68:71], v[88:91], v[188:191]
    v_mfma_f32_16x16x32_bf16 v[220:223], v[68:71], v[92:95], v[220:223]
    s_waitcnt lgkmcnt(3)
    v_mfma_f32_16x16x32_bf16 v[192:195], v[72:75], v[88:91], v[192:195]
    v_mfma_f32_16x16x32_bf16 v[224:227], v[72:75], v[92:95], v[224:227]
    s_waitcnt lgkmcnt(2)
    v_mfma_f32_16x16x32_bf16 v[196:199], v[76:79], v[88:91], v[196:199]
    v_mfma_f32_16x16x32_bf16 v[228:231], v[76:79], v[92:95], v[228:231]
    s_waitcnt lgkmcnt(1)
    v_mfma_f32_16x16x32_bf16 v[200:203], v[80:83], v[88:91], v[200:203]
    v_mfma_f32_16x16x32_bf16 v[232:235], v[80:83], v[92:95], v[232:235]
    s_waitcnt lgkmcnt(0)
    v_mfma_f32_16x16x32_bf16 v[204:207], v[84:87], v[88:91], v[204:207]
    v_mfma_f32_16x16x32_bf16 v[236:239], v[84:87], v[92:95], v[236:239]
    s_lshl_b32 s43, s31, 2
    s_add_u32 s43, s43, s28
    s_lshl_b32 s43, s43, 5
    s_add_u32 s43, s43, s30
    s_lshl_b32 s41, s43, 10
    s_add_u32 s41, s41, 8912896
    s_lshl_b32 s42, s31, 4
    s_add_u32 s42, s42, s30
    s_lshl_b32 s42, s42, 2
    s_add_u32 s42, s42, s28
    s_lshl_b32 s42, s42, 6
    s_add_u32 s42, s42, 9961472
    s_lshl_b32 s43, s43, 7
    s_add_u32 s43, s43, 10223616
    v_mov_b32 v96, 0x3f803f80
    v_mov_b32 v97, 0x3f803f80
    v_mov_b32 v98, 0x3f803f80
    v_mov_b32 v99, 0x3f803f80
    v_mov_b32 v100, 0x3fb8aa3b
    v_mov_b32 v101, 0x3fb8aa3b
    v_mov_b32 v102, 0x358637bd
    v_mov_b32 v103, 0x358637bd
    v_pk_mul_f32 v[16:17], v[176:177], v[100:101]
    v_pk_mul_f32 v[18:19], v[178:179], v[100:101]
    v_pk_mul_f32 v[20:21], v[180:181], v[100:101]
    v_pk_mul_f32 v[22:23], v[182:183], v[100:101]
    v_pk_mul_f32 v[24:25], v[184:185], v[100:101]
    v_pk_mul_f32 v[26:27], v[186:187], v[100:101]
    v_pk_mul_f32 v[28:29], v[188:189], v[100:101]
    v_pk_mul_f32 v[30:31], v[190:191], v[100:101]
    v_exp_f32_e64 v16, v16 clamp
    v_max_f32 v176, 0, v176
    v_exp_f32_e64 v17, v17 clamp
    v_max_f32_e64 v177, 0, v177
    v_exp_f32_e64 v18, v18 clamp
    v_max_f32_e64 v178, 0, v178
    v_exp_f32_e64 v19, v19 clamp
    v_max_f32_e64 v179, 0, v179
    v_exp_f32_e64 v20, v20 clamp
    v_max_f32_e64 v180, 0, v180
    v_exp_f32_e64 v21, v21 clamp
    v_max_f32_e64 v181, 0, v181
    v_exp_f32_e64 v22, v22 clamp
    v_max_f32_e64 v182, 0, v182
    v_exp_f32_e64 v23, v23 clamp
    v_max_f32_e64 v183, 0, v183
    v_exp_f32_e64 v24, v24 clamp
    v_max_f32_e64 v184, 0, v184
    v_exp_f32_e64 v25, v25 clamp
    v_max_f32_e64 v185, 0, v185
    v_exp_f32_e64 v26, v26 clamp
    v_max_f32_e64 v186, 0, v186
    v_exp_f32_e64 v27, v27 clamp
    v_max_f32_e64 v187, 0, v187
    v_exp_f32_e64 v28, v28 clamp
    v_max_f32_e64 v188, 0, v188
    v_exp_f32_e64 v29, v29 clamp
    v_max_f32_e64 v189, 0, v189
    v_exp_f32_e64 v30, v30 clamp
    v_max_f32_e64 v190, 0, v190
    v_exp_f32_e64 v31, v31 clamp
    v_max_f32_e64 v191, 0, v191
    v_pk_add_f32 v[176:177], v[176:177], v[16:17]
    v_pk_add_f32 v[178:179], v[178:179], v[18:19]
    v_pk_add_f32 v[180:181], v[180:181], v[20:21]
    v_pk_add_f32 v[182:183], v[182:183], v[22:23]
    v_pk_add_f32 v[184:185], v[184:185], v[24:25]
    v_pk_add_f32 v[186:187], v[186:187], v[26:27]
    v_pk_add_f32 v[188:189], v[188:189], v[28:29]
    v_pk_add_f32 v[190:191], v[190:191], v[30:31]
    v_pk_add_f32 v[176:177], v[176:177], v[102:103]
    v_pk_add_f32 v[178:179], v[178:179], v[102:103]
    v_pk_add_f32 v[180:181], v[180:181], v[102:103]
    v_pk_add_f32 v[182:183], v[182:183], v[102:103]
    v_pk_add_f32 v[184:185], v[184:185], v[102:103]
    v_pk_add_f32 v[186:187], v[186:187], v[102:103]
    v_pk_add_f32 v[188:189], v[188:189], v[102:103]
    v_pk_add_f32 v[190:191], v[190:191], v[102:103]
    v_cvt_pk_bf16_f32 v48, v176, v177
    v_cvt_pk_bf16_f32 v64, v208, v209
    v_cvt_pk_bf16_f32 v49, v178, v179
    v_cvt_pk_bf16_f32 v65, v210, v211
    v_cvt_pk_bf16_f32 v50, v180, v181
    v_cvt_pk_bf16_f32 v66, v212, v213
    v_cvt_pk_bf16_f32 v51, v182, v183
    v_cvt_pk_bf16_f32 v67, v214, v215
    v_cvt_pk_bf16_f32 v52, v184, v185
    v_cvt_pk_bf16_f32 v68, v216, v217
    v_cvt_pk_bf16_f32 v53, v186, v187
    v_cvt_pk_bf16_f32 v69, v218, v219
    v_cvt_pk_bf16_f32 v54, v188, v189
    v_cvt_pk_bf16_f32 v70, v220, v221
    v_cvt_pk_bf16_f32 v55, v190, v191
    v_cvt_pk_bf16_f32 v71, v222, v223
    v_mfma_f32_16x16x32_bf16 v[112:115], v[64:67], v[48:51], 0
    v_mfma_f32_16x16x32_bf16 v[116:119], v[96:99], v[48:51], 0
    v_mfma_f32_16x16x32_bf16 v[112:115], v[68:71], v[52:55], v[112:115]
    v_mfma_f32_16x16x32_bf16 v[116:119], v[96:99], v[52:55], v[116:119]
    v_pk_mul_f32 v[16:17], v[192:193], v[100:101]
    v_pk_mul_f32 v[18:19], v[194:195], v[100:101]
    v_pk_mul_f32 v[20:21], v[196:197], v[100:101]
    v_pk_mul_f32 v[22:23], v[198:199], v[100:101]
    v_pk_mul_f32 v[24:25], v[200:201], v[100:101]
    v_pk_mul_f32 v[26:27], v[202:203], v[100:101]
    v_pk_mul_f32 v[28:29], v[204:205], v[100:101]
    v_pk_mul_f32 v[30:31], v[206:207], v[100:101]
    v_exp_f32_e64 v16, v16 clamp
    v_max_f32_e64 v192, 0, v192
    v_exp_f32_e64 v17, v17 clamp
    v_max_f32_e64 v193, 0, v193
    v_exp_f32_e64 v18, v18 clamp
    v_max_f32_e64 v194, 0, v194
    v_exp_f32_e64 v19, v19 clamp
    v_max_f32_e64 v195, 0, v195
    v_exp_f32_e64 v20, v20 clamp
    v_max_f32_e64 v196, 0, v196
    v_exp_f32_e64 v21, v21 clamp
    v_max_f32_e64 v197, 0, v197
    v_exp_f32_e64 v22, v22 clamp
    v_max_f32_e64 v198, 0, v198
    v_exp_f32_e64 v23, v23 clamp
    v_max_f32_e64 v199, 0, v199
    v_exp_f32_e64 v24, v24 clamp
    v_max_f32_e64 v200, 0, v200
    v_exp_f32_e64 v25, v25 clamp
    v_max_f32_e64 v201, 0, v201
    v_exp_f32_e64 v26, v26 clamp
    v_max_f32_e64 v202, 0, v202
    v_exp_f32_e64 v27, v27 clamp
    v_max_f32_e64 v203, 0, v203
    v_exp_f32_e64 v28, v28 clamp
    v_max_f32_e64 v204, 0, v204
    v_exp_f32_e64 v29, v29 clamp
    v_max_f32_e64 v205, 0, v205
    v_exp_f32_e64 v30, v30 clamp
    v_max_f32_e64 v206, 0, v206
    v_exp_f32_e64 v31, v31 clamp
    v_max_f32_e64 v207, 0, v207
    v_pk_add_f32 v[192:193], v[192:193], v[16:17]
    v_pk_add_f32 v[194:195], v[194:195], v[18:19]
    v_pk_add_f32 v[196:197], v[196:197], v[20:21]
    v_pk_add_f32 v[198:199], v[198:199], v[22:23]
    v_pk_add_f32 v[200:201], v[200:201], v[24:25]
    v_pk_add_f32 v[202:203], v[202:203], v[26:27]
    v_pk_add_f32 v[204:205], v[204:205], v[28:29]
    v_pk_add_f32 v[206:207], v[206:207], v[30:31]
    v_pk_add_f32 v[192:193], v[192:193], v[102:103]
    v_pk_add_f32 v[194:195], v[194:195], v[102:103]
    v_pk_add_f32 v[196:197], v[196:197], v[102:103]
    v_pk_add_f32 v[198:199], v[198:199], v[102:103]
    v_pk_add_f32 v[200:201], v[200:201], v[102:103]
    v_pk_add_f32 v[202:203], v[202:203], v[102:103]
    v_pk_add_f32 v[204:205], v[204:205], v[102:103]
    v_pk_add_f32 v[206:207], v[206:207], v[102:103]
    v_cvt_pk_bf16_f32 v56, v192, v193
    v_cvt_pk_bf16_f32 v72, v224, v225
    v_cvt_pk_bf16_f32 v57, v194, v195
    v_cvt_pk_bf16_f32 v73, v226, v227
    v_cvt_pk_bf16_f32 v58, v196, v197
    v_cvt_pk_bf16_f32 v74, v228, v229
    v_cvt_pk_bf16_f32 v59, v198, v199
    v_cvt_pk_bf16_f32 v75, v230, v231
    v_cvt_pk_bf16_f32 v60, v200, v201
    v_cvt_pk_bf16_f32 v76, v232, v233
    v_cvt_pk_bf16_f32 v61, v202, v203
    v_cvt_pk_bf16_f32 v77, v234, v235
    v_cvt_pk_bf16_f32 v62, v204, v205
    v_cvt_pk_bf16_f32 v78, v236, v237
    v_cvt_pk_bf16_f32 v63, v206, v207
    v_cvt_pk_bf16_f32 v79, v238, v239
    v_mfma_f32_16x16x32_bf16 v[112:115], v[72:75], v[56:59], v[112:115]
    v_mfma_f32_16x16x32_bf16 v[116:119], v[96:99], v[56:59], v[116:119]
    v_mfma_f32_16x16x32_bf16 v[112:115], v[76:79], v[60:63], v[112:115]
    v_mfma_f32_16x16x32_bf16 v[116:119], v[96:99], v[60:63], v[116:119]
    s_mov_b64 exec, 0xffff
    s_nop 6
    buffer_store_dword v116, v130, s[8:11], s42 offen sc1
    s_mov_b64 exec, -1
    buffer_store_dwordx4 v[112:115], v5, s[8:11], s41 offen sc1
    s_waitcnt vmcnt(4)
    v_cmp_ne_u32 vcc, s29, v172
    s_nop 1
    s_cbranch_vccnz slow_f1
back_f1:
    s_add_u32 s69, s66, 0
    s_and_b32 s69, s69, 7
    s_lshl_b32 s69, s69, 14
    s_add_u32 s69, s69, s64
    buffer_load_dwordx4 a[0:3], v136, s[8:11], s69 offen offset:0 sc1
    buffer_load_dwordx4 a[4:7], v137, s[8:11], s69 offen offset:0 sc1
    buffer_load_dwordx4 a[8:11], v136, s[8:11], s69 offen offset:2048 sc1
    buffer_load_dwordx4 a[12:15], v137, s[8:11], s69 offen offset:2048 sc1
    s_add_u32 s69, s66, 1
    s_and_b32 s69, s69, 7
    s_lshl_b32 s69, s69, 14
    s_add_u32 s69, s69, s64
    buffer_load_dwordx4 a[16:19], v136, s[8:11], s69 offen offset:0 sc1
    buffer_load_dwordx4 a[20:23], v137, s[8:11], s69 offen offset:0 sc1
    buffer_load_dwordx4 a[24:27], v136, s[8:11], s69 offen offset:2048 sc1
    buffer_load_dwordx4 a[28:31], v137, s[8:11], s69 offen offset:2048 sc1
    s_waitcnt vmcnt(8)
    buffer_store_dword v170, v169, s[8:11], s43 offen sc1
    s_add_u32 s69, s66, 2
    s_and_b32 s69, s69, 7
    s_lshl_b32 s69, s69, 14
    s_add_u32 s69, s69, s64
    buffer_load_dwordx4 a[32:35], v136, s[8:11], s69 offen offset:0 sc1
    buffer_load_dwordx4 a[36:39], v137, s[8:11], s69 offen offset:0 sc1
    buffer_load_dwordx4 a[40:43], v136, s[8:11], s69 offen offset:2048 sc1
    buffer_load_dwordx4 a[44:47], v137, s[8:11], s69 offen offset:2048 sc1
g2:
    v_lshlrev_b32 v120, 16, v144
    v_and_b32 v121, 0xffff0000, v144
    v_lshlrev_b32_e64 v122, 16, v145
    v_and_b32 v123, 0xffff0000, v145
    v_lshlrev_b32_e64 v124, 16, v146
    v_and_b32 v125, 0xffff0000, v146
    v_lshlrev_b32_e64 v126, 16, v147
    v_and_b32 v127, 0xffff0000, v147
    v_lshlrev_b32_e64 v128, 16, v148
    v_and_b32 v129, 0xffff0000, v148
    v_lshlrev_b32_e64 v130, 16, v149
    v_and_b32 v131, 0xffff0000, v149
    v_lshlrev_b32_e64 v132, 16, v150
    v_and_b32 v133, 0xffff0000, v150
    v_lshlrev_b32_e64 v134, 16, v151
    v_and_b32 v135, 0xffff0000, v151
    v_add_u32_e64 v144, s67, v5
    v_xor_b32 v145, 8192, v144
    v_xor_b32 v146, 16384, v144
    v_xor_b32 v147, 24576, v144
    v_add_u32 v248, 0x20000, v144
    v_add_u32 v249, 0x20000, v145
    v_add_u32 v250, 0x20000, v146
    v_mov_b32 v148, 0xc0135761
    v_mov_b32 v149, 0xc0135761
    v_mov_b32 v150, 0xbdd2d3e8
    v_mov_b32 v151, 0xbdd2d3e8
    v_mov_b32 v12, 0x3f800000
    v_mov_b32 v13, 0x3f800000
    v_lshlrev_b32_e64 v14, 4, v173
    v_lshl_add_u32 v14, v174, 11, v14
    s_mul_i32 s32, s76, 294912
    s_lshl_b32 s6, s77, 13
    s_add_u32 s32, s32, s6
    s_and_b32 s6, s28, 1
    s_lshl_b32 s6, s6, 12
    s_add_u32 s32, s32, s6
    s_lshr_b32 s6, s28, 1
    s_lshl_b32 s6, s6, 9
    s_add_u32 s32, s32, s6
    s_add_u32 s32, s32, 6291456
    s_lshl_b32 s33, s76, 5
    s_add_u32 s33, s33, s77
    s_lshl_b32 s33, s33, 2
    s_add_u32 s33, s33, s28
    s_lshl_b32 s33, s33, 7
    s_add_u32 s33, s33, 10387456
    ds_read_b64_tr_b16 v[16:17], v142 offset:0
    ds_read_b64_tr_b16 v[18:19], v142 offset:512
    ds_read_b64_tr_b16 v[20:21], v143 offset:0
    ds_read_b64_tr_b16 v[22:23], v143 offset:512
    ds_read_b64_tr_b16 v[24:25], v142 offset:2048
    ds_read_b64_tr_b16 v[26:27], v142 offset:2560
    ds_read_b64_tr_b16 v[28:29], v143 offset:2048
    ds_read_b64_tr_b16 v[30:31], v143 offset:2560
    s_waitcnt vmcnt(9) lgkmcnt(0)
    v_mfma_f32_32x32x16_bf16 a[64:79], v[16:19], a[0:3], 0
    ds_read_b64_tr_b16 v[32:33], v142 offset:4096
    ds_read_b64_tr_b16 v[34:35], v142 offset:4608
    s_add_u32 s68, s66, 4
    s_and_b32 s68, s68, 7
    s_mul_i32 s68, s68, 458752
    s_add_u32 s68, s68, s65
    s_add_u32 m0, s67, 65536
    s_nop 0
    buffer_load_dwordx4 v138, s[24:27], s68 offen offset:0 lds
    v_mfma_f32_32x32x16_bf16 a[80:95], v[20:23], a[0:3], 0
    ds_read_b64_tr_b16 v[36:37], v143 offset:4096
    ds_read_b64_tr_b16 v[38:39], v143 offset:4608
    buffer_load_dwordx4 v139, s[24:27], s68 offen offset:1024 lds
    v_mfma_f32_32x32x16_bf16 a[96:111], v[16:19], a[4:7], 0
    ds_read_b64_tr_b16 v[40:41], v142 offset:6144
    ds_read_b64_tr_b16 v[42:43], v142 offset:6656
    buffer_load_dwordx4 v140, s[24:27], s68 offen offset:2048 lds
    v_mfma_f32_32x32x16_bf16 a[112:127], v[20:23], a[4:7], 0
    ds_read_b64_tr_b16 v[44:45], v143 offset:6144
    ds_read_b64_tr_b16 v[46:47], v143 offset:6656
    buffer_load_dwordx4 v141, s[24:27], s68 offen offset:3072 lds
    v_mfma_f32_32x32x16_bf16 a[64:79], v[24:27], a[8:11], a[64:79]
    s_add_u32 s69, s66, 3
    s_and_b32 s69, s69, 7
    s_lshl_b32 s69, s69, 14
    s_add_u32 s69, s69, s64
    buffer_load_dwordx4 a[48:51], v136, s[8:11], s69 offen offset:0 sc1
    v_mfma_f32_32x32x16_bf16 a[80:95], v[28:31], a[8:11], a[80:95]
    buffer_load_dwordx4 a[52:55], v137, s[8:11], s69 offen offset:0 sc1
    v_mfma_f32_32x32x16_bf16 a[96:111], v[24:27], a[12:15], a[96:111]
    buffer_load_dwordx4 a[56:59], v136, s[8:11], s69 offen offset:2048 sc1
    v_mfma_f32_32x32x16_bf16 a[112:127], v[28:31], a[12:15], a[112:127]
    buffer_load_dwordx4 a[60:63], v137, s[8:11], s69 offen offset:2048 sc1
    s_waitcnt vmcnt(13) lgkmcnt(0)
    s_barrier
    v_mfma_f32_32x32x16_bf16 a[64:79], v[32:35], a[16:19], a[64:79]
    ds_read_b64_tr_b16 v[16:17], v142 offset:32768
    ds_read_b64_tr_b16 v[18:19], v142 offset:33280
    s_add_u32 s68, s66, 5
    s_and_b32 s68, s68, 7
    s_mul_i32 s68, s68, 458752
    s_add_u32 s68, s68, s65
    s_add_u32 m0, s67, 69632
    s_nop 0
    buffer_load_dwordx4 v138, s[24:27], s68 offen offset:0 lds
    v_mfma_f32_32x32x16_bf16 a[80:95], v[36:39], a[16:19], a[80:95]
    ds_read_b64_tr_b16 v[20:21], v143 offset:32768
    ds_read_b64_tr_b16 v[22:23], v143 offset:33280
    buffer_load_dwordx4 v139, s[24:27], s68 offen offset:1024 lds
    v_mfma_f32_32x32x16_bf16 a[96:111], v[32:35], a[20:23], a[96:111]
    ds_read_b64_tr_b16 v[24:25], v142 offset:34816
    ds_read_b64_tr_b16 v[26:27], v142 offset:35328
    buffer_load_dwordx4 v140, s[24:27], s68 offen offset:2048 lds
    v_mfma_f32_32x32x16_bf16 a[112:127], v[36:39], a[20:23], a[112:127]
    ds_read_b64_tr_b16 v[28:29], v143 offset:34816
    ds_read_b64_tr_b16 v[30:31], v143 offset:35328
    buffer_load_dwordx4 v141, s[24:27], s68 offen offset:3072 lds
    v_mfma_f32_32x32x16_bf16 a[64:79], v[40:43], a[24:27], a[64:79]
    s_add_u32 s69, s66, 4
    s_and_b32 s69, s69, 7
    s_lshl_b32 s69, s69, 14
    s_add_u32 s69, s69, s64
    buffer_load_dwordx4 a[0:3], v136, s[8:11], s69 offen offset:0 sc1
    v_mfma_f32_32x32x16_bf16 a[80:95], v[44:47], a[24:27], a[80:95]
    buffer_load_dwordx4 a[4:7], v137, s[8:11], s69 offen offset:0 sc1
    v_mfma_f32_32x32x16_bf16 a[96:111], v[40:43], a[28:31], a[96:111]
    buffer_load_dwordx4 a[8:11], v136, s[8:11], s69 offen offset:2048 sc1
    v_mfma_f32_32x32x16_bf16 a[112:127], v[44:47], a[28:31], a[112:127]
    buffer_load_dwordx4 a[12:15], v137, s[8:11], s69 offen offset:2048 sc1
    s_waitcnt vmcnt(16) lgkmcnt(0)
    v_mfma_f32_32x32x16_bf16 a[64:79], v[16:19], a[32:35], a[64:79]
    ds_read_b64_tr_b16 v[32:33], v142 offset:36864
    ds_read_b64_tr_b16 v[34:35], v142 offset:37376
    s_add_u32 s68, s66, 6
    s_and_b32 s68, s68, 7
    s_mul_i32 s68, s68, 458752
    s_add_u32 s68, s68, s65
    s_add_u32 m0, s67, 98304
    s_nop 0
    buffer_load_dwordx4 v138, s[24:27], s68 offen offset:0 lds
    v_mfma_f32_32x32x16_bf16 a[80:95], v[20:23], a[32:35], a[80:95]
    ds_read_b64_tr_b16 v[36:37], v143 offset:36864
    ds_read_b64_tr_b16 v[38:39], v143 offset:37376
    buffer_load_dwordx4 v139, s[24:27], s68 offen offset:1024 lds
    v_mfma_f32_32x32x16_bf16 a[96:111], v[16:19], a[36:39], a[96:111]
    ds_read_b64_tr_b16 v[40:41], v142 offset:38912
    ds_read_b64_tr_b16 v[42:43], v142 offset:39424
    buffer_load_dwordx4 v140, s[24:27], s68 offen offset:2048 lds
    v_mfma_f32_32x32x16_bf16 a[112:127], v[20:23], a[36:39], a[112:127]
    ds_read_b64_tr_b16 v[44:45], v143 offset:38912
    ds_read_b64_tr_b16 v[46:47], v143 offset:39424
    buffer_load_dwordx4 v141, s[24:27], s68 offen offset:3072 lds
    v_mfma_f32_32x32x16_bf16 a[64:79], v[24:27], a[40:43], a[64:79]
    s_add_u32 s69, s66, 5
    s_and_b32 s69, s69, 7
    s_lshl_b32 s69, s69, 14
    s_add_u32 s69, s69, s64
    buffer_load_dwordx4 a[16:19], v136, s[8:11], s69 offen offset:0 sc1
    v_mfma_f32_32x32x16_bf16 a[80:95], v[28:31], a[40:43], a[80:95]
    buffer_load_dwordx4 a[20:23], v137, s[8:11], s69 offen offset:0 sc1
    v_mfma_f32_32x32x16_bf16 a[96:111], v[24:27], a[44:47], a[96:111]
    buffer_load_dwordx4 a[24:27], v136, s[8:11], s69 offen offset:2048 sc1
    v_mfma_f32_32x32x16_bf16 a[112:127], v[28:31], a[44:47], a[112:127]
    buffer_load_dwordx4 a[28:31], v137, s[8:11], s69 offen offset:2048 sc1
    s_waitcnt vmcnt(16) lgkmcnt(0)
    v_mfma_f32_32x32x16_bf16 a[64:79], v[32:35], a[48:51], a[64:79]
    ds_read_b64_tr_b16 v[16:17], v244 offset:0
    ds_read_b64_tr_b16 v[18:19], v244 offset:512
    s_add_u32 s68, s66, 7
    s_and_b32 s68, s68, 7
    s_mul_i32 s68, s68, 458752
    s_add_u32 s68, s68, s65
    s_add_u32 m0, s67, 102400
    s_nop 0
    buffer_load_dwordx4 v138, s[24:27], s68 offen offset:0 lds
    v_mfma_f32_32x32x16_bf16 a[80:95], v[36:39], a[48:51], a[80:95]
    ds_read_b64_tr_b16 v[20:21], v245 offset:0
    ds_read_b64_tr_b16 v[22:23], v245 offset:512
    buffer_load_dwordx4 v139, s[24:27], s68 offen offset:1024 lds
    v_mfma_f32_32x32x16_bf16 a[96:111], v[32:35], a[52:55], a[96:111]
    ds_read_b64_tr_b16 v[24:25], v244 offset:2048
    ds_read_b64_tr_b16 v[26:27], v244 offset:2560
    buffer_load_dwordx4 v140, s[24:27], s68 offen offset:2048 lds
    v_mfma_f32_32x32x16_bf16 a[112:127], v[36:39], a[52:55], a[112:127]
    ds_read_b64_tr_b16 v[28:29], v245 offset:2048
    ds_read_b64_tr_b16 v[30:31], v245 offset:2560
    buffer_load_dwordx4 v141, s[24:27], s68 offen offset:3072 lds
    v_mfma_f32_32x32x16_bf16 a[64:79], v[40:43], a[56:59], a[64:79]
    s_add_u32 s69, s66, 6
    s_and_b32 s69, s69, 7
    s_lshl_b32 s69, s69, 14
    s_add_u32 s69, s69, s64
    buffer_load_dwordx4 a[32:35], v136, s[8:11], s69 offen offset:0 sc1
    v_mfma_f32_32x32x16_bf16 a[80:95], v[44:47], a[56:59], a[80:95]
    buffer_load_dwordx4 a[36:39], v137, s[8:11], s69 offen offset:0 sc1
    v_mfma_f32_32x32x16_bf16 a[96:111], v[40:43], a[60:63], a[96:111]
    buffer_load_dwordx4 a[40:43], v136, s[8:11], s69 offen offset:2048 sc1
    v_mfma_f32_32x32x16_bf16 a[112:127], v[44:47], a[60:63], a[112:127]
    buffer_load_dwordx4 a[44:47], v137, s[8:11], s69 offen offset:2048 sc1
    s_waitcnt vmcnt(16) lgkmcnt(0)
    v_mfma_f32_32x32x16_bf16 a[64:79], v[16:19], a[0:3], a[64:79]
    ds_read_b64_tr_b16 v[32:33], v244 offset:4096
    ds_read_b64_tr_b16 v[34:35], v244 offset:4608
    s_add_u32 s69, s66, 7
    s_and_b32 s69, s69, 7
    s_lshl_b32 s69, s69, 14
    s_add_u32 s69, s69, s64
    buffer_load_dwordx4 a[48:51], v136, s[8:11], s69 offen offset:0 sc1
    v_mfma_f32_32x32x16_bf16 a[80:95], v[20:23], a[0:3], a[80:95]
    ds_read_b64_tr_b16 v[36:37], v245 offset:4096
    ds_read_b64_tr_b16 v[38:39], v245 offset:4608
    buffer_load_dwordx4 a[52:55], v137, s[8:11], s69 offen offset:0 sc1
    v_mfma_f32_32x32x16_bf16 a[96:111], v[16:19], a[4:7], a[96:111]
    ds_read_b64_tr_b16 v[40:41], v244 offset:6144
    ds_read_b64_tr_b16 v[42:43], v244 offset:6656
    buffer_load_dwordx4 a[56:59], v136, s[8:11], s69 offen offset:2048 sc1
    v_mfma_f32_32x32x16_bf16 a[112:127], v[20:23], a[4:7], a[112:127]
    ds_read_b64_tr_b16 v[44:45], v245 offset:6144
    ds_read_b64_tr_b16 v[46:47], v245 offset:6656
    buffer_load_dwordx4 a[60:63], v137, s[8:11], s69 offen offset:2048 sc1
    v_mfma_f32_32x32x16_bf16 a[64:79], v[24:27], a[8:11], a[64:79]
    v_mfma_f32_32x32x16_bf16 a[80:95], v[28:31], a[8:11], a[80:95]
    v_mfma_f32_32x32x16_bf16 a[96:111], v[24:27], a[12:15], a[96:111]
    v_mfma_f32_32x32x16_bf16 a[112:127], v[28:31], a[12:15], a[112:127]
    s_waitcnt vmcnt(12) lgkmcnt(0)
    v_mfma_f32_32x32x16_bf16 a[64:79], v[32:35], a[16:19], a[64:79]
    ds_read_b64_tr_b16 v[16:17], v244 offset:32768
    ds_read_b64_tr_b16 v[18:19], v244 offset:33280
    s_add_u32 s69, s66, 0
    s_and_b32 s69, s69, 7
    s_lshl_b32 s69, s69, 14
    s_add_u32 s69, s69, s80
    buffer_load_dwordx4 a[128:131], v136, s[8:11], s69 offen offset:0 sc1
    v_mfma_f32_32x32x16_bf16 a[80:95], v[36:39], a[16:19], a[80:95]
    ds_read_b64_tr_b16 v[20:21], v245 offset:32768
    ds_read_b64_tr_b16 v[22:23], v245 offset:33280
    buffer_load_dwordx4 a[132:135], v137, s[8:11], s69 offen offset:0 sc1
    v_mfma_f32_32x32x16_bf16 a[96:111], v[32:35], a[20:23], a[96:111]
    ds_read_b64_tr_b16 v[24:25], v244 offset:34816
    ds_read_b64_tr_b16 v[26:27], v244 offset:35328
    buffer_load_dwordx4 a[136:139], v136, s[8:11], s69 offen offset:2048 sc1
    v_mfma_f32_32x32x16_bf16 a[112:127], v[36:39], a[20:23], a[112:127]
    ds_read_b64_tr_b16 v[28:29], v245 offset:34816
    ds_read_b64_tr_b16 v[30:31], v245 offset:35328
    buffer_load_dwordx4 a[140:143], v137, s[8:11], s69 offen offset:2048 sc1
    v_mfma_f32_32x32x16_bf16 a[64:79], v[40:43], a[24:27], a[64:79]
    v_mfma_f32_32x32x16_bf16 a[80:95], v[44:47], a[24:27], a[80:95]
    v_mfma_f32_32x32x16_bf16 a[96:111], v[40:43], a[28:31], a[96:111]
    v_mfma_f32_32x32x16_bf16 a[112:127], v[44:47], a[28:31], a[112:127]
    s_waitcnt vmcnt(8) lgkmcnt(0)
    v_mfma_f32_32x32x16_bf16 a[64:79], v[16:19], a[32:35], a[64:79]
    ds_read_b64_tr_b16 v[32:33], v244 offset:36864
    ds_read_b64_tr_b16 v[34:35], v244 offset:37376
    s_add_u32 s69, s66, 1
    s_and_b32 s69, s69, 7
    s_lshl_b32 s69, s69, 14
    s_add_u32 s69, s69, s80
    buffer_load_dwordx4 a[144:147], v136, s[8:11], s69 offen offset:0 sc1
    v_mfma_f32_32x32x16_bf16 a[80:95], v[20:23], a[32:35], a[80:95]
    ds_read_b64_tr_b16 v[36:37], v245 offset:36864
    ds_read_b64_tr_b16 v[38:39], v245 offset:37376
    buffer_load_dwordx4 a[148:151], v137, s[8:11], s69 offen offset:0 sc1
    v_mfma_f32_32x32x16_bf16 a[96:111], v[16:19], a[36:39], a[96:111]
    ds_read_b64_tr_b16 v[40:41], v244 offset:38912
    ds_read_b64_tr_b16 v[42:43], v244 offset:39424
    buffer_load_dwordx4 a[152:155], v136, s[8:11], s69 offen offset:2048 sc1
    v_mfma_f32_32x32x16_bf16 a[112:127], v[20:23], a[36:39], a[112:127]
    ds_read_b64_tr_b16 v[44:45], v245 offset:38912
    ds_read_b64_tr_b16 v[46:47], v245 offset:39424
    buffer_load_dwordx4 a[156:159], v137, s[8:11], s69 offen offset:2048 sc1
    v_mfma_f32_32x32x16_bf16 a[64:79], v[24:27], a[40:43], a[64:79]
    v_mfma_f32_32x32x16_bf16 a[80:95], v[28:31], a[40:43], a[80:95]
    v_mfma_f32_32x32x16_bf16 a[96:111], v[24:27], a[44:47], a[96:111]
    v_mfma_f32_32x32x16_bf16 a[112:127], v[28:31], a[44:47], a[112:127]
    s_waitcnt vmcnt(8) lgkmcnt(0)
    s_lshl_b32 s99, s2, 2
    s_add_u32 s99, s99, s28
    s_lshl_b32 s98, s99, 12
    s_add_u32 s98, s98, 16777216
    s_lshl_b32 s99, s99, 7
    s_add_u32 s99, s99, 10747904
    s_xor_b32 s100, s98, 0x4000
    s_xor_b32 s101, s99, 0x200
    v_mfma_f32_32x32x16_bf16 a[80:95], v[36:39], a[48:51], a[80:95]
    ds_read_b64_tr_b16 v[16:17], v142 offset:0
    ds_read_b64_tr_b16 v[18:19], v142 offset:512
    s_add_u32 s69, s66, 2
    s_and_b32 s69, s69, 7
    s_lshl_b32 s69, s69, 14
    s_add_u32 s69, s69, s80
    buffer_load_dwordx4 a[160:163], v136, s[8:11], s69 offen offset:0 sc1
    v_mfma_f32_32x32x16_bf16 a[80:95], v[44:47], a[56:59], a[80:95]
    ds_read_b64_tr_b16 v[20:21], v143 offset:0
    ds_read_b64_tr_b16 v[22:23], v143 offset:512
    buffer_load_dwordx4 a[164:167], v137, s[8:11], s69 offen offset:0 sc1
    v_mfma_f32_32x32x16_bf16 a[96:111], v[32:35], a[52:55], a[96:111]
    ds_read_b64_tr_b16 v[24:25], v142 offset:2048
    ds_read_b64_tr_b16 v[26:27], v142 offset:2560
    buffer_load_dwordx4 a[168:171], v136, s[8:11], s69 offen offset:2048 sc1
    v_mfma_f32_32x32x16_bf16 a[96:111], v[40:43], a[60:63], a[96:111]
    ds_read_b64_tr_b16 v[28:29], v143 offset:2048
    ds_read_b64_tr_b16 v[30:31], v143 offset:2560
    buffer_load_dwordx4 a[172:175], v137, s[8:11], s69 offen offset:2048 sc1
    v_mfma_f32_32x32x16_bf16 a[112:127], v[36:39], a[52:55], a[112:127]
    s_add_u32 s69, s66, 3
    s_and_b32 s69, s69, 7
    s_lshl_b32 s69, s69, 14
    s_add_u32 s69, s69, s80
    buffer_load_dwordx4 a[176:179], v136, s[8:11], s69 offen offset:0 sc1
    v_mfma_f32_32x32x16_bf16 a[112:127], v[44:47], a[60:63], a[112:127]
    buffer_load_dwordx4 a[180:183], v137, s[8:11], s69 offen offset:0 sc1
    ds_write_b128 v248, a[80:83] offset:0
    ds_write_b128 v248, a[84:87] offset:1024
    ds_write_b128 v248, a[88:91] offset:2048
    ds_write_b128 v248, a[92:95] offset:3072
    v_mfma_f32_32x32x16_bf16 a[64:79], v[32:35], a[48:51], a[64:79]
    buffer_load_dwordx4 a[184:187], v136, s[8:11], s69 offen offset:2048 sc1
    v_mfma_f32_32x32x16_bf16 a[64:79], v[40:43], a[56:59], a[64:79]
    buffer_load_dwordx4 a[188:191], v137, s[8:11], s69 offen offset:2048 sc1
    ds_write_b128 v248, a[96:99] offset:4096
    ds_write_b128 v248, a[100:103] offset:5120
    ds_write_b128 v248, a[104:107] offset:6144
    s_waitcnt lgkmcnt(14)
    ds_write_b128 v248, a[108:111] offset:7168
    s_waitcnt vmcnt(12) lgkmcnt(8)
    ds_write_b128 v144, a[112:115] offset:0
    ds_write_b128 v144, a[116:119] offset:1024
    ds_write_b128 v144, a[120:123] offset:2048
    ds_write_b128 v144, a[124:127] offset:3072
    s_add_u32 s69, s66, 4
    s_and_b32 s69, s69, 7
    s_lshl_b32 s69, s69, 14
    s_add_u32 s69, s69, s80
    buffer_load_dwordx4 a[192:195], v136, s[8:11], s69 offen offset:0 sc1
    buffer_load_dwordx4 a[196:199], v137, s[8:11], s69 offen offset:0 sc1
    buffer_load_dwordx4 a[200:203], v136, s[8:11], s69 offen offset:2048 sc1
    buffer_load_dwordx4 a[204:207], v137, s[8:11], s69 offen offset:2048 sc1
    s_add_u32 s69, s66, 5
    s_and_b32 s69, s69, 7
    s_lshl_b32 s69, s69, 14
    s_add_u32 s69, s69, s80
    buffer_load_dwordx4 a[208:211], v136, s[8:11], s69 offen offset:0 sc1
    buffer_load_dwordx4 a[212:215], v137, s[8:11], s69 offen offset:0 sc1
    buffer_load_dwordx4 a[216:219], v136, s[8:11], s69 offen offset:2048 sc1
    buffer_load_dwordx4 a[220:223], v137, s[8:11], s69 offen offset:2048 sc1
    s_waitcnt lgkmcnt(0)
    s_barrier
    ds_read_b128 v[64:67], v249 offset:0
    ds_read_b128 v[68:71], v249 offset:1024
    ds_read_b128 v[72:75], v249 offset:2048
    ds_read_b128 v[76:79], v249 offset:3072
    ds_read_b128 v[80:83], v250 offset:4096
    ds_read_b128 v[84:87], v250 offset:5120
    ds_read_b128 v[88:91], v250 offset:6144
    ds_read_b128 v[92:95], v250 offset:7168
    ds_read_b128 v[96:99], v147 offset:0
    ds_read_b128 v[100:103], v147 offset:1024
    ds_read_b128 v[104:107], v147 offset:2048
    ds_read_b128 v[108:111], v147 offset:3072
    v_accvgpr_read_b32 v176, a64
    v_accvgpr_read_b32 v177, a65
    v_accvgpr_read_b32 v178, a66
    v_accvgpr_read_b32 v179, a67
    v_accvgpr_read_b32 v180, a68
    v_accvgpr_read_b32 v181, a69
    v_accvgpr_read_b32 v182, a70
    v_accvgpr_read_b32 v183, a71
    v_accvgpr_read_b32 v184, a72
    v_accvgpr_read_b32 v185, a73
    v_accvgpr_read_b32 v186, a74
    v_accvgpr_read_b32 v187, a75
    v_accvgpr_read_b32 v188, a76
    v_accvgpr_read_b32 v189, a77
    v_accvgpr_read_b32 v190, a78
    v_accvgpr_read_b32 v191, a79
    s_waitcnt lgkmcnt(8)
    v_pk_add_f32 v[176:177], v[176:177], v[64:65]
    v_pk_add_f32 v[178:179], v[178:179], v[66:67]
    v_pk_add_f32 v[180:181], v[180:181], v[68:69]
    v_pk_add_f32 v[182:183], v[182:183], v[70:71]
    v_pk_add_f32 v[184:185], v[184:185], v[72:73]
    v_pk_add_f32 v[186:187], v[186:187], v[74:75]
    v_pk_add_f32 v[188:189], v[188:189], v[76:77]
    v_pk_add_f32 v[190:191], v[190:191], v[78:79]
    s_waitcnt lgkmcnt(4)
    v_pk_add_f32 v[176:177], v[176:177], v[80:81]
    v_pk_add_f32 v[178:179], v[178:179], v[82:83]
    v_pk_add_f32 v[180:181], v[180:181], v[84:85]
    v_pk_add_f32 v[182:183], v[182:183], v[86:87]
    v_pk_add_f32 v[184:185], v[184:185], v[88:89]
    v_pk_add_f32 v[186:187], v[186:187], v[90:91]
    v_pk_add_f32 v[188:189], v[188:189], v[92:93]
    v_pk_add_f32 v[190:191], v[190:191], v[94:95]
    s_waitcnt lgkmcnt(0)
    v_pk_add_f32 v[176:177], v[176:177], v[96:97]
    v_pk_add_f32 v[178:179], v[178:179], v[98:99]
    v_pk_add_f32 v[180:181], v[180:181], v[100:101]
    v_pk_add_f32 v[182:183], v[182:183], v[102:103]
    v_pk_add_f32 v[184:185], v[184:185], v[104:105]
    v_pk_add_f32 v[186:187], v[186:187], v[106:107]
    v_pk_add_f32 v[188:189], v[188:189], v[108:109]
    v_pk_add_f32 v[190:191], v[190:191], v[110:111]
    v_cvt_pk_bf16_f32 v176, v176, v177
    v_cvt_pk_bf16_f32 v177, v178, v179
    v_cvt_pk_bf16_f32 v178, v180, v181
    v_cvt_pk_bf16_f32 v179, v182, v183
    buffer_store_dwordx4 v[176:179], v5, s[8:11], s98 offen offset:0 sc1
    v_cvt_pk_bf16_f32 v180, v184, v185
    v_cvt_pk_bf16_f32 v181, v186, v187
    v_cvt_pk_bf16_f32 v182, v188, v189
    v_cvt_pk_bf16_f32 v183, v190, v191
    buffer_store_dwordx4 v[180:183], v5, s[8:11], s98 offen offset:1024 sc1
    v_mfma_f32_32x32x16_bf16 v[48:63], v[16:19], a[128:131], v[120:135]
    ds_read_b64_tr_b16 v[32:33], v142 offset:4096
    ds_read_b64_tr_b16 v[34:35], v142 offset:4608
    s_add_u32 s69, s66, 6
    s_and_b32 s69, s69, 7
    s_lshl_b32 s69, s69, 14
    s_add_u32 s69, s69, s80
    buffer_load_dwordx4 a[224:227], v136, s[8:11], s69 offen offset:0 sc1
    v_mfma_f32_32x32x16_bf16 v[64:79], v[20:23], a[128:131], 0
    ds_read_b64_tr_b16 v[36:37], v143 offset:4096
    ds_read_b64_tr_b16 v[38:39], v143 offset:4608
    buffer_load_dwordx4 a[228:231], v137, s[8:11], s69 offen offset:0 sc1
    v_mfma_f32_32x32x16_bf16 v[80:95], v[16:19], a[132:135], 0
    ds_read_b64_tr_b16 v[40:41], v142 offset:6144
    ds_read_b64_tr_b16 v[42:43], v142 offset:6656
    buffer_load_dwordx4 a[232:235], v136, s[8:11], s69 offen offset:2048 sc1
    v_mfma_f32_32x32x16_bf16 v[96:111], v[20:23], a[132:135], 0
    ds_read_b64_tr_b16 v[44:45], v143 offset:6144
    ds_read_b64_tr_b16 v[46:47], v143 offset:6656
    buffer_load_dwordx4 a[236:239], v137, s[8:11], s69 offen offset:2048 sc1
    v_mfma_f32_32x32x16_bf16 v[48:63], v[24:27], a[136:139], v[48:63]
    s_add_u32 s69, s66, 7
    s_and_b32 s69, s69, 7
    s_lshl_b32 s69, s69, 14
    s_add_u32 s69, s69, s80
    buffer_load_dwordx4 a[240:243], v136, s[8:11], s69 offen offset:0 sc1
    v_mfma_f32_32x32x16_bf16 v[64:79], v[28:31], a[136:139], v[64:79]
    buffer_load_dwordx4 a[244:247], v137, s[8:11], s69 offen offset:0 sc1
    v_mfma_f32_32x32x16_bf16 v[80:95], v[24:27], a[140:143], v[80:95]
    buffer_load_dwordx4 a[248:251], v136, s[8:11], s69 offen offset:2048 sc1
    v_mfma_f32_32x32x16_bf16 v[96:111], v[28:31], a[140:143], v[96:111]
    buffer_load_dwordx4 a[252:255], v137, s[8:11], s69 offen offset:2048 sc1
    s_waitcnt vmcnt(26) lgkmcnt(0)
    v_mfma_f32_32x32x16_bf16 v[48:63], v[32:35], a[144:147], v[48:63]
    ds_read_b64_tr_b16 v[16:17], v142 offset:32768
    ds_read_b64_tr_b16 v[18:19], v142 offset:33280
    v_mfma_f32_32x32x16_bf16 v[64:79], v[36:39], a[144:147], v[64:79]
    ds_read_b64_tr_b16 v[20:21], v143 offset:32768
    ds_read_b64_tr_b16 v[22:23], v143 offset:33280
    v_mfma_f32_32x32x16_bf16 v[80:95], v[32:35], a[148:151], v[80:95]
    ds_read_b64_tr_b16 v[24:25], v142 offset:34816
    ds_read_b64_tr_b16 v[26:27], v142 offset:35328
    v_mfma_f32_32x32x16_bf16 v[96:111], v[36:39], a[148:151], v[96:111]
    ds_read_b64_tr_b16 v[28:29], v143 offset:34816
    ds_read_b64_tr_b16 v[30:31], v143 offset:35328
    v_mfma_f32_32x32x16_bf16 v[48:63], v[40:43], a[152:155], v[48:63]
    v_mfma_f32_32x32x16_bf16 v[64:79], v[44:47], a[152:155], v[64:79]
    v_mfma_f32_32x32x16_bf16 v[80:95], v[40:43], a[156:159], v[80:95]
    v_mfma_f32_32x32x16_bf16 v[96:111], v[44:47], a[156:159], v[96:111]
    s_waitcnt vmcnt(22) lgkmcnt(0)
    s_barrier
    v_mfma_f32_32x32x16_bf16 v[48:63], v[16:19], a[160:163], v[48:63]
    ds_read_b64_tr_b16 v[32:33], v142 offset:36864
    ds_read_b64_tr_b16 v[34:35], v142 offset:37376
    v_mfma_f32_32x32x16_bf16 v[64:79], v[20:23], a[160:163], v[64:79]
    ds_read_b64_tr_b16 v[36:37], v143 offset:36864
    ds_read_b64_tr_b16 v[38:39], v143 offset:37376
    v_mfma_f32_32x32x16_bf16 v[80:95], v[16:19], a[164:167], v[80:95]
    ds_read_b64_tr_b16 v[40:41], v142 offset:38912
    ds_read_b64_tr_b16 v[42:43], v142 offset:39424
    v_mfma_f32_32x32x16_bf16 v[96:111], v[20:23], a[164:167], v[96:111]
    ds_read_b64_tr_b16 v[44:45], v143 offset:38912
    ds_read_b64_tr_b16 v[46:47], v143 offset:39424
    v_mfma_f32_32x32x16_bf16 v[48:63], v[24:27], a[168:171], v[48:63]
    v_mfma_f32_32x32x16_bf16 v[64:79], v[28:31], a[168:171], v[64:79]
    v_mfma_f32_32x32x16_bf16 v[80:95], v[24:27], a[172:175], v[80:95]
    v_mfma_f32_32x32x16_bf16 v[96:111], v[28:31], a[172:175], v[96:111]
    s_waitcnt vmcnt(18) lgkmcnt(0)
    s_waitcnt vmcnt(8)
    buffer_store_dword v170, v169, s[8:11], s99 offen sc1
    v_mfma_f32_32x32x16_bf16 v[48:63], v[32:35], a[176:179], v[48:63]
    ds_read_b64_tr_b16 v[16:17], v244 offset:0
    ds_read_b64_tr_b16 v[18:19], v244 offset:512
    s_add_u32 s74, s72, 0
    s_cmp_ge_u32 s74, 7
    s_cselect_b32 s6, 7, 0
    s_sub_u32 s74, s74, s6
    s_mul_i32 s74, s74, 524288
    s_add_u32 s74, s74, s71
    s_add_u32 m0, s67, 131072
    s_nop 0
    buffer_load_dwordx4 v154, s[44:47], s74 offen offset:0 lds
    v_mfma_f32_32x32x16_bf16 v[64:79], v[36:39], a[176:179], v[64:79]
    ds_read_b64_tr_b16 v[20:21], v245 offset:0
    ds_read_b64_tr_b16 v[22:23], v245 offset:512
    buffer_load_dwordx4 v155, s[44:47], s74 offen offset:1024 lds
    v_mfma_f32_32x32x16_bf16 v[80:95], v[32:35], a[180:183], v[80:95]
    ds_read_b64_tr_b16 v[24:25], v244 offset:2048
    ds_read_b64_tr_b16 v[26:27], v244 offset:2560
    buffer_load_dwordx4 v156, s[44:47], s74 offen offset:2048 lds
    v_mfma_f32_32x32x16_bf16 v[96:111], v[36:39], a[180:183], v[96:111]
    ds_read_b64_tr_b16 v[28:29], v245 offset:2048
    ds_read_b64_tr_b16 v[30:31], v245 offset:2560
    buffer_load_dwordx4 v157, s[44:47], s74 offen offset:3072 lds
    v_mfma_f32_32x32x16_bf16 v[48:63], v[40:43], a[184:187], v[48:63]
    s_add_u32 s74, s72, 1
    s_cmp_ge_u32 s74, 7
    s_cselect_b32 s6, 7, 0
    s_sub_u32 s74, s74, s6
    s_mul_i32 s74, s74, 524288
    s_add_u32 s74, s74, s71
    s_add_u32 m0, s67, 135168
    s_nop 0
    buffer_load_dwordx4 v154, s[44:47], s74 offen offset:0 lds
    v_mfma_f32_32x32x16_bf16 v[64:79], v[44:47], a[184:187], v[64:79]
    buffer_load_dwordx4 v155, s[44:47], s74 offen offset:1024 lds
    v_mfma_f32_32x32x16_bf16 v[80:95], v[40:43], a[188:191], v[80:95]
    buffer_load_dwordx4 v156, s[44:47], s74 offen offset:2048 lds
    v_mfma_f32_32x32x16_bf16 v[96:111], v[44:47], a[188:191], v[96:111]
    buffer_load_dwordx4 v157, s[44:47], s74 offen offset:3072 lds
    s_waitcnt lgkmcnt(0)
    v_mfma_f32_32x32x16_bf16 v[48:63], v[16:19], a[192:195], v[48:63]
    ds_read_b64_tr_b16 v[32:33], v244 offset:4096
    ds_read_b64_tr_b16 v[34:35], v244 offset:4608
    v_mfma_f32_32x32x16_bf16 v[64:79], v[20:23], a[192:195], v[64:79]
    ds_read_b64_tr_b16 v[36:37], v245 offset:4096
    ds_read_b64_tr_b16 v[38:39], v245 offset:4608
    v_mfma_f32_32x32x16_bf16 v[80:95], v[16:19], a[196:199], v[80:95]
    ds_read_b64_tr_b16 v[40:41], v244 offset:6144
    ds_read_b64_tr_b16 v[42:43], v244 offset:6656
    v_mfma_f32_32x32x16_bf16 v[96:111], v[20:23], a[196:199], v[96:111]
    ds_read_b64_tr_b16 v[44:45], v245 offset:6144
    ds_read_b64_tr_b16 v[46:47], v245 offset:6656
    v_mfma_f32_32x32x16_bf16 v[48:63], v[24:27], a[200:203], v[48:63]
    v_mfma_f32_32x32x16_bf16 v[64:79], v[28:31], a[200:203], v[64:79]
    v_mfma_f32_32x32x16_bf16 v[80:95], v[24:27], a[204:207], v[80:95]
    v_mfma_f32_32x32x16_bf16 v[96:111], v[28:31], a[204:207], v[96:111]
    s_waitcnt lgkmcnt(0)
    v_mfma_f32_32x32x16_bf16 v[48:63], v[32:35], a[208:211], v[48:63]
    ds_read_b64_tr_b16 v[16:17], v244 offset:32768
    ds_read_b64_tr_b16 v[18:19], v244 offset:33280
    v_mfma_f32_32x32x16_bf16 v[64:79], v[36:39], a[208:211], v[64:79]
    ds_read_b64_tr_b16 v[20:21], v245 offset:32768
    ds_read_b64_tr_b16 v[22:23], v245 offset:33280
    v_mfma_f32_32x32x16_bf16 v[80:95], v[32:35], a[212:215], v[80:95]
    ds_read_b64_tr_b16 v[24:25], v244 offset:34816
    ds_read_b64_tr_b16 v[26:27], v244 offset:35328
    v_mfma_f32_32x32x16_bf16 v[96:111], v[36:39], a[212:215], v[96:111]
    ds_read_b64_tr_b16 v[28:29], v245 offset:34816
    ds_read_b64_tr_b16 v[30:31], v245 offset:35328
    v_mfma_f32_32x32x16_bf16 v[48:63], v[40:43], a[216:219], v[48:63]
    v_mfma_f32_32x32x16_bf16 v[64:79], v[44:47], a[216:219], v[64:79]
    v_mfma_f32_32x32x16_bf16 v[80:95], v[40:43], a[220:223], v[80:95]
    v_mfma_f32_32x32x16_bf16 v[96:111], v[44:47], a[220:223], v[96:111]
    s_waitcnt vmcnt(13) lgkmcnt(0)
    v_mov_b32 v171, 0
    buffer_load_dword v172, v171, s[8:11], s101 offen sc1
    v_mfma_f32_32x32x16_bf16 v[48:63], v[16:19], a[224:227], v[48:63]
    ds_read_b64_tr_b16 v[32:33], v244 offset:36864
    ds_read_b64_tr_b16 v[34:35], v244 offset:37376
    v_mfma_f32_32x32x16_bf16 v[64:79], v[20:23], a[224:227], v[64:79]
    ds_read_b64_tr_b16 v[36:37], v245 offset:36864
    ds_read_b64_tr_b16 v[38:39], v245 offset:37376
    v_mfma_f32_32x32x16_bf16 v[80:95], v[16:19], a[228:231], v[80:95]
    ds_read_b64_tr_b16 v[40:41], v244 offset:38912
    ds_read_b64_tr_b16 v[42:43], v244 offset:39424
    v_mfma_f32_32x32x16_bf16 v[96:111], v[20:23], a[228:231], v[96:111]
    ds_read_b64_tr_b16 v[44:45], v245 offset:38912
    ds_read_b64_tr_b16 v[46:47], v245 offset:39424
    v_mfma_f32_32x32x16_bf16 v[48:63], v[24:27], a[232:235], v[48:63]
    v_mfma_f32_32x32x16_bf16 v[64:79], v[28:31], a[232:235], v[64:79]
    v_mfma_f32_32x32x16_bf16 v[80:95], v[24:27], a[236:239], v[80:95]
    v_mfma_f32_32x32x16_bf16 v[96:111], v[28:31], a[236:239], v[96:111]
    s_waitcnt vmcnt(10) lgkmcnt(0)
    v_mfma_f32_32x32x16_bf16 v[64:79], v[36:39], a[240:243], v[64:79]
    v_mfma_f32_32x32x16_bf16 v[64:79], v[44:47], a[248:251], v[64:79]
    v_mfma_f32_32x32x16_bf16 v[80:95], v[32:35], a[244:247], v[80:95]
    v_mfma_f32_32x32x16_bf16 v[80:95], v[40:43], a[252:255], v[80:95]
    v_mfma_f32_32x32x16_bf16 v[96:111], v[36:39], a[244:247], v[96:111]
    v_mfma_f32_32x32x16_bf16 v[96:111], v[44:47], a[252:255], v[96:111]
    s_nop 7
    ds_write_b128 v144, v[64:67] offset:0
    ds_write_b128 v144, v[68:71] offset:1024
    ds_write_b128 v144, v[72:75] offset:2048
    ds_write_b128 v144, v[76:79] offset:3072
    v_mfma_f32_32x32x16_bf16 v[48:63], v[32:35], a[240:243], v[48:63]
    v_mfma_f32_32x32x16_bf16 v[48:63], v[40:43], a[248:251], v[48:63]
    ds_write_b128 v144, v[80:83] offset:4096
    ds_write_b128 v144, v[84:87] offset:5120
    ds_write_b128 v144, v[88:91] offset:6144
    ds_write_b128 v144, v[92:95] offset:7168
    s_waitcnt vmcnt(0)
    v_cmp_ne_u32 vcc, s29, v172
    s_nop 1
    s_cbranch_vccnz slow_f6a
back_f6a:
    buffer_load_dwordx4 v[112:115], v5, s[8:11], s100 offen offset:0 sc1
    buffer_load_dwordx4 v[116:119], v5, s[8:11], s100 offen offset:1024 sc1
    ds_write_b128 v144, v[96:99] offset:32768
    ds_write_b128 v144, v[100:103] offset:33792
    ds_write_b128 v144, v[104:107] offset:34816
    ds_write_b128 v144, v[108:111] offset:35840
    s_add_u32 s74, s72, 2
    s_cmp_ge_u32 s74, 7
    s_cselect_b32 s6, 7, 0
    s_sub_u32 s74, s74, s6
    s_mul_i32 s74, s74, 524288
    s_add_u32 s74, s74, s71
    s_add_u32 m0, s67, 36864
    s_nop 0
    buffer_load_dwordx4 v154, s[44:47], s74 offen offset:0 lds
    buffer_load_dwordx4 v155, s[44:47], s74 offen offset:1024 lds
    buffer_load_dwordx4 v156, s[44:47], s74 offen offset:2048 lds
    buffer_load_dwordx4 v157, s[44:47], s74 offen offset:3072 lds
    s_add_u32 s74, s72, 3
    s_cmp_ge_u32 s74, 7
    s_cselect_b32 s6, 7, 0
    s_sub_u32 s74, s74, s6
    s_mul_i32 s74, s74, 524288
    s_add_u32 s74, s74, s71
    s_add_u32 m0, s67, 65536
    s_nop 0
    buffer_load_dwordx4 v154, s[44:47], s74 offen offset:0 lds
    buffer_load_dwordx4 v155, s[44:47], s74 offen offset:1024 lds
    buffer_load_dwordx4 v156, s[44:47], s74 offen offset:2048 lds
    buffer_load_dwordx4 v157, s[44:47], s74 offen offset:3072 lds
    s_waitcnt lgkmcnt(0)
    s_barrier
    ds_read_b128 v[64:67], v145 offset:0
    ds_read_b128 v[68:71], v145 offset:1024
    ds_read_b128 v[72:75], v145 offset:2048
    ds_read_b128 v[76:79], v145 offset:3072
    ds_read_b128 v[80:83], v146 offset:4096
    ds_read_b128 v[84:87], v146 offset:5120
    ds_read_b128 v[88:91], v146 offset:6144
    ds_read_b128 v[92:95], v146 offset:7168
    ds_read_b128 v[96:99], v147 offset:32768
    ds_read_b128 v[100:103], v147 offset:33792
    ds_read_b128 v[104:107], v147 offset:34816
    ds_read_b128 v[108:111], v147 offset:35840
    s_waitcnt lgkmcnt(8)
    v_pk_add_f32 v[48:49], v[48:49], v[64:65]
    v_pk_add_f32 v[50:51], v[50:51], v[66:67]
    v_pk_add_f32 v[52:53], v[52:53], v[68:69]
    v_pk_add_f32 v[54:55], v[54:55], v[70:71]
    v_pk_add_f32 v[56:57], v[56:57], v[72:73]
    v_pk_add_f32 v[58:59], v[58:59], v[74:75]
    v_pk_add_f32 v[60:61], v[60:61], v[76:77]
    v_pk_add_f32 v[62:63], v[62:63], v[78:79]
    s_waitcnt lgkmcnt(4)
    v_pk_add_f32 v[48:49], v[48:49], v[80:81]
    v_pk_add_f32 v[50:51], v[50:51], v[82:83]
    v_pk_add_f32 v[52:53], v[52:53], v[84:85]
    v_pk_add_f32 v[54:55], v[54:55], v[86:87]
    v_pk_add_f32 v[56:57], v[56:57], v[88:89]
    v_pk_add_f32 v[58:59], v[58:59], v[90:91]
    v_pk_add_f32 v[60:61], v[60:61], v[92:93]
    v_pk_add_f32 v[62:63], v[62:63], v[94:95]
    s_waitcnt lgkmcnt(0)
    v_pk_add_f32 v[48:49], v[48:49], v[96:97]
    v_pk_add_f32 v[50:51], v[50:51], v[98:99]
    v_pk_add_f32 v[52:53], v[52:53], v[100:101]
    v_pk_add_f32 v[54:55], v[54:55], v[102:103]
    v_pk_add_f32 v[56:57], v[56:57], v[104:105]
    v_pk_add_f32 v[58:59], v[58:59], v[106:107]
    v_pk_add_f32 v[60:61], v[60:61], v[108:109]
    v_pk_add_f32 v[62:63], v[62:63], v[110:111]
    s_waitcnt vmcnt(8)
    v_lshlrev_b32_e64 v120, 16, v112
    v_and_b32 v121, 0xffff0000, v112
    v_lshlrev_b32_e64 v122, 16, v113
    v_and_b32 v123, 0xffff0000, v113
    v_lshlrev_b32_e64 v124, 16, v114
    v_and_b32 v125, 0xffff0000, v114
    v_lshlrev_b32_e64 v126, 16, v115
    v_and_b32 v127, 0xffff0000, v115
    v_lshlrev_b32_e64 v128, 16, v116
    v_and_b32 v129, 0xffff0000, v116
    v_lshlrev_b32_e64 v130, 16, v117
    v_and_b32 v131, 0xffff0000, v117
    v_lshlrev_b32_e64 v132, 16, v118
    v_and_b32 v133, 0xffff0000, v118
    v_lshlrev_b32_e64 v134, 16, v119
    v_and_b32 v135, 0xffff0000, v119
    v_pk_add_f32 v[48:49], v[48:49], v[120:121]
    v_pk_add_f32 v[50:51], v[50:51], v[122:123]
    v_pk_add_f32 v[52:53], v[52:53], v[124:125]
    v_pk_add_f32 v[54:55], v[54:55], v[126:127]
    v_pk_add_f32 v[56:57], v[56:57], v[128:129]
    v_pk_add_f32 v[58:59], v[58:59], v[130:131]
    v_pk_add_f32 v[60:61], v[60:61], v[132:133]
    v_pk_add_f32 v[62:63], v[62:63], v[134:135]
    v_pk_mul_f32 v[64:65], v[48:49], v[48:49]
    v_pk_mul_f32 v[66:67], v[50:51], v[50:51]
    v_pk_mul_f32 v[68:69], v[52:53], v[52:53]
    v_pk_mul_f32 v[70:71], v[54:55], v[54:55]
    v_pk_fma_f32 v[64:65], v[64:65], v[150:151], v[148:149]
    v_pk_fma_f32 v[66:67], v[66:67], v[150:151], v[148:149]
    s_add_u32 s74, s72, 4
    s_cmp_ge_u32 s74, 7
    s_cselect_b32 s6, 7, 0
    s_sub_u32 s74, s74, s6
    s_mul_i32 s74, s74, 524288
    s_add_u32 s74, s74, s71
    s_add_u32 m0, s67, 69632
    s_nop 0
    buffer_load_dwordx4 v154, s[44:47], s74 offen offset:0 lds
    v_pk_fma_f32 v[68:69], v[68:69], v[150:151], v[148:149]
    v_pk_fma_f32 v[70:71], v[70:71], v[150:151], v[148:149]
    v_pk_mul_f32 v[64:65], v[64:65], v[48:49]
    v_pk_mul_f32 v[66:67], v[66:67], v[50:51]
    v_pk_mul_f32 v[68:69], v[68:69], v[52:53]
    v_pk_mul_f32 v[70:71], v[70:71], v[54:55]
    buffer_load_dwordx4 v155, s[44:47], s74 offen offset:1024 lds
    v_exp_f32 v64, v64
    v_exp_f32 v65, v65
    v_exp_f32 v66, v66
    v_exp_f32 v67, v67
    v_exp_f32 v68, v68
    v_exp_f32 v69, v69
    buffer_load_dwordx4 v156, s[44:47], s74 offen offset:2048 lds
    v_exp_f32 v70, v70
    v_exp_f32 v71, v71
    v_pk_add_f32 v[64:65], v[64:65], v[12:13]
    v_pk_add_f32 v[66:67], v[66:67], v[12:13]
    v_pk_add_f32 v[68:69], v[68:69], v[12:13]
    v_pk_add_f32 v[70:71], v[70:71], v[12:13]
    buffer_load_dwordx4 v157, s[44:47], s74 offen offset:3072 lds
    v_rcp_f32 v64, v64
    v_rcp_f32 v65, v65
    v_rcp_f32 v66, v66
    v_rcp_f32 v67, v67
    v_rcp_f32 v68, v68
    v_rcp_f32 v69, v69
    s_add_u32 s74, s72, 5
    s_cmp_ge_u32 s74, 7
    s_cselect_b32 s6, 7, 0
    s_sub_u32 s74, s74, s6
    s_mul_i32 s74, s74, 524288
    s_add_u32 s74, s74, s71
    s_add_u32 m0, s67, 98304
    s_nop 0
    buffer_load_dwordx4 v154, s[44:47], s74 offen offset:0 lds
    v_rcp_f32 v70, v70
    v_rcp_f32 v71, v71
    v_pk_mul_f32 v[64:65], v[64:65], v[48:49]
    v_pk_mul_f32 v[66:67], v[66:67], v[50:51]
    v_pk_mul_f32 v[68:69], v[68:69], v[52:53]
    v_pk_mul_f32 v[70:71], v[70:71], v[54:55]
    buffer_load_dwordx4 v155, s[44:47], s74 offen offset:1024 lds
    v_cvt_pk_bf16_f32 v112, v64, v65
    v_cvt_pk_bf16_f32 v113, v66, v67
    v_cvt_pk_bf16_f32 v114, v68, v69
    v_cvt_pk_bf16_f32 v115, v70, v71
    buffer_store_dwordx4 v[112:115], v14, s[8:11], s32 offen offset:0 sc1
    v_pk_mul_f32 v[72:73], v[56:57], v[56:57]
    v_pk_mul_f32 v[74:75], v[58:59], v[58:59]
    v_pk_mul_f32 v[76:77], v[60:61], v[60:61]
    v_pk_mul_f32 v[78:79], v[62:63], v[62:63]
    v_pk_fma_f32 v[72:73], v[72:73], v[150:151], v[148:149]
    v_pk_fma_f32 v[74:75], v[74:75], v[150:151], v[148:149]
    v_pk_fma_f32 v[76:77], v[76:77], v[150:151], v[148:149]
    v_pk_fma_f32 v[78:79], v[78:79], v[150:151], v[148:149]
    v_pk_mul_f32 v[72:73], v[72:73], v[56:57]
    v_pk_mul_f32 v[74:75], v[74:75], v[58:59]
    v_pk_mul_f32 v[76:77], v[76:77], v[60:61]
    v_pk_mul_f32 v[78:79], v[78:79], v[62:63]
    v_exp_f32 v72, v72
    v_exp_f32 v73, v73
    v_exp_f32 v74, v74
    v_exp_f32 v75, v75
    v_exp_f32 v76, v76
    v_exp_f32 v77, v77
    v_exp_f32 v78, v78
    v_exp_f32 v79, v79
    v_pk_add_f32 v[72:73], v[72:73], v[12:13]
    v_pk_add_f32 v[74:75], v[74:75], v[12:13]
    v_pk_add_f32 v[76:77], v[76:77], v[12:13]
    v_pk_add_f32 v[78:79], v[78:79], v[12:13]
    v_rcp_f32 v72, v72
    v_rcp_f32 v73, v73
    v_rcp_f32 v74, v74
    v_rcp_f32 v75, v75
    v_rcp_f32 v76, v76
    v_rcp_f32 v77, v77
    v_rcp_f32 v78, v78
    v_rcp_f32 v79, v79
    v_pk_mul_f32 v[72:73], v[72:73], v[56:57]
    v_pk_mul_f32 v[74:75], v[74:75], v[58:59]
    v_pk_mul_f32 v[76:77], v[76:77], v[60:61]
    v_pk_mul_f32 v[78:79], v[78:79], v[62:63]
    v_cvt_pk_bf16_f32 v116, v72, v73
    v_cvt_pk_bf16_f32 v117, v74, v75
    v_cvt_pk_bf16_f32 v118, v76, v77
    v_cvt_pk_bf16_f32 v119, v78, v79
    buffer_store_dwordx4 v[116:119], v14, s[8:11], s32 offen offset:1024 sc1
    v_bfe_u32 v171, v2, 1, 2
    v_and_b32_e64 v1, 1, v2
    v_lshl_add_u32 v1, v171, 3, v1
    s_lshl_b32 s5, s28, 1
    v_add_u32 v1, s5, v1
    v_lshlrev_b32 v1, 7, v1
    v_lshlrev_b32 v171, 8, v171
    s_lshr_b32 s5, s79, 1
    s_lshl_b32 s5, s5, 3
    s_lshr_b32 s6, s28, 1
    s_add_u32 s5, s5, s6
    s_lshl_b32 s5, s5, 7
    s_add_u32 s5, s5, 196608
    v_add_u32 v171, s5, v171
    v_and_b32 v172, 8, v2
    v_cmp_eq_u32 vcc, 0, v172
    s_nop 1
    v_cndmask_b32 v171, v171, v1, vcc
    s_mov_b32 s34, 10354688
    s_lshl_b32 s38, s79, 16
    s_lshl_b32 s5, s28, 12
    s_add_u32 s38, s38, s5
    s_add_u32 s38, s38, 4194304
    buffer_load_dword v172, v171, s[8:11], s34 offen sc1
    buffer_load_dwordx4 v156, s[44:47], s74 offen offset:2048 lds
    buffer_load_dwordx4 v157, s[44:47], s74 offen offset:3072 lds
    s_add_u32 s74, s72, 6
    s_cmp_ge_u32 s74, 7
    s_cselect_b32 s6, 7, 0
    s_sub_u32 s74, s74, s6
    s_mul_i32 s74, s74, 524288
    s_add_u32 s74, s74, s71
    s_add_u32 m0, s67, 102400
    s_nop 0
    buffer_load_dwordx4 v154, s[44:47], s74 offen offset:0 lds
    buffer_load_dwordx4 v155, s[44:47], s74 offen offset:1024 lds
    s_waitcnt vmcnt(5)
    buffer_store_dword v170, v169, s[8:11], s33 offen sc1
    s_waitcnt vmcnt(5)
    v_cmp_ne_u32 vcc, s29, v172
    s_nop 1
    s_cbranch_vccnz slow_f3
back_f3:
    s_lshr_b32 s36, s4, 2
    s_add_u32 s36, s36, s4
    s_add_u32 s36, s36, 0
    s_and_b32 s36, s36, 3
    s_lshl_b32 s36, s36, 14
    s_add_u32 s37, s36, s38
    s_add_u32 s36, s36, s73
    buffer_load_dwordx4 a[128:131], v152, s[8:11], s36 offen offset:0 sc1
    buffer_load_dwordx4 a[192:195], v160, s[8:11], s37 offen offset:0 sc1
    buffer_load_dwordx4 a[132:135], v153, s[8:11], s36 offen offset:0 sc1
    buffer_load_dwordx4 a[196:199], v161, s[8:11], s37 offen offset:0 sc1
    buffer_load_dwordx4 a[136:139], v152, s[8:11], s36 offen offset:2048 sc1
    buffer_load_dwordx4 a[200:203], v160, s[8:11], s37 offen offset:2048 sc1
    buffer_load_dwordx4 a[140:143], v153, s[8:11], s36 offen offset:2048 sc1
    buffer_load_dwordx4 a[204:207], v161, s[8:11], s37 offen offset:2048 sc1
    s_lshr_b32 s36, s4, 2
    s_add_u32 s36, s36, s4
    s_add_u32 s36, s36, 1
    s_and_b32 s36, s36, 3
    s_lshl_b32 s36, s36, 14
    s_add_u32 s37, s36, s38
    s_add_u32 s36, s36, s73
    buffer_load_dwordx4 a[144:147], v152, s[8:11], s36 offen offset:0 sc1
    buffer_load_dwordx4 a[208:211], v160, s[8:11], s37 offen offset:0 sc1
    buffer_load_dwordx4 a[148:151], v153, s[8:11], s36 offen offset:0 sc1
    buffer_load_dwordx4 a[212:215], v161, s[8:11], s37 offen offset:0 sc1
    buffer_load_dwordx4 a[152:155], v152, s[8:11], s36 offen offset:2048 sc1
    buffer_load_dwordx4 a[216:219], v160, s[8:11], s37 offen offset:2048 sc1
    buffer_load_dwordx4 a[156:159], v153, s[8:11], s36 offen offset:2048 sc1
    buffer_load_dwordx4 a[220:223], v161, s[8:11], s37 offen offset:2048 sc1
    s_lshr_b32 s36, s4, 2
    s_add_u32 s36, s36, s4
    s_add_u32 s36, s36, 2
    s_and_b32 s36, s36, 3
    s_lshl_b32 s36, s36, 14
    s_add_u32 s37, s36, s38
    s_add_u32 s36, s36, s73
    buffer_load_dwordx4 a[160:163], v152, s[8:11], s36 offen offset:0 sc1
    buffer_load_dwordx4 a[224:227], v160, s[8:11], s37 offen offset:0 sc1
    buffer_load_dwordx4 a[164:167], v153, s[8:11], s36 offen offset:0 sc1
    buffer_load_dwordx4 a[228:231], v161, s[8:11], s37 offen offset:0 sc1
    buffer_load_dwordx4 a[168:171], v152, s[8:11], s36 offen offset:2048 sc1
    buffer_load_dwordx4 a[232:235], v160, s[8:11], s37 offen offset:2048 sc1
    buffer_load_dwordx4 a[172:175], v153, s[8:11], s36 offen offset:2048 sc1
    buffer_load_dwordx4 a[236:239], v161, s[8:11], s37 offen offset:2048 sc1
    s_lshr_b32 s36, s4, 2
    s_add_u32 s36, s36, s4
    s_add_u32 s36, s36, 3
    s_and_b32 s36, s36, 3
    s_lshl_b32 s36, s36, 14
    s_add_u32 s37, s36, s38
    s_add_u32 s36, s36, s73
    buffer_load_dwordx4 a[176:179], v152, s[8:11], s36 offen offset:0 sc1
    buffer_load_dwordx4 a[240:243], v160, s[8:11], s37 offen offset:0 sc1
    buffer_load_dwordx4 a[180:183], v153, s[8:11], s36 offen offset:0 sc1
    buffer_load_dwordx4 a[244:247], v161, s[8:11], s37 offen offset:0 sc1
    buffer_load_dwordx4 a[184:187], v152, s[8:11], s36 offen offset:2048 sc1
    buffer_load_dwordx4 a[248:251], v160, s[8:11], s37 offen offset:2048 sc1
    buffer_load_dwordx4 a[188:191], v153, s[8:11], s36 offen offset:2048 sc1
    buffer_load_dwordx4 a[252:255], v161, s[8:11], s37 offen offset:2048 sc1
    v_lshlrev_b32_e64 v163, 2, v162
    v_xor_b32 v164, 128, v163
    v_lshlrev_b32 v165, 1, v162
    s_lshl_b32 s36, s79, 8
    s_add_u32 s36, s36, 10027008
    s_lshl_b32 s37, s79, 7
    buffer_load_dword v166, v163, s[8:11], s36 offen sc1
    buffer_load_dword v252, v164, s[8:11], s36 offen sc1
    buffer_load_ushort v168, v165, s[52:55], s37 offen
    buffer_load_dwordx4 v156, s[44:47], s74 offen offset:2048 lds
    buffer_load_dwordx4 v157, s[44:47], s74 offen offset:3072 lds
join:
    v_bfe_u32 v1, v2, 1, 3
    v_min_u32 v1, 6, v1
    v_lshlrev_b32 v171, 10, v1
    v_and_b32 v1, 1, v2
    v_lshl_add_u32 v171, v1, 8, v171
    v_bfe_u32 v1, v2, 4, 1
    v_lshl_add_u32 v171, v1, 14, v171
    s_lshr_b32 s34, s76, 1
    s_lshl_b32 s34, s34, 15
    s_mul_i32 s5, s78, 7168
    s_add_u32 s34, s34, s5
    s_lshr_b32 s5, s28, 1
    s_lshl_b32 s5, s5, 9
    s_add_u32 s34, s34, s5
    s_and_b32 s5, s28, 1
    s_lshl_b32 s5, s5, 7
    s_add_u32 s34, s34, s5
    s_add_u32 s34, s34, 10387456
    buffer_load_dword v172, v171, s[8:11], s34 offen sc1
    v_add_u32 v144, s67, v5
    v_xor_b32 v145, 8192, v144
    v_xor_b32 v146, 16384, v144
    v_xor_b32 v147, 24576, v144
    v_add_u32 v248, 0x20000, v144
    v_add_u32 v249, 0x20000, v145
    v_add_u32 v250, 0x20000, v146
    v_lshlrev_b32_e64 v14, 10, v162
    v_lshl_add_u32 v14, v174, 5, v14
    s_lshl_b32 s32, s79, 16
    s_lshl_b32 s6, s76, 7
    s_add_u32 s32, s32, s6
    s_lshr_b32 s6, s28, 1
    s_lshl_b32 s6, s6, 6
    s_add_u32 s32, s32, s6
    s_waitcnt vmcnt(30)
    v_mfma_f32_32x32x16_bf16 v[176:191], a[128:131], a[192:195], 0
    v_mfma_f32_32x32x16_bf16 v[192:207], a[128:131], a[196:199], 0
    v_mfma_f32_32x32x16_bf16 v[208:223], a[132:135], a[192:195], 0
    v_mfma_f32_32x32x16_bf16 v[224:239], a[132:135], a[196:199], 0
    v_mfma_f32_32x32x16_bf16 v[176:191], a[136:139], a[200:203], v[176:191]
    v_mfma_f32_32x32x16_bf16 v[192:207], a[136:139], a[204:207], v[192:207]
    v_mfma_f32_32x32x16_bf16 v[208:223], a[140:143], a[200:203], v[208:223]
    v_mfma_f32_32x32x16_bf16 v[224:239], a[140:143], a[204:207], v[224:239]
    s_waitcnt vmcnt(22)
    v_mfma_f32_32x32x16_bf16 v[176:191], a[144:147], a[208:211], v[176:191]
    v_mfma_f32_32x32x16_bf16 v[192:207], a[144:147], a[212:215], v[192:207]
    v_mfma_f32_32x32x16_bf16 v[208:223], a[148:151], a[208:211], v[208:223]
    v_mfma_f32_32x32x16_bf16 v[224:239], a[148:151], a[212:215], v[224:239]
    v_mfma_f32_32x32x16_bf16 v[176:191], a[152:155], a[216:219], v[176:191]
    v_mfma_f32_32x32x16_bf16 v[192:207], a[152:155], a[220:223], v[192:207]
    v_mfma_f32_32x32x16_bf16 v[208:223], a[156:159], a[216:219], v[208:223]
    v_mfma_f32_32x32x16_bf16 v[224:239], a[156:159], a[220:223], v[224:239]
    s_waitcnt vmcnt(14)
    v_mfma_f32_32x32x16_bf16 v[176:191], a[160:163], a[224:227], v[176:191]
    v_mfma_f32_32x32x16_bf16 v[192:207], a[160:163], a[228:231], v[192:207]
    v_mfma_f32_32x32x16_bf16 v[208:223], a[164:167], a[224:227], v[208:223]
    v_mfma_f32_32x32x16_bf16 v[224:239], a[164:167], a[228:231], v[224:239]
    v_mfma_f32_32x32x16_bf16 v[176:191], a[168:171], a[232:235], v[176:191]
    v_mfma_f32_32x32x16_bf16 v[192:207], a[168:171], a[236:239], v[192:207]
    v_mfma_f32_32x32x16_bf16 v[208:223], a[172:175], a[232:235], v[208:223]
    v_mfma_f32_32x32x16_bf16 v[224:239], a[172:175], a[236:239], v[224:239]
    s_waitcnt vmcnt(0)
    v_cmp_ne_u32 vcc, s29, v172
    s_nop 1
    s_cbranch_vccnz slow_f4
back_f4:
    s_add_u32 s75, s72, 0
    s_cmp_ge_u32 s75, 7
    s_cselect_b32 s6, 7, 0
    s_sub_u32 s75, s75, s6
    s_lshl_b32 s75, s75, 14
    s_add_u32 s75, s75, s70
    buffer_load_dwordx4 a[0:3], v152, s[8:11], s75 offen offset:0 sc1
    v_mfma_f32_32x32x16_bf16 v[176:191], a[176:179], a[240:243], v[176:191]
    buffer_load_dwordx4 a[4:7], v153, s[8:11], s75 offen offset:0 sc1
    v_mfma_f32_32x32x16_bf16 v[192:207], a[176:179], a[244:247], v[192:207]
    buffer_load_dwordx4 a[8:11], v152, s[8:11], s75 offen offset:2048 sc1
    v_mfma_f32_32x32x16_bf16 v[208:223], a[180:183], a[240:243], v[208:223]
    buffer_load_dwordx4 a[12:15], v153, s[8:11], s75 offen offset:2048 sc1
    v_mfma_f32_32x32x16_bf16 v[224:239], a[180:183], a[244:247], v[224:239]
    s_add_u32 s75, s72, 1
    s_cmp_ge_u32 s75, 7
    s_cselect_b32 s6, 7, 0
    s_sub_u32 s75, s75, s6
    s_lshl_b32 s75, s75, 14
    s_add_u32 s75, s75, s70
    buffer_load_dwordx4 a[16:19], v152, s[8:11], s75 offen offset:0 sc1
    v_mfma_f32_32x32x16_bf16 v[176:191], a[184:187], a[248:251], v[176:191]
    buffer_load_dwordx4 a[20:23], v153, s[8:11], s75 offen offset:0 sc1
    v_mfma_f32_32x32x16_bf16 v[192:207], a[184:187], a[252:255], v[192:207]
    buffer_load_dwordx4 a[24:27], v152, s[8:11], s75 offen offset:2048 sc1
    v_mfma_f32_32x32x16_bf16 v[208:223], a[188:191], a[248:251], v[208:223]
    buffer_load_dwordx4 a[28:31], v153, s[8:11], s75 offen offset:2048 sc1
    v_mfma_f32_32x32x16_bf16 v[224:239], a[188:191], a[252:255], v[224:239]
    s_add_u32 s75, s72, 2
    s_cmp_ge_u32 s75, 7
    s_cselect_b32 s6, 7, 0
    s_sub_u32 s75, s75, s6
    s_lshl_b32 s75, s75, 14
    s_add_u32 s75, s75, s70
    buffer_load_dwordx4 a[32:35], v152, s[8:11], s75 offen offset:0 sc1
    v_sub_f32 v166, 1.0, v166
    buffer_load_dwordx4 a[36:39], v153, s[8:11], s75 offen offset:0 sc1
    v_sub_f32_e64 v252, 1.0, v252
    buffer_load_dwordx4 a[40:43], v152, s[8:11], s75 offen offset:2048 sc1
    v_lshlrev_b32_e64 v168, 16, v168
    buffer_load_dwordx4 a[44:47], v153, s[8:11], s75 offen offset:2048 sc1
    v_mov_b32_e64 v167, v166
    ds_read_b64_tr_b16 v[16:17], v246 offset:28672
    ds_read_b64_tr_b16 v[18:19], v246 offset:29184
    ds_read_b64_tr_b16 v[20:21], v247 offset:28672
    ds_read_b64_tr_b16 v[22:23], v247 offset:29184
    ds_read_b64_tr_b16 v[24:25], v246 offset:30720
    ds_read_b64_tr_b16 v[26:27], v246 offset:31232
    ds_read_b64_tr_b16 v[28:29], v247 offset:30720
    ds_read_b64_tr_b16 v[30:31], v247 offset:31232
    s_waitcnt vmcnt(8) lgkmcnt(0)
    v_mfma_f32_32x32x16_bf16 a[64:79], a[0:3], v[16:19], 0
    ds_read_b64_tr_b16 v[32:33], v246 offset:32768
    ds_read_b64_tr_b16 v[34:35], v246 offset:33280
    s_add_u32 s75, s72, 3
    s_cmp_ge_u32 s75, 7
    s_cselect_b32 s6, 7, 0
    s_sub_u32 s75, s75, s6
    s_lshl_b32 s75, s75, 14
    s_add_u32 s75, s75, s70
    buffer_load_dwordx4 a[48:51], v152, s[8:11], s75 offen offset:0 sc1
    v_mov_b32 v253, v252
    v_mul_f32_e64 v168, v168, v166
    v_mfma_f32_32x32x16_bf16 a[80:95], a[0:3], v[20:23], 0
    ds_read_b64_tr_b16 v[36:37], v247 offset:32768
    ds_read_b64_tr_b16 v[38:39], v247 offset:33280
    buffer_load_dwordx4 a[52:55], v153, s[8:11], s75 offen offset:0 sc1
    v_add_f32 v176, v176, v168
    v_add_f32 v177, v177, v168
    v_mfma_f32_32x32x16_bf16 a[96:111], a[4:7], v[16:19], 0
    ds_read_b64_tr_b16 v[40:41], v246 offset:34816
    ds_read_b64_tr_b16 v[42:43], v246 offset:35328
    buffer_load_dwordx4 a[56:59], v152, s[8:11], s75 offen offset:2048 sc1
    v_add_f32 v178, v178, v168
    v_add_f32 v179, v179, v168
    v_mfma_f32_32x32x16_bf16 a[112:127], a[4:7], v[20:23], 0
    ds_read_b64_tr_b16 v[44:45], v247 offset:34816
    ds_read_b64_tr_b16 v[46:47], v247 offset:35328
    buffer_load_dwordx4 a[60:63], v153, s[8:11], s75 offen offset:2048 sc1
    v_add_f32 v180, v180, v168
    v_add_f32 v181, v181, v168
    v_mfma_f32_32x32x16_bf16 a[64:79], a[8:11], v[24:27], a[64:79]
    v_add_f32 v182, v182, v168
    v_add_f32 v183, v183, v168
    v_mfma_f32_32x32x16_bf16 a[80:95], a[8:11], v[28:31], a[80:95]
    v_add_f32 v184, v184, v168
    v_add_f32 v185, v185, v168
    v_mfma_f32_32x32x16_bf16 a[96:111], a[12:15], v[24:27], a[96:111]
    v_add_f32 v186, v186, v168
    v_add_f32 v187, v187, v168
    v_mfma_f32_32x32x16_bf16 a[112:127], a[12:15], v[28:31], a[112:127]
    v_add_f32 v188, v188, v168
    v_add_f32 v189, v189, v168
    s_waitcnt vmcnt(8) lgkmcnt(0)
    s_barrier
    v_mfma_f32_32x32x16_bf16 a[64:79], a[16:19], v[32:35], a[64:79]
    ds_read_b64_tr_b16 v[16:17], v158 offset:0
    ds_read_b64_tr_b16 v[18:19], v158 offset:512
    s_add_u32 s75, s72, 4
    s_cmp_ge_u32 s75, 7
    s_cselect_b32 s6, 7, 0
    s_sub_u32 s75, s75, s6
    s_lshl_b32 s75, s75, 14
    s_add_u32 s75, s75, s70
    buffer_load_dwordx4 a[0:3], v152, s[8:11], s75 offen offset:0 sc1
    v_add_f32 v190, v190, v168
    v_add_f32 v191, v191, v168
    v_mfma_f32_32x32x16_bf16 a[80:95], a[16:19], v[36:39], a[80:95]
    ds_read_b64_tr_b16 v[20:21], v159 offset:0
    ds_read_b64_tr_b16 v[22:23], v159 offset:512
    buffer_load_dwordx4 a[4:7], v153, s[8:11], s75 offen offset:0 sc1
    v_mfma_f32_32x32x16_bf16 a[96:111], a[20:23], v[32:35], a[96:111]
    ds_read_b64_tr_b16 v[24:25], v158 offset:2048
    ds_read_b64_tr_b16 v[26:27], v158 offset:2560
    buffer_load_dwordx4 a[8:11], v152, s[8:11], s75 offen offset:2048 sc1
    v_mfma_f32_32x32x16_bf16 a[112:127], a[20:23], v[36:39], a[112:127]
    ds_read_b64_tr_b16 v[28:29], v159 offset:2048
    ds_read_b64_tr_b16 v[30:31], v159 offset:2560
    buffer_load_dwordx4 a[12:15], v153, s[8:11], s75 offen offset:2048 sc1
    v_mfma_f32_32x32x16_bf16 a[64:79], a[24:27], v[40:43], a[64:79]
    v_mfma_f32_32x32x16_bf16 a[80:95], a[24:27], v[44:47], a[80:95]
    v_mfma_f32_32x32x16_bf16 a[96:111], a[28:31], v[40:43], a[96:111]
    v_mfma_f32_32x32x16_bf16 a[112:127], a[28:31], v[44:47], a[112:127]
    s_waitcnt vmcnt(8) lgkmcnt(0)
    v_mfma_f32_32x32x16_bf16 a[64:79], a[32:35], v[16:19], a[64:79]
    ds_read_b64_tr_b16 v[32:33], v158 offset:28672
    ds_read_b64_tr_b16 v[34:35], v158 offset:29184
    s_add_u32 s75, s72, 5
    s_cmp_ge_u32 s75, 7
    s_cselect_b32 s6, 7, 0
    s_sub_u32 s75, s75, s6
    s_lshl_b32 s75, s75, 14
    s_add_u32 s75, s75, s70
    buffer_load_dwordx4 a[16:19], v152, s[8:11], s75 offen offset:0 sc1
    v_mfma_f32_32x32x16_bf16 a[80:95], a[32:35], v[20:23], a[80:95]
    ds_read_b64_tr_b16 v[36:37], v159 offset:28672
    ds_read_b64_tr_b16 v[38:39], v159 offset:29184
    buffer_load_dwordx4 a[20:23], v153, s[8:11], s75 offen offset:0 sc1
    v_mfma_f32_32x32x16_bf16 a[96:111], a[36:39], v[16:19], a[96:111]
    ds_read_b64_tr_b16 v[40:41], v158 offset:30720
    ds_read_b64_tr_b16 v[42:43], v158 offset:31232
    buffer_load_dwordx4 a[24:27], v152, s[8:11], s75 offen offset:2048 sc1
    v_mfma_f32_32x32x16_bf16 a[112:127], a[36:39], v[20:23], a[112:127]
    ds_read_b64_tr_b16 v[44:45], v159 offset:30720
    ds_read_b64_tr_b16 v[46:47], v159 offset:31232
    buffer_load_dwordx4 a[28:31], v153, s[8:11], s75 offen offset:2048 sc1
    v_mfma_f32_32x32x16_bf16 a[64:79], a[40:43], v[24:27], a[64:79]
    v_mfma_f32_32x32x16_bf16 a[80:95], a[40:43], v[28:31], a[80:95]
    v_mfma_f32_32x32x16_bf16 a[96:111], a[44:47], v[24:27], a[96:111]
    v_mfma_f32_32x32x16_bf16 a[112:127], a[44:47], v[28:31], a[112:127]
    s_waitcnt vmcnt(8) lgkmcnt(0)
    v_mfma_f32_32x32x16_bf16 a[64:79], a[48:51], v[32:35], a[64:79]
    ds_read_b64_tr_b16 v[16:17], v158 offset:32768
    ds_read_b64_tr_b16 v[18:19], v158 offset:33280
    s_add_u32 s75, s72, 6
    s_cmp_ge_u32 s75, 7
    s_cselect_b32 s6, 7, 0
    s_sub_u32 s75, s75, s6
    s_lshl_b32 s75, s75, 14
    s_add_u32 s75, s75, s70
    buffer_load_dwordx4 a[32:35], v152, s[8:11], s75 offen offset:0 sc1
    v_mfma_f32_32x32x16_bf16 a[80:95], a[48:51], v[36:39], a[80:95]
    ds_read_b64_tr_b16 v[20:21], v159 offset:32768
    ds_read_b64_tr_b16 v[22:23], v159 offset:33280
    buffer_load_dwordx4 a[36:39], v153, s[8:11], s75 offen offset:0 sc1
    v_mfma_f32_32x32x16_bf16 a[96:111], a[52:55], v[32:35], a[96:111]
    ds_read_b64_tr_b16 v[24:25], v158 offset:34816
    ds_read_b64_tr_b16 v[26:27], v158 offset:35328
    buffer_load_dwordx4 a[40:43], v152, s[8:11], s75 offen offset:2048 sc1
    v_mfma_f32_32x32x16_bf16 a[112:127], a[52:55], v[36:39], a[112:127]
    ds_read_b64_tr_b16 v[28:29], v159 offset:34816
    ds_read_b64_tr_b16 v[30:31], v159 offset:35328
    buffer_load_dwordx4 a[44:47], v153, s[8:11], s75 offen offset:2048 sc1
    v_mfma_f32_32x32x16_bf16 a[64:79], a[56:59], v[40:43], a[64:79]
    v_mfma_f32_32x32x16_bf16 a[80:95], a[56:59], v[44:47], a[80:95]
    v_mfma_f32_32x32x16_bf16 a[96:111], a[60:63], v[40:43], a[96:111]
    v_mfma_f32_32x32x16_bf16 a[112:127], a[60:63], v[44:47], a[112:127]
    s_waitcnt vmcnt(8) lgkmcnt(0)
    v_mfma_f32_32x32x16_bf16 a[64:79], a[0:3], v[16:19], a[64:79]
    ds_read_b64_tr_b16 v[32:33], v158 offset:61440
    ds_read_b64_tr_b16 v[34:35], v158 offset:61952
    s_add_u32 s75, s72, 0
    s_cmp_ge_u32 s75, 7
    s_cselect_b32 s6, 7, 0
    s_sub_u32 s75, s75, s6
    s_lshl_b32 s75, s75, 14
    s_add_u32 s75, s75, s81
    buffer_load_dwordx4 a[128:131], v152, s[8:11], s75 offen offset:0 sc1
    v_mfma_f32_32x32x16_bf16 a[80:95], a[0:3], v[20:23], a[80:95]
    ds_read_b64_tr_b16 v[36:37], v159 offset:61440
    ds_read_b64_tr_b16 v[38:39], v159 offset:61952
    buffer_load_dwordx4 a[132:135], v153, s[8:11], s75 offen offset:0 sc1
    v_mfma_f32_32x32x16_bf16 a[96:111], a[4:7], v[16:19], a[96:111]
    ds_read_b64_tr_b16 v[40:41], v158 offset:63488
    ds_read_b64_tr_b16 v[42:43], v158 offset:64000
    buffer_load_dwordx4 a[136:139], v152, s[8:11], s75 offen offset:2048 sc1
    v_mfma_f32_32x32x16_bf16 a[112:127], a[4:7], v[20:23], a[112:127]
    ds_read_b64_tr_b16 v[44:45], v159 offset:63488
    ds_read_b64_tr_b16 v[46:47], v159 offset:64000
    buffer_load_dwordx4 a[140:143], v153, s[8:11], s75 offen offset:2048 sc1
    v_mfma_f32_32x32x16_bf16 a[64:79], a[8:11], v[24:27], a[64:79]
    v_mfma_f32_32x32x16_bf16 a[80:95], a[8:11], v[28:31], a[80:95]
    v_mfma_f32_32x32x16_bf16 a[96:111], a[12:15], v[24:27], a[96:111]
    v_mfma_f32_32x32x16_bf16 a[112:127], a[12:15], v[28:31], a[112:127]
    s_waitcnt vmcnt(8) lgkmcnt(0)
    v_mfma_f32_32x32x16_bf16 a[64:79], a[16:19], v[32:35], a[64:79]
    ds_read_b64_tr_b16 v[16:17], v246 offset:0
    ds_read_b64_tr_b16 v[18:19], v246 offset:512
    s_add_u32 s75, s72, 1
    s_cmp_ge_u32 s75, 7
    s_cselect_b32 s6, 7, 0
    s_sub_u32 s75, s75, s6
    s_lshl_b32 s75, s75, 14
    s_add_u32 s75, s75, s81
    buffer_load_dwordx4 a[144:147], v152, s[8:11], s75 offen offset:0 sc1
    v_mfma_f32_32x32x16_bf16 a[80:95], a[16:19], v[36:39], a[80:95]
    ds_read_b64_tr_b16 v[20:21], v247 offset:0
    ds_read_b64_tr_b16 v[22:23], v247 offset:512
    buffer_load_dwordx4 a[148:151], v153, s[8:11], s75 offen offset:0 sc1
    v_mfma_f32_32x32x16_bf16 a[96:111], a[20:23], v[32:35], a[96:111]
    ds_read_b64_tr_b16 v[24:25], v246 offset:2048
    ds_read_b64_tr_b16 v[26:27], v246 offset:2560
    buffer_load_dwordx4 a[152:155], v152, s[8:11], s75 offen offset:2048 sc1
    v_mfma_f32_32x32x16_bf16 a[112:127], a[20:23], v[36:39], a[112:127]
    ds_read_b64_tr_b16 v[28:29], v247 offset:2048
    ds_read_b64_tr_b16 v[30:31], v247 offset:2560
    buffer_load_dwordx4 a[156:159], v153, s[8:11], s75 offen offset:2048 sc1
    v_mfma_f32_32x32x16_bf16 a[64:79], a[24:27], v[40:43], a[64:79]
    v_mfma_f32_32x32x16_bf16 a[80:95], a[24:27], v[44:47], a[80:95]
    v_mfma_f32_32x32x16_bf16 a[96:111], a[28:31], v[40:43], a[96:111]
    v_mfma_f32_32x32x16_bf16 a[112:127], a[28:31], v[44:47], a[112:127]
    s_waitcnt vmcnt(8) lgkmcnt(0)
    s_lshl_b32 s99, s2, 2
    s_add_u32 s99, s99, s28
    s_lshl_b32 s98, s99, 12
    s_add_u32 s98, s98, 20971520
    s_lshl_b32 s99, s99, 7
    s_add_u32 s99, s99, 10878976
    s_xor_b32 s100, s98, 0x4000
    s_xor_b32 s101, s99, 0x200
    v_mfma_f32_32x32x16_bf16 a[80:95], a[32:35], v[20:23], a[80:95]
    ds_read_b64_tr_b16 v[32:33], v246 offset:28672
    ds_read_b64_tr_b16 v[34:35], v246 offset:29184
    s_add_u32 s75, s72, 2
    s_cmp_ge_u32 s75, 7
    s_cselect_b32 s6, 7, 0
    s_sub_u32 s75, s75, s6
    s_lshl_b32 s75, s75, 14
    s_add_u32 s75, s75, s81
    buffer_load_dwordx4 a[160:163], v152, s[8:11], s75 offen offset:0 sc1
    v_mfma_f32_32x32x16_bf16 a[80:95], a[40:43], v[28:31], a[80:95]
    ds_read_b64_tr_b16 v[36:37], v247 offset:28672
    ds_read_b64_tr_b16 v[38:39], v247 offset:29184
    buffer_load_dwordx4 a[164:167], v153, s[8:11], s75 offen offset:0 sc1
    v_mfma_f32_32x32x16_bf16 a[96:111], a[36:39], v[16:19], a[96:111]
    ds_read_b64_tr_b16 v[40:41], v246 offset:30720
    ds_read_b64_tr_b16 v[42:43], v246 offset:31232
    buffer_load_dwordx4 a[168:171], v152, s[8:11], s75 offen offset:2048 sc1
    v_mfma_f32_32x32x16_bf16 a[96:111], a[44:47], v[24:27], a[96:111]
    ds_read_b64_tr_b16 v[44:45], v247 offset:30720
    ds_read_b64_tr_b16 v[46:47], v247 offset:31232
    buffer_load_dwordx4 a[172:175], v153, s[8:11], s75 offen offset:2048 sc1
    v_mfma_f32_32x32x16_bf16 a[112:127], a[36:39], v[20:23], a[112:127]
    s_add_u32 s75, s72, 3
    s_cmp_ge_u32 s75, 7
    s_cselect_b32 s6, 7, 0
    s_sub_u32 s75, s75, s6
    s_lshl_b32 s75, s75, 14
    s_add_u32 s75, s75, s81
    buffer_load_dwordx4 a[176:179], v152, s[8:11], s75 offen offset:0 sc1
    v_mfma_f32_32x32x16_bf16 a[112:127], a[44:47], v[28:31], a[112:127]
    buffer_load_dwordx4 a[180:183], v153, s[8:11], s75 offen offset:0 sc1
    ds_write_b128 v144, a[80:83] offset:0
    ds_write_b128 v144, a[84:87] offset:1024
    ds_write_b128 v144, a[88:91] offset:2048
    ds_write_b128 v144, a[92:95] offset:3072
    v_mfma_f32_32x32x16_bf16 a[64:79], a[32:35], v[16:19], a[64:79]
    buffer_load_dwordx4 a[184:187], v152, s[8:11], s75 offen offset:2048 sc1
    v_mfma_f32_32x32x16_bf16 a[64:79], a[40:43], v[24:27], a[64:79]
    buffer_load_dwordx4 a[188:191], v153, s[8:11], s75 offen offset:2048 sc1
    ds_write_b128 v144, a[96:99] offset:4096
    ds_write_b128 v144, a[100:103] offset:5120
    ds_write_b128 v144, a[104:107] offset:6144
    s_waitcnt lgkmcnt(14)
    ds_write_b128 v144, a[108:111] offset:7168
    s_waitcnt vmcnt(12) lgkmcnt(8)
    ds_write_b128 v144, a[112:115] offset:32768
    ds_write_b128 v144, a[116:119] offset:33792
    ds_write_b128 v144, a[120:123] offset:34816
    ds_write_b128 v144, a[124:127] offset:35840
    s_add_u32 s75, s72, 4
    s_cmp_ge_u32 s75, 7
    s_cselect_b32 s6, 7, 0
    s_sub_u32 s75, s75, s6
    s_lshl_b32 s75, s75, 14
    s_add_u32 s75, s75, s81
    buffer_load_dwordx4 a[192:195], v152, s[8:11], s75 offen offset:0 sc1
    buffer_load_dwordx4 a[196:199], v153, s[8:11], s75 offen offset:0 sc1
    buffer_load_dwordx4 a[200:203], v152, s[8:11], s75 offen offset:2048 sc1
    buffer_load_dwordx4 a[204:207], v153, s[8:11], s75 offen offset:2048 sc1
    s_add_u32 s75, s72, 5
    s_cmp_ge_u32 s75, 7
    s_cselect_b32 s6, 7, 0
    s_sub_u32 s75, s75, s6
    s_lshl_b32 s75, s75, 14
    s_add_u32 s75, s75, s81
    buffer_load_dwordx4 a[208:211], v152, s[8:11], s75 offen offset:0 sc1
    buffer_load_dwordx4 a[212:215], v153, s[8:11], s75 offen offset:0 sc1
    buffer_load_dwordx4 a[216:219], v152, s[8:11], s75 offen offset:2048 sc1
    buffer_load_dwordx4 a[220:223], v153, s[8:11], s75 offen offset:2048 sc1
    s_waitcnt lgkmcnt(0)
    s_barrier
    ds_read_b128 v[64:67], v145 offset:0
    ds_read_b128 v[68:71], v145 offset:1024
    ds_read_b128 v[72:75], v145 offset:2048
    ds_read_b128 v[76:79], v145 offset:3072
    ds_read_b128 v[80:83], v146 offset:4096
    ds_read_b128 v[84:87], v146 offset:5120
    ds_read_b128 v[88:91], v146 offset:6144
    ds_read_b128 v[92:95], v146 offset:7168
    ds_read_b128 v[96:99], v147 offset:32768
    ds_read_b128 v[100:103], v147 offset:33792
    ds_read_b128 v[104:107], v147 offset:34816
    ds_read_b128 v[108:111], v147 offset:35840
    v_accvgpr_read_b32 v120, a64
    v_accvgpr_read_b32 v121, a65
    v_accvgpr_read_b32 v122, a66
    v_accvgpr_read_b32 v123, a67
    v_accvgpr_read_b32 v124, a68
    v_accvgpr_read_b32 v125, a69
    v_accvgpr_read_b32 v126, a70
    v_accvgpr_read_b32 v127, a71
    v_accvgpr_read_b32 v128, a72
    v_accvgpr_read_b32 v129, a73
    v_accvgpr_read_b32 v130, a74
    v_accvgpr_read_b32 v131, a75
    v_accvgpr_read_b32 v132, a76
    v_accvgpr_read_b32 v133, a77
    v_accvgpr_read_b32 v134, a78
    v_accvgpr_read_b32 v135, a79
    s_waitcnt lgkmcnt(8)
    v_pk_add_f32 v[120:121], v[120:121], v[64:65]
    v_pk_add_f32 v[122:123], v[122:123], v[66:67]
    v_pk_add_f32 v[124:125], v[124:125], v[68:69]
    v_pk_add_f32 v[126:127], v[126:127], v[70:71]
    v_pk_add_f32 v[128:129], v[128:129], v[72:73]
    v_pk_add_f32 v[130:131], v[130:131], v[74:75]
    v_pk_add_f32 v[132:133], v[132:133], v[76:77]
    v_pk_add_f32 v[134:135], v[134:135], v[78:79]
    s_waitcnt lgkmcnt(4)
    v_pk_add_f32 v[120:121], v[120:121], v[80:81]
    v_pk_add_f32 v[122:123], v[122:123], v[82:83]
    v_pk_add_f32 v[124:125], v[124:125], v[84:85]
    v_pk_add_f32 v[126:127], v[126:127], v[86:87]
    v_pk_add_f32 v[128:129], v[128:129], v[88:89]
    v_pk_add_f32 v[130:131], v[130:131], v[90:91]
    v_pk_add_f32 v[132:133], v[132:133], v[92:93]
    v_pk_add_f32 v[134:135], v[134:135], v[94:95]
    s_waitcnt lgkmcnt(0)
    v_pk_add_f32 v[120:121], v[120:121], v[96:97]
    v_pk_add_f32 v[122:123], v[122:123], v[98:99]
    v_pk_add_f32 v[124:125], v[124:125], v[100:101]
    v_pk_add_f32 v[126:127], v[126:127], v[102:103]
    v_pk_add_f32 v[128:129], v[128:129], v[104:105]
    v_pk_add_f32 v[130:131], v[130:131], v[106:107]
    v_pk_add_f32 v[132:133], v[132:133], v[108:109]
    v_pk_add_f32 v[134:135], v[134:135], v[110:111]
    v_cvt_pk_bf16_f32 v120, v120, v121
    v_cvt_pk_bf16_f32 v121, v122, v123
    v_cvt_pk_bf16_f32 v122, v124, v125
    v_cvt_pk_bf16_f32 v123, v126, v127
    buffer_store_dwordx4 v[120:123], v5, s[8:11], s98 offen offset:0 sc1
    v_cvt_pk_bf16_f32 v124, v128, v129
    v_cvt_pk_bf16_f32 v125, v130, v131
    v_cvt_pk_bf16_f32 v126, v132, v133
    v_cvt_pk_bf16_f32 v127, v134, v135
    buffer_store_dwordx4 v[124:127], v5, s[8:11], s98 offen offset:1024 sc1
    v_mfma_f32_32x32x16_bf16 v[48:63], a[128:131], v[32:35], 0
    ds_read_b64_tr_b16 v[16:17], v246 offset:32768
    ds_read_b64_tr_b16 v[18:19], v246 offset:33280
    s_add_u32 s75, s72, 6
    s_cmp_ge_u32 s75, 7
    s_cselect_b32 s6, 7, 0
    s_sub_u32 s75, s75, s6
    s_lshl_b32 s75, s75, 14
    s_add_u32 s75, s75, s81
    buffer_load_dwordx4 a[224:227], v152, s[8:11], s75 offen offset:0 sc1
    v_mfma_f32_32x32x16_bf16 v[64:79], a[128:131], v[36:39], 0
    ds_read_b64_tr_b16 v[20:21], v247 offset:32768
    ds_read_b64_tr_b16 v[22:23], v247 offset:33280
    buffer_load_dwordx4 a[228:231], v153, s[8:11], s75 offen offset:0 sc1
    v_mfma_f32_32x32x16_bf16 v[80:95], a[132:135], v[32:35], 0
    ds_read_b64_tr_b16 v[24:25], v246 offset:34816
    ds_read_b64_tr_b16 v[26:27], v246 offset:35328
    buffer_load_dwordx4 a[232:235], v152, s[8:11], s75 offen offset:2048 sc1
    v_mfma_f32_32x32x16_bf16 v[96:111], a[132:135], v[36:39], 0
    ds_read_b64_tr_b16 v[28:29], v247 offset:34816
    ds_read_b64_tr_b16 v[30:31], v247 offset:35328
    buffer_load_dwordx4 a[236:239], v153, s[8:11], s75 offen offset:2048 sc1
    v_mfma_f32_32x32x16_bf16 v[48:63], a[136:139], v[40:43], v[48:63]
    v_mfma_f32_32x32x16_bf16 v[64:79], a[136:139], v[44:47], v[64:79]
    v_mfma_f32_32x32x16_bf16 v[80:95], a[140:143], v[40:43], v[80:95]
    v_mfma_f32_32x32x16_bf16 v[96:111], a[140:143], v[44:47], v[96:111]
    s_waitcnt vmcnt(22) lgkmcnt(0)
    v_mfma_f32_32x32x16_bf16 v[48:63], a[144:147], v[16:19], v[48:63]
    ds_read_b64_tr_b16 v[32:33], v158 offset:0
    ds_read_b64_tr_b16 v[34:35], v158 offset:512
    v_mfma_f32_32x32x16_bf16 v[64:79], a[144:147], v[20:23], v[64:79]
    ds_read_b64_tr_b16 v[36:37], v159 offset:0
    ds_read_b64_tr_b16 v[38:39], v159 offset:512
    v_mfma_f32_32x32x16_bf16 v[80:95], a[148:151], v[16:19], v[80:95]
    ds_read_b64_tr_b16 v[40:41], v158 offset:2048
    ds_read_b64_tr_b16 v[42:43], v158 offset:2560
    v_mfma_f32_32x32x16_bf16 v[96:111], a[148:151], v[20:23], v[96:111]
    ds_read_b64_tr_b16 v[44:45], v159 offset:2048
    ds_read_b64_tr_b16 v[46:47], v159 offset:2560
    v_mfma_f32_32x32x16_bf16 v[48:63], a[152:155], v[24:27], v[48:63]
    v_mfma_f32_32x32x16_bf16 v[64:79], a[152:155], v[28:31], v[64:79]
    v_mfma_f32_32x32x16_bf16 v[80:95], a[156:159], v[24:27], v[80:95]
    v_mfma_f32_32x32x16_bf16 v[96:111], a[156:159], v[28:31], v[96:111]
    s_waitcnt vmcnt(18) lgkmcnt(0)
    s_barrier
    v_mov_b32 v1, 2341
    v_mul_u32_u24 v1, v0, v1
    v_lshrrev_b32_e64 v1, 16, v1
    v_lshl_add_u32 v1, v1, 2, v0
    v_lshlrev_b32_e64 v1, 9, v1
    v_add_u32 v1, 10387456, v1
    v_lshlrev_b32_e64 v254, 7, v0
    v_add_u32 v254, 10326016, v254
    v_cmp_gt_u32 vcc, 224, v0
    s_nop 1
    v_cndmask_b32 v254, v254, v1, vcc
    s_cmp_eq_u32 s2, 224
    s_cselect_b32 s39, 0, 1073741824
    buffer_load_dword v255, v254, s[8:11], s39 offen sc1
    v_mfma_f32_32x32x16_bf16 v[48:63], a[160:163], v[32:35], v[48:63]
    ds_read_b64_tr_b16 v[16:17], v158 offset:28672
    ds_read_b64_tr_b16 v[18:19], v158 offset:29184
    v_mfma_f32_32x32x16_bf16 v[64:79], a[160:163], v[36:39], v[64:79]
    ds_read_b64_tr_b16 v[20:21], v159 offset:28672
    ds_read_b64_tr_b16 v[22:23], v159 offset:29184
    v_mfma_f32_32x32x16_bf16 v[80:95], a[164:167], v[32:35], v[80:95]
    ds_read_b64_tr_b16 v[24:25], v158 offset:30720
    ds_read_b64_tr_b16 v[26:27], v158 offset:31232
    v_mfma_f32_32x32x16_bf16 v[96:111], a[164:167], v[36:39], v[96:111]
    ds_read_b64_tr_b16 v[28:29], v159 offset:30720
    ds_read_b64_tr_b16 v[30:31], v159 offset:31232
    v_mfma_f32_32x32x16_bf16 v[48:63], a[168:171], v[40:43], v[48:63]
    v_mfma_f32_32x32x16_bf16 v[64:79], a[168:171], v[44:47], v[64:79]
    v_mfma_f32_32x32x16_bf16 v[80:95], a[172:175], v[40:43], v[80:95]
    v_mfma_f32_32x32x16_bf16 v[96:111], a[172:175], v[44:47], v[96:111]
    s_waitcnt vmcnt(15) lgkmcnt(0)
    s_waitcnt vmcnt(5)
    buffer_store_dword v170, v169, s[8:11], s99 offen sc1
    v_mfma_f32_32x32x16_bf16 v[48:63], a[176:179], v[16:19], v[48:63]
    ds_read_b64_tr_b16 v[32:33], v158 offset:32768
    ds_read_b64_tr_b16 v[34:35], v158 offset:33280
    v_mfma_f32_32x32x16_bf16 v[64:79], a[176:179], v[20:23], v[64:79]
    ds_read_b64_tr_b16 v[36:37], v159 offset:32768
    ds_read_b64_tr_b16 v[38:39], v159 offset:33280
    v_mfma_f32_32x32x16_bf16 v[80:95], a[180:183], v[16:19], v[80:95]
    ds_read_b64_tr_b16 v[40:41], v158 offset:34816
    ds_read_b64_tr_b16 v[42:43], v158 offset:35328
    v_mfma_f32_32x32x16_bf16 v[96:111], a[180:183], v[20:23], v[96:111]
    ds_read_b64_tr_b16 v[44:45], v159 offset:34816
    ds_read_b64_tr_b16 v[46:47], v159 offset:35328
    v_mfma_f32_32x32x16_bf16 v[48:63], a[184:187], v[24:27], v[48:63]
    v_mfma_f32_32x32x16_bf16 v[64:79], a[184:187], v[28:31], v[64:79]
    v_mfma_f32_32x32x16_bf16 v[80:95], a[188:191], v[24:27], v[80:95]
    v_mfma_f32_32x32x16_bf16 v[96:111], a[188:191], v[28:31], v[96:111]
    s_waitcnt lgkmcnt(0)
    v_mfma_f32_32x32x16_bf16 v[48:63], a[192:195], v[32:35], v[48:63]
    ds_read_b64_tr_b16 v[16:17], v158 offset:61440
    ds_read_b64_tr_b16 v[18:19], v158 offset:61952
    v_mfma_f32_32x32x16_bf16 v[64:79], a[192:195], v[36:39], v[64:79]
    ds_read_b64_tr_b16 v[20:21], v159 offset:61440
    ds_read_b64_tr_b16 v[22:23], v159 offset:61952
    v_mfma_f32_32x32x16_bf16 v[80:95], a[196:199], v[32:35], v[80:95]
    ds_read_b64_tr_b16 v[24:25], v158 offset:63488
    ds_read_b64_tr_b16 v[26:27], v158 offset:64000
    v_mfma_f32_32x32x16_bf16 v[96:111], a[196:199], v[36:39], v[96:111]
    ds_read_b64_tr_b16 v[28:29], v159 offset:63488
    ds_read_b64_tr_b16 v[30:31], v159 offset:64000
    v_mfma_f32_32x32x16_bf16 v[48:63], a[200:203], v[40:43], v[48:63]
    v_mfma_f32_32x32x16_bf16 v[64:79], a[200:203], v[44:47], v[64:79]
    v_mfma_f32_32x32x16_bf16 v[80:95], a[204:207], v[40:43], v[80:95]
    v_mfma_f32_32x32x16_bf16 v[96:111], a[204:207], v[44:47], v[96:111]
    s_waitcnt lgkmcnt(0)
    v_mov_b32 v171, 0
    buffer_load_dword v172, v171, s[8:11], s101 offen sc1
    v_mfma_f32_32x32x16_bf16 v[48:63], a[208:211], v[16:19], v[48:63]
    ds_read_b64_tr_b16 v[32:33], v246 offset:0
    ds_read_b64_tr_b16 v[34:35], v246 offset:512
    v_mfma_f32_32x32x16_bf16 v[64:79], a[208:211], v[20:23], v[64:79]
    ds_read_b64_tr_b16 v[36:37], v247 offset:0
    ds_read_b64_tr_b16 v[38:39], v247 offset:512
    v_mfma_f32_32x32x16_bf16 v[80:95], a[212:215], v[16:19], v[80:95]
    ds_read_b64_tr_b16 v[40:41], v246 offset:2048
    ds_read_b64_tr_b16 v[42:43], v246 offset:2560
    v_mfma_f32_32x32x16_bf16 v[96:111], a[212:215], v[20:23], v[96:111]
    ds_read_b64_tr_b16 v[44:45], v247 offset:2048
    ds_read_b64_tr_b16 v[46:47], v247 offset:2560
    v_mfma_f32_32x32x16_bf16 v[48:63], a[216:219], v[24:27], v[48:63]
    v_mfma_f32_32x32x16_bf16 v[64:79], a[216:219], v[28:31], v[64:79]
    v_mfma_f32_32x32x16_bf16 v[80:95], a[220:223], v[24:27], v[80:95]
    v_mfma_f32_32x32x16_bf16 v[96:111], a[220:223], v[28:31], v[96:111]
    s_waitcnt vmcnt(3) lgkmcnt(0)
    s_cmp_lg_u32 s2, 224
    s_cbranch_scc1 back_fe
    s_waitcnt vmcnt(2)
    v_cmp_ne_u32 vcc, s29, v255
    s_nop 1
    s_cbranch_vccnz slow_fe
back_fe:
    v_mfma_f32_32x32x16_bf16 v[64:79], a[224:227], v[36:39], v[64:79]
    v_mfma_f32_32x32x16_bf16 v[64:79], a[232:235], v[44:47], v[64:79]
    v_mfma_f32_32x32x16_bf16 v[80:95], a[228:231], v[32:35], v[80:95]
    v_mfma_f32_32x32x16_bf16 v[80:95], a[236:239], v[40:43], v[80:95]
    v_mfma_f32_32x32x16_bf16 v[96:111], a[228:231], v[36:39], v[96:111]
    v_mfma_f32_32x32x16_bf16 v[96:111], a[236:239], v[44:47], v[96:111]
    s_nop 7
    v_pk_fma_f32 v[64:65], v[64:65], v[252:253], v[192:193]
    v_pk_fma_f32 v[66:67], v[66:67], v[252:253], v[194:195]
    v_pk_fma_f32 v[68:69], v[68:69], v[252:253], v[196:197]
    v_pk_fma_f32 v[70:71], v[70:71], v[252:253], v[198:199]
    v_pk_fma_f32 v[72:73], v[72:73], v[252:253], v[200:201]
    v_pk_fma_f32 v[74:75], v[74:75], v[252:253], v[202:203]
    v_pk_fma_f32 v[76:77], v[76:77], v[252:253], v[204:205]
    v_pk_fma_f32 v[78:79], v[78:79], v[252:253], v[206:207]
    ds_write_b128 v144, v[64:67] offset:0
    ds_write_b128 v144, v[68:71] offset:1024
    ds_write_b128 v144, v[72:75] offset:2048
    ds_write_b128 v144, v[76:79] offset:3072
    v_mfma_f32_32x32x16_bf16 v[48:63], a[224:227], v[32:35], v[48:63]
    v_mfma_f32_32x32x16_bf16 v[48:63], a[232:235], v[40:43], v[48:63]
    v_pk_fma_f32 v[80:81], v[80:81], v[166:167], v[208:209]
    v_pk_fma_f32 v[82:83], v[82:83], v[166:167], v[210:211]
    v_pk_fma_f32 v[84:85], v[84:85], v[166:167], v[212:213]
    v_pk_fma_f32 v[86:87], v[86:87], v[166:167], v[214:215]
    v_pk_fma_f32 v[88:89], v[88:89], v[166:167], v[216:217]
    v_pk_fma_f32 v[90:91], v[90:91], v[166:167], v[218:219]
    v_pk_fma_f32 v[92:93], v[92:93], v[166:167], v[220:221]
    v_pk_fma_f32 v[94:95], v[94:95], v[166:167], v[222:223]
    ds_write_b128 v144, v[80:83] offset:4096
    ds_write_b128 v144, v[84:87] offset:5120
    ds_write_b128 v144, v[88:91] offset:6144
    ds_write_b128 v144, v[92:95] offset:7168
    s_waitcnt vmcnt(0)
    v_cmp_ne_u32 vcc, s29, v172
    s_nop 1
    s_cbranch_vccnz slow_f6b
back_f6b:
    buffer_load_dwordx4 v[112:115], v5, s[8:11], s100 offen offset:0 sc1
    buffer_load_dwordx4 v[116:119], v5, s[8:11], s100 offen offset:1024 sc1
    v_pk_fma_f32 v[96:97], v[96:97], v[252:253], v[224:225]
    v_pk_fma_f32 v[98:99], v[98:99], v[252:253], v[226:227]
    v_pk_fma_f32 v[100:101], v[100:101], v[252:253], v[228:229]
    v_pk_fma_f32 v[102:103], v[102:103], v[252:253], v[230:231]
    v_pk_fma_f32 v[104:105], v[104:105], v[252:253], v[232:233]
    v_pk_fma_f32 v[106:107], v[106:107], v[252:253], v[234:235]
    v_pk_fma_f32 v[108:109], v[108:109], v[252:253], v[236:237]
    v_pk_fma_f32 v[110:111], v[110:111], v[252:253], v[238:239]
    ds_write_b128 v144, v[96:99] offset:32768
    ds_write_b128 v144, v[100:103] offset:33792
    ds_write_b128 v144, v[104:107] offset:34816
    ds_write_b128 v144, v[108:111] offset:35840
    v_pk_fma_f32 v[48:49], v[48:49], v[166:167], v[176:177]
    v_pk_fma_f32 v[50:51], v[50:51], v[166:167], v[178:179]
    v_pk_fma_f32 v[52:53], v[52:53], v[166:167], v[180:181]
    v_pk_fma_f32 v[54:55], v[54:55], v[166:167], v[182:183]
    v_pk_fma_f32 v[56:57], v[56:57], v[166:167], v[184:185]
    v_pk_fma_f32 v[58:59], v[58:59], v[166:167], v[186:187]
    v_pk_fma_f32 v[60:61], v[60:61], v[166:167], v[188:189]
    v_pk_fma_f32 v[62:63], v[62:63], v[166:167], v[190:191]
    s_waitcnt lgkmcnt(0)
    s_barrier
    ds_read_b128 v[64:67], v145 offset:0
    ds_read_b128 v[68:71], v145 offset:1024
    ds_read_b128 v[72:75], v145 offset:2048
    ds_read_b128 v[76:79], v145 offset:3072
    ds_read_b128 v[80:83], v146 offset:4096
    ds_read_b128 v[84:87], v146 offset:5120
    ds_read_b128 v[88:91], v146 offset:6144
    ds_read_b128 v[92:95], v146 offset:7168
    ds_read_b128 v[96:99], v147 offset:32768
    ds_read_b128 v[100:103], v147 offset:33792
    ds_read_b128 v[104:107], v147 offset:34816
    ds_read_b128 v[108:111], v147 offset:35840
    s_waitcnt lgkmcnt(8)
    v_pk_add_f32 v[48:49], v[48:49], v[64:65]
    v_pk_add_f32 v[50:51], v[50:51], v[66:67]
    v_pk_add_f32 v[52:53], v[52:53], v[68:69]
    v_pk_add_f32 v[54:55], v[54:55], v[70:71]
    v_pk_add_f32 v[56:57], v[56:57], v[72:73]
    v_pk_add_f32 v[58:59], v[58:59], v[74:75]
    v_pk_add_f32 v[60:61], v[60:61], v[76:77]
    v_pk_add_f32 v[62:63], v[62:63], v[78:79]
    s_waitcnt lgkmcnt(4)
    v_pk_add_f32 v[48:49], v[48:49], v[80:81]
    v_pk_add_f32 v[50:51], v[50:51], v[82:83]
    v_pk_add_f32 v[52:53], v[52:53], v[84:85]
    v_pk_add_f32 v[54:55], v[54:55], v[86:87]
    v_pk_add_f32 v[56:57], v[56:57], v[88:89]
    v_pk_add_f32 v[58:59], v[58:59], v[90:91]
    v_pk_add_f32 v[60:61], v[60:61], v[92:93]
    v_pk_add_f32 v[62:63], v[62:63], v[94:95]
    s_waitcnt lgkmcnt(0)
    v_pk_add_f32 v[48:49], v[48:49], v[96:97]
    v_pk_add_f32 v[50:51], v[50:51], v[98:99]
    v_pk_add_f32 v[52:53], v[52:53], v[100:101]
    v_pk_add_f32 v[54:55], v[54:55], v[102:103]
    v_pk_add_f32 v[56:57], v[56:57], v[104:105]
    v_pk_add_f32 v[58:59], v[58:59], v[106:107]
    v_pk_add_f32 v[60:61], v[60:61], v[108:109]
    v_pk_add_f32 v[62:63], v[62:63], v[110:111]
    s_waitcnt vmcnt(0)
    v_lshlrev_b32 v120, 16, v112
    v_and_b32 v121, 0xffff0000, v112
    v_lshlrev_b32_e64 v122, 16, v113
    v_and_b32 v123, 0xffff0000, v113
    v_lshlrev_b32_e64 v124, 16, v114
    v_and_b32 v125, 0xffff0000, v114
    v_lshlrev_b32_e64 v126, 16, v115
    v_and_b32 v127, 0xffff0000, v115
    v_lshlrev_b32_e64 v128, 16, v116
    v_and_b32 v129, 0xffff0000, v116
    v_lshlrev_b32_e64 v130, 16, v117
    v_and_b32 v131, 0xffff0000, v117
    v_lshlrev_b32_e64 v132, 16, v118
    v_and_b32 v133, 0xffff0000, v118
    v_lshlrev_b32_e64 v134, 16, v119
    v_and_b32 v135, 0xffff0000, v119
    v_pk_fma_f32 v[48:49], v[120:121], v[166:167], v[48:49]
    v_pk_fma_f32 v[50:51], v[122:123], v[166:167], v[50:51]
    v_pk_fma_f32 v[52:53], v[124:125], v[166:167], v[52:53]
    v_pk_fma_f32 v[54:55], v[126:127], v[166:167], v[54:55]
    v_pk_fma_f32 v[56:57], v[128:129], v[166:167], v[56:57]
    v_pk_fma_f32 v[58:59], v[130:131], v[166:167], v[58:59]
    v_pk_fma_f32 v[60:61], v[132:133], v[166:167], v[60:61]
    v_pk_fma_f32 v[62:63], v[134:135], v[166:167], v[62:63]
    v_cvt_pk_bf16_f32 v80, v48, v49
    v_cvt_pk_bf16_f32 v81, v50, v51
    v_cvt_pk_bf16_f32 v82, v52, v53
    v_cvt_pk_bf16_f32 v83, v54, v55
    v_cvt_pk_bf16_f32 v84, v56, v57
    v_cvt_pk_bf16_f32 v85, v58, v59
    v_cvt_pk_bf16_f32 v86, v60, v61
    v_cvt_pk_bf16_f32 v87, v62, v63
    buffer_store_dwordx4 v[80:83], v14, s[56:59], s32 offen
    buffer_store_dwordx4 v[84:87], v14, s[56:59], s32 offen offset:16
    s_or_b32 s39, s39, s28
    s_cmp_eq_u32 s39, 0
    s_mov_b32 s39, 10092544
    s_cselect_b32 s39, s39, 1073741824
    buffer_store_dword v170, v169, s[8:11], s39 offen sc1
k_end:
    s_endpgm
role_ln:
    v_mul_u32_u24 v231, 3584, v2
    v_lshlrev_b32_e64 v232, 12, v2
    buffer_load_dword v170, v230, s[8:11], 0 offen sc1
    s_mul_i32 s5, s28, 2176
    s_add_u32 s5, s5, 122880
    v_add_u32 v12, s5, v5
    v_lshrrev_b32 v1, 2, v3
    v_mul_u32_u24 v13, 1088, v1
    v_lshl_add_u32 v13, v4, 5, v13
    v_and_b32_e64 v1, 3, v3
    v_lshl_add_u32 v13, v1, 3, v13
    s_lshl_b32 s5, s28, 8
    s_add_u32 s5, s5, 122880
    v_add_u32 v13, s5, v13
    v_lshrrev_b32 v14, 1, v2
    v_lshlrev_b32 v14, 5, v14
    v_and_b32_e64 v1, 1, v2
    v_lshl_add_u32 v14, v1, 2, v14
    v_mov_b32 v15, 0
    s_lshl_b32 s31, s28, 19
    s_lshl_b32 s5, s33, 10
    s_add_u32 s31, s31, s5
    s_add_u32 s35, s31, 0x40000
    s_sub_u32 s99, s4, 16
    s_lshl_b32 s99, s99, 2
    s_add_u32 s99, s99, s28
    s_add_u32 s99, s99, 0
    s_mul_i32 s100, s99, 9363
    s_lshr_b32 s100, s100, 16
    s_mul_i32 s101, s100, 7
    s_sub_u32 s101, s99, s101
    s_and_b32 s98, s3, 1
    s_lshl_b32 s98, s98, 4
    s_add_u32 s98, s98, s100
    s_mul_i32 s98, s98, 229376
    s_lshr_b32 s100, s3, 1
    s_mul_i32 s100, s100, 7
    s_add_u32 s100, s100, s101
    s_lshl_b32 s100, s100, 7
    s_add_u32 s98, s98, s100
    s_cmp_ge_u32 s99, 112
    s_cselect_b32 s98, 1073741824, s98
    buffer_load_dword v175, v231, s[24:27], s98 offen
    s_waitcnt vmcnt(6)
    v_lshlrev_b32 v56, 16, v48
    v_and_b32 v57, 0xffff0000, v48
    v_lshlrev_b32_e64 v58, 16, v49
    v_and_b32 v59, 0xffff0000, v49
    v_lshlrev_b32_e64 v60, 16, v50
    v_and_b32 v61, 0xffff0000, v50
    v_lshlrev_b32_e64 v62, 16, v51
    v_and_b32 v63, 0xffff0000, v51
    v_lshlrev_b32_e64 v64, 16, v16
    v_and_b32 v65, 0xffff0000, v16
    v_lshlrev_b32_e64 v66, 16, v17
    v_and_b32 v67, 0xffff0000, v17
    v_lshlrev_b32_e64 v68, 16, v18
    v_and_b32 v69, 0xffff0000, v18
    v_lshlrev_b32_e64 v70, 16, v19
    v_and_b32 v71, 0xffff0000, v19
    v_lshlrev_b32_e64 v72, 16, v20
    v_and_b32 v73, 0xffff0000, v20
    v_lshlrev_b32_e64 v74, 16, v21
    v_and_b32 v75, 0xffff0000, v21
    v_lshlrev_b32_e64 v76, 16, v22
    v_and_b32 v77, 0xffff0000, v22
    v_lshlrev_b32_e64 v78, 16, v23
    v_and_b32 v79, 0xffff0000, v23
    v_lshlrev_b32_e64 v80, 16, v24
    v_and_b32 v81, 0xffff0000, v24
    v_lshlrev_b32_e64 v82, 16, v25
    v_and_b32 v83, 0xffff0000, v25
    v_lshlrev_b32_e64 v84, 16, v26
    v_and_b32 v85, 0xffff0000, v26
    v_lshlrev_b32_e64 v86, 16, v27
    v_and_b32 v87, 0xffff0000, v27
    v_lshlrev_b32_e64 v88, 16, v28
    v_and_b32 v89, 0xffff0000, v28
    v_lshlrev_b32_e64 v90, 16, v29
    v_and_b32 v91, 0xffff0000, v29
    v_lshlrev_b32_e64 v92, 16, v30
    v_and_b32 v93, 0xffff0000, v30
    v_lshlrev_b32_e64 v94, 16, v31
    v_and_b32 v95, 0xffff0000, v31
    v_pk_add_f32 v[176:177], v[64:65], v[66:67]
    v_pk_mul_f32 v[178:179], v[64:65], v[56:57]
    v_pk_add_f32 v[180:181], v[72:73], v[74:75]
    v_pk_mul_f32 v[182:183], v[72:73], v[56:57]
    v_pk_add_f32 v[184:185], v[80:81], v[82:83]
    v_pk_mul_f32 v[186:187], v[80:81], v[56:57]
    v_pk_add_f32 v[188:189], v[88:89], v[90:91]
    v_pk_mul_f32 v[190:191], v[88:89], v[56:57]
    v_pk_fma_f32 v[178:179], v[66:67], v[58:59], v[178:179]
    v_pk_fma_f32 v[182:183], v[74:75], v[58:59], v[182:183]
    v_pk_fma_f32 v[186:187], v[82:83], v[58:59], v[186:187]
    v_pk_fma_f32 v[190:191], v[90:91], v[58:59], v[190:191]
    v_pk_add_f32 v[176:177], v[176:177], v[68:69]
    v_pk_fma_f32 v[178:179], v[68:69], v[60:61], v[178:179]
    v_pk_add_f32 v[180:181], v[180:181], v[76:77]
    v_pk_fma_f32 v[182:183], v[76:77], v[60:61], v[182:183]
    v_pk_add_f32 v[184:185], v[184:185], v[84:85]
    v_pk_fma_f32 v[186:187], v[84:85], v[60:61], v[186:187]
    v_pk_add_f32 v[188:189], v[188:189], v[92:93]
    v_pk_fma_f32 v[190:191], v[92:93], v[60:61], v[190:191]
    v_pk_add_f32 v[176:177], v[176:177], v[70:71]
    v_pk_fma_f32 v[178:179], v[70:71], v[62:63], v[178:179]
    v_pk_add_f32 v[180:181], v[180:181], v[78:79]
    v_pk_fma_f32 v[182:183], v[78:79], v[62:63], v[182:183]
    v_pk_add_f32 v[184:185], v[184:185], v[86:87]
    v_pk_fma_f32 v[186:187], v[86:87], v[62:63], v[186:187]
    v_pk_add_f32 v[188:189], v[188:189], v[94:95]
    v_pk_fma_f32 v[190:191], v[94:95], v[62:63], v[190:191]
    v_add_f32 v96, v176, v177
    v_add_f32 v100, v178, v179
    v_add_f32 v97, v180, v181
    v_add_f32 v101, v182, v183
    v_add_f32 v98, v184, v185
    v_add_f32 v102, v186, v187
    v_add_f32 v99, v188, v189
    v_add_f32 v103, v190, v191
    v_add_f32_dpp v96, v96, v96 quad_perm:[1,0,3,2] row_mask:0xf bank_mask:0xf
    v_add_f32_dpp v97, v97, v97 quad_perm:[1,0,3,2] row_mask:0xf bank_mask:0xf
    v_add_f32_dpp v98, v98, v98 quad_perm:[1,0,3,2] row_mask:0xf bank_mask:0xf
    v_add_f32_dpp v99, v99, v99 quad_perm:[1,0,3,2] row_mask:0xf bank_mask:0xf
    v_add_f32_dpp v100, v100, v100 quad_perm:[1,0,3,2] row_mask:0xf bank_mask:0xf
    v_add_f32_dpp v101, v101, v101 quad_perm:[1,0,3,2] row_mask:0xf bank_mask:0xf
    v_add_f32_dpp v102, v102, v102 quad_perm:[1,0,3,2] row_mask:0xf bank_mask:0xf
    v_add_f32_dpp v103, v103, v103 quad_perm:[1,0,3,2] row_mask:0xf bank_mask:0xf
    v_add_f32_dpp v96, v96, v96 quad_perm:[2,3,0,1] row_mask:0xf bank_mask:0xf
    v_add_f32_dpp v97, v97, v97 quad_perm:[2,3,0,1] row_mask:0xf bank_mask:0xf
    v_add_f32_dpp v98, v98, v98 quad_perm:[2,3,0,1] row_mask:0xf bank_mask:0xf
    v_add_f32_dpp v99, v99, v99 quad_perm:[2,3,0,1] row_mask:0xf bank_mask:0xf
    v_add_f32_dpp v100, v100, v100 quad_perm:[2,3,0,1] row_mask:0xf bank_mask:0xf
    v_add_f32_dpp v101, v101, v101 quad_perm:[2,3,0,1] row_mask:0xf bank_mask:0xf
    v_add_f32_dpp v102, v102, v102 quad_perm:[2,3,0,1] row_mask:0xf bank_mask:0xf
    v_add_f32_dpp v103, v103, v103 quad_perm:[2,3,0,1] row_mask:0xf bank_mask:0xf
    v_add_f32_dpp v96, v96, v96 row_half_mirror row_mask:0xf bank_mask:0xf
    v_add_f32_dpp v97, v97, v97 row_half_mirror row_mask:0xf bank_mask:0xf
    v_add_f32_dpp v98, v98, v98 row_half_mirror row_mask:0xf bank_mask:0xf
    v_add_f32_dpp v99, v99, v99 row_half_mirror row_mask:0xf bank_mask:0xf
    v_add_f32_dpp v100, v100, v100 row_half_mirror row_mask:0xf bank_mask:0xf
    v_add_f32_dpp v101, v101, v101 row_half_mirror row_mask:0xf bank_mask:0xf
    v_add_f32_dpp v102, v102, v102 row_half_mirror row_mask:0xf bank_mask:0xf
    v_add_f32_dpp v103, v103, v103 row_half_mirror row_mask:0xf bank_mask:0xf
    v_add_f32_dpp v96, v96, v96 row_mirror row_mask:0xf bank_mask:0xf
    v_add_f32_dpp v97, v97, v97 row_mirror row_mask:0xf bank_mask:0xf
    v_add_f32_dpp v98, v98, v98 row_mirror row_mask:0xf bank_mask:0xf
    v_add_f32_dpp v99, v99, v99 row_mirror row_mask:0xf bank_mask:0xf
    v_add_f32_dpp v100, v100, v100 row_mirror row_mask:0xf bank_mask:0xf
    v_add_f32_dpp v101, v101, v101 row_mirror row_mask:0xf bank_mask:0xf
    v_add_f32_dpp v102, v102, v102 row_mirror row_mask:0xf bank_mask:0xf
    v_add_f32_dpp v103, v103, v103 row_mirror row_mask:0xf bank_mask:0xf
    v_mov_b32 v104, v96
    v_mov_b32 v105, v97
    v_mov_b32 v106, v98
    v_mov_b32 v107, v99
    v_mov_b32 v108, v100
    v_mov_b32 v109, v101
    v_mov_b32 v110, v102
    v_mov_b32 v111, v103
    v_permlane16_swap_b32 v96, v104
    v_permlane16_swap_b32 v97, v105
    v_permlane16_swap_b32 v98, v106
    v_permlane16_swap_b32 v99, v107
    v_permlane16_swap_b32 v100, v108
    v_permlane16_swap_b32 v101, v109
    v_permlane16_swap_b32 v102, v110
    v_permlane16_swap_b32 v103, v111
    v_add_f32 v96, v96, v104
    v_add_f32 v97, v97, v105
    v_add_f32 v98, v98, v106
    v_add_f32 v99, v99, v107
    v_add_f32 v100, v100, v108
    v_add_f32 v101, v101, v109
    v_add_f32 v102, v102, v110
    v_add_f32 v103, v103, v111
    v_mov_b32 v104, v96
    v_mov_b32 v105, v97
    v_mov_b32 v106, v98
    v_mov_b32 v107, v99
    v_mov_b32 v108, v100
    v_mov_b32 v109, v101
    v_mov_b32 v110, v102
    v_mov_b32 v111, v103
    v_permlane32_swap_b32 v96, v104
    v_permlane32_swap_b32 v97, v105
    v_permlane32_swap_b32 v98, v106
    v_permlane32_swap_b32 v99, v107
    v_permlane32_swap_b32 v100, v108
    v_permlane32_swap_b32 v101, v109
    v_permlane32_swap_b32 v102, v110
    v_permlane32_swap_b32 v103, v111
    v_add_f32 v96, v96, v104
    v_add_f32 v97, v97, v105
    v_add_f32 v98, v98, v106
    v_add_f32 v99, v99, v107
    v_add_f32 v100, v100, v108
    v_add_f32 v101, v101, v109
    v_add_f32 v102, v102, v110
    v_add_f32 v103, v103, v111
    v_mul_f32 v176, 0xbb000000, v96
    v_cmp_eq_u32 vcc, 0, v2
    s_nop 1
    v_cndmask_b32_e64 v15, v15, v100, vcc
    v_mul_f32 v180, 0xbb000000, v97
    v_cmp_eq_u32 vcc, 1, v2
    s_nop 1
    v_cndmask_b32_e64 v15, v15, v101, vcc
    v_mul_f32 v184, 0xbb000000, v98
    v_cmp_eq_u32 vcc, 2, v2
    s_nop 1
    v_cndmask_b32_e64 v15, v15, v102, vcc
    v_mul_f32 v188, 0xbb000000, v99
    v_cmp_eq_u32 vcc, 3, v2
    s_nop 1
    v_cndmask_b32_e64 v15, v15, v103, vcc
    v_pk_add_f32 v[64:65], v[64:65], v[176:177] op_sel_hi:[1,0]
    v_pk_add_f32 v[72:73], v[72:73], v[180:181] op_sel_hi:[1,0]
    v_pk_add_f32 v[80:81], v[80:81], v[184:185] op_sel_hi:[1,0]
    v_pk_add_f32 v[88:89], v[88:89], v[188:189] op_sel_hi:[1,0]
    v_pk_add_f32 v[66:67], v[66:67], v[176:177] op_sel_hi:[1,0]
    v_pk_add_f32 v[74:75], v[74:75], v[180:181] op_sel_hi:[1,0]
    v_pk_add_f32 v[82:83], v[82:83], v[184:185] op_sel_hi:[1,0]
    v_pk_add_f32 v[90:91], v[90:91], v[188:189] op_sel_hi:[1,0]
    v_pk_add_f32 v[68:69], v[68:69], v[176:177] op_sel_hi:[1,0]
    v_pk_add_f32 v[76:77], v[76:77], v[180:181] op_sel_hi:[1,0]
    v_pk_add_f32 v[84:85], v[84:85], v[184:185] op_sel_hi:[1,0]
    v_pk_add_f32 v[92:93], v[92:93], v[188:189] op_sel_hi:[1,0]
    v_pk_add_f32 v[70:71], v[70:71], v[176:177] op_sel_hi:[1,0]
    v_pk_add_f32 v[78:79], v[78:79], v[180:181] op_sel_hi:[1,0]
    v_pk_add_f32 v[86:87], v[86:87], v[184:185] op_sel_hi:[1,0]
    v_pk_add_f32 v[94:95], v[94:95], v[188:189] op_sel_hi:[1,0]
    v_pk_mul_f32 v[178:179], v[64:65], v[64:65]
    v_pk_mul_f32 v[182:183], v[72:73], v[72:73]
    v_pk_mul_f32 v[186:187], v[80:81], v[80:81]
    v_pk_mul_f32 v[190:191], v[88:89], v[88:89]
    v_pk_fma_f32 v[178:179], v[66:67], v[66:67], v[178:179]
    v_pk_fma_f32 v[182:183], v[74:75], v[74:75], v[182:183]
    v_pk_fma_f32 v[186:187], v[82:83], v[82:83], v[186:187]
    v_pk_fma_f32 v[190:191], v[90:91], v[90:91], v[190:191]
    v_pk_fma_f32 v[178:179], v[68:69], v[68:69], v[178:179]
    v_pk_fma_f32 v[182:183], v[76:77], v[76:77], v[182:183]
    v_pk_fma_f32 v[186:187], v[84:85], v[84:85], v[186:187]
    v_pk_fma_f32 v[190:191], v[92:93], v[92:93], v[190:191]
    v_pk_fma_f32 v[178:179], v[70:71], v[70:71], v[178:179]
    v_pk_fma_f32 v[182:183], v[78:79], v[78:79], v[182:183]
    v_pk_fma_f32 v[186:187], v[86:87], v[86:87], v[186:187]
    v_pk_fma_f32 v[190:191], v[94:95], v[94:95], v[190:191]
    v_add_f32 v96, v178, v179
    v_add_f32 v97, v182, v183
    v_add_f32 v98, v186, v187
    v_add_f32 v99, v190, v191
    v_add_f32_dpp v96, v96, v96 quad_perm:[1,0,3,2] row_mask:0xf bank_mask:0xf
    v_add_f32_dpp v97, v97, v97 quad_perm:[1,0,3,2] row_mask:0xf bank_mask:0xf
    v_add_f32_dpp v98, v98, v98 quad_perm:[1,0,3,2] row_mask:0xf bank_mask:0xf
    v_add_f32_dpp v99, v99, v99 quad_perm:[1,0,3,2] row_mask:0xf bank_mask:0xf
    v_add_f32_dpp v96, v96, v96 quad_perm:[2,3,0,1] row_mask:0xf bank_mask:0xf
    v_add_f32_dpp v97, v97, v97 quad_perm:[2,3,0,1] row_mask:0xf bank_mask:0xf
    v_add_f32_dpp v98, v98, v98 quad_perm:[2,3,0,1] row_mask:0xf bank_mask:0xf
    v_add_f32_dpp v99, v99, v99 quad_perm:[2,3,0,1] row_mask:0xf bank_mask:0xf
    v_add_f32_dpp v96, v96, v96 row_half_mirror row_mask:0xf bank_mask:0xf
    v_add_f32_dpp v97, v97, v97 row_half_mirror row_mask:0xf bank_mask:0xf
    v_add_f32_dpp v98, v98, v98 row_half_mirror row_mask:0xf bank_mask:0xf
    v_add_f32_dpp v99, v99, v99 row_half_mirror row_mask:0xf bank_mask:0xf
    v_add_f32_dpp v96, v96, v96 row_mirror row_mask:0xf bank_mask:0xf
    v_add_f32_dpp v97, v97, v97 row_mirror row_mask:0xf bank_mask:0xf
    v_add_f32_dpp v98, v98, v98 row_mirror row_mask:0xf bank_mask:0xf
    v_add_f32_dpp v99, v99, v99 row_mirror row_mask:0xf bank_mask:0xf
    v_mov_b32 v104, v96
    v_mov_b32 v105, v97
    v_mov_b32 v106, v98
    v_mov_b32 v107, v99
    v_permlane16_swap_b32 v96, v104
    v_permlane16_swap_b32 v97, v105
    v_permlane16_swap_b32 v98, v106
    v_permlane16_swap_b32 v99, v107
    v_add_f32 v96, v96, v104
    v_add_f32 v97, v97, v105
    v_add_f32 v98, v98, v106
    v_add_f32 v99, v99, v107
    v_mov_b32 v104, v96
    v_mov_b32 v105, v97
    v_mov_b32 v106, v98
    v_mov_b32 v107, v99
    v_permlane32_swap_b32 v96, v104
    v_permlane32_swap_b32 v97, v105
    v_permlane32_swap_b32 v98, v106
    v_permlane32_swap_b32 v99, v107
    v_add_f32 v96, v96, v104
    v_add_f32 v97, v97, v105
    v_add_f32 v98, v98, v106
    v_add_f32 v99, v99, v107
    v_mov_b32 v104, 0x3727c5ac
    v_fmamk_f32 v96, v96, 0x3b000000, v104
    v_fmamk_f32 v97, v97, 0x3b000000, v104
    v_fmamk_f32 v98, v98, 0x3b000000, v104
    v_fmamk_f32 v99, v99, 0x3b000000, v104
    v_rsq_f32 v176, v96
    v_rsq_f32 v180, v97
    v_rsq_f32 v184, v98
    v_rsq_f32 v188, v99
    v_pk_mul_f32 v[64:65], v[64:65], v[176:177] op_sel_hi:[1,0]
    v_pk_mul_f32 v[72:73], v[72:73], v[180:181] op_sel_hi:[1,0]
    v_pk_mul_f32 v[80:81], v[80:81], v[184:185] op_sel_hi:[1,0]
    v_pk_mul_f32 v[88:89], v[88:89], v[188:189] op_sel_hi:[1,0]
    v_pk_mul_f32 v[66:67], v[66:67], v[176:177] op_sel_hi:[1,0]
    v_pk_mul_f32 v[74:75], v[74:75], v[180:181] op_sel_hi:[1,0]
    v_pk_mul_f32 v[82:83], v[82:83], v[184:185] op_sel_hi:[1,0]
    v_pk_mul_f32 v[90:91], v[90:91], v[188:189] op_sel_hi:[1,0]
    v_pk_mul_f32 v[68:69], v[68:69], v[176:177] op_sel_hi:[1,0]
    v_pk_mul_f32 v[76:77], v[76:77], v[180:181] op_sel_hi:[1,0]
    v_pk_mul_f32 v[84:85], v[84:85], v[184:185] op_sel_hi:[1,0]
    v_pk_mul_f32 v[92:93], v[92:93], v[188:189] op_sel_hi:[1,0]
    v_pk_mul_f32 v[70:71], v[70:71], v[176:177] op_sel_hi:[1,0]
    v_pk_mul_f32 v[78:79], v[78:79], v[180:181] op_sel_hi:[1,0]
    v_pk_mul_f32 v[86:87], v[86:87], v[184:185] op_sel_hi:[1,0]
    v_pk_mul_f32 v[94:95], v[94:95], v[188:189] op_sel_hi:[1,0]
    v_cvt_pk_bf16_f32 v16, v64, v65
    v_cvt_pk_bf16_f32 v17, v66, v67
    v_cvt_pk_bf16_f32 v18, v68, v69
    v_cvt_pk_bf16_f32 v19, v70, v71
    ds_write_b128 v12, v[16:19] offset:0
    v_cvt_pk_bf16_f32 v20, v72, v73
    v_cvt_pk_bf16_f32 v21, v74, v75
    v_cvt_pk_bf16_f32 v22, v76, v77
    v_cvt_pk_bf16_f32 v23, v78, v79
    ds_write_b128 v12, v[20:23] offset:1088
    v_cvt_pk_bf16_f32 v24, v80, v81
    v_cvt_pk_bf16_f32 v25, v82, v83
    v_cvt_pk_bf16_f32 v26, v84, v85
    v_cvt_pk_bf16_f32 v27, v86, v87
    ds_write_b128 v12, v[24:27] offset:8704
    v_cvt_pk_bf16_f32 v28, v88, v89
    v_cvt_pk_bf16_f32 v29, v90, v91
    v_cvt_pk_bf16_f32 v30, v92, v93
    v_cvt_pk_bf16_f32 v31, v94, v95
    ds_write_b128 v12, v[28:31] offset:9792
    s_waitcnt lgkmcnt(0)
    s_barrier
    ds_read_b64_tr_b16 v[112:113], v13 offset:0
    ds_read_b64_tr_b16 v[114:115], v13 offset:4352
    ds_read_b64_tr_b16 v[116:117], v13 offset:128
    ds_read_b64_tr_b16 v[118:119], v13 offset:4480
    ds_read_b64_tr_b16 v[120:121], v13 offset:8704
    ds_read_b64_tr_b16 v[122:123], v13 offset:13056
    ds_read_b64_tr_b16 v[124:125], v13 offset:8832
    ds_read_b64_tr_b16 v[126:127], v13 offset:13184
    s_waitcnt lgkmcnt(6)
    buffer_store_dwordx4 v[112:115], v5, s[8:11], s31 offen offset:0 sc1
    s_waitcnt lgkmcnt(4)
    buffer_store_dwordx4 v[116:119], v5, s[8:11], s35 offen offset:0 sc1
    s_waitcnt lgkmcnt(2)
    buffer_store_dwordx4 v[120:123], v5, s[8:11], s31 offen offset:1024 sc1
    s_waitcnt lgkmcnt(0)
    buffer_store_dwordx4 v[124:127], v5, s[8:11], s35 offen offset:1024 sc1
    s_waitcnt vmcnt(6)
    v_lshlrev_b32 v64, 16, v32
    v_and_b32 v65, 0xffff0000, v32
    v_lshlrev_b32_e64 v66, 16, v33
    v_and_b32 v67, 0xffff0000, v33
    v_lshlrev_b32_e64 v68, 16, v34
    v_and_b32 v69, 0xffff0000, v34
    v_lshlrev_b32_e64 v70, 16, v35
    v_and_b32 v71, 0xffff0000, v35
    v_lshlrev_b32_e64 v72, 16, v36
    v_and_b32 v73, 0xffff0000, v36
    v_lshlrev_b32_e64 v74, 16, v37
    v_and_b32 v75, 0xffff0000, v37
    v_lshlrev_b32_e64 v76, 16, v38
    v_and_b32 v77, 0xffff0000, v38
    v_lshlrev_b32_e64 v78, 16, v39
    v_and_b32 v79, 0xffff0000, v39
    v_lshlrev_b32_e64 v80, 16, v40
    v_and_b32 v81, 0xffff0000, v40
    v_lshlrev_b32_e64 v82, 16, v41
    v_and_b32 v83, 0xffff0000, v41
    v_lshlrev_b32_e64 v84, 16, v42
    v_and_b32 v85, 0xffff0000, v42
    v_lshlrev_b32_e64 v86, 16, v43
    v_and_b32 v87, 0xffff0000, v43
    v_lshlrev_b32_e64 v88, 16, v44
    v_and_b32 v89, 0xffff0000, v44
    v_lshlrev_b32_e64 v90, 16, v45
    v_and_b32 v91, 0xffff0000, v45
    v_lshlrev_b32_e64 v92, 16, v46
    v_and_b32 v93, 0xffff0000, v46
    v_lshlrev_b32_e64 v94, 16, v47
    v_and_b32 v95, 0xffff0000, v47
    v_pk_add_f32 v[176:177], v[64:65], v[66:67]
    v_pk_mul_f32 v[178:179], v[64:65], v[56:57]
    v_pk_add_f32 v[180:181], v[72:73], v[74:75]
    v_pk_mul_f32 v[182:183], v[72:73], v[56:57]
    v_pk_add_f32 v[184:185], v[80:81], v[82:83]
    v_pk_mul_f32 v[186:187], v[80:81], v[56:57]
    v_pk_add_f32 v[188:189], v[88:89], v[90:91]
    v_pk_mul_f32 v[190:191], v[88:89], v[56:57]
    v_pk_fma_f32 v[178:179], v[66:67], v[58:59], v[178:179]
    v_pk_fma_f32 v[182:183], v[74:75], v[58:59], v[182:183]
    v_pk_fma_f32 v[186:187], v[82:83], v[58:59], v[186:187]
    v_pk_fma_f32 v[190:191], v[90:91], v[58:59], v[190:191]
    v_pk_add_f32 v[176:177], v[176:177], v[68:69]
    v_pk_fma_f32 v[178:179], v[68:69], v[60:61], v[178:179]
    v_pk_add_f32 v[180:181], v[180:181], v[76:77]
    v_pk_fma_f32 v[182:183], v[76:77], v[60:61], v[182:183]
    v_pk_add_f32 v[184:185], v[184:185], v[84:85]
    v_pk_fma_f32 v[186:187], v[84:85], v[60:61], v[186:187]
    v_pk_add_f32 v[188:189], v[188:189], v[92:93]
    v_pk_fma_f32 v[190:191], v[92:93], v[60:61], v[190:191]
    v_pk_add_f32 v[176:177], v[176:177], v[70:71]
    v_pk_fma_f32 v[178:179], v[70:71], v[62:63], v[178:179]
    v_pk_add_f32 v[180:181], v[180:181], v[78:79]
    v_pk_fma_f32 v[182:183], v[78:79], v[62:63], v[182:183]
    v_pk_add_f32 v[184:185], v[184:185], v[86:87]
    v_pk_fma_f32 v[186:187], v[86:87], v[62:63], v[186:187]
    v_pk_add_f32 v[188:189], v[188:189], v[94:95]
    v_pk_fma_f32 v[190:191], v[94:95], v[62:63], v[190:191]
    v_add_f32 v96, v176, v177
    v_add_f32 v100, v178, v179
    v_add_f32 v97, v180, v181
    v_add_f32 v101, v182, v183
    v_add_f32 v98, v184, v185
    v_add_f32 v102, v186, v187
    v_add_f32 v99, v188, v189
    v_add_f32 v103, v190, v191
    v_add_f32_dpp v96, v96, v96 quad_perm:[1,0,3,2] row_mask:0xf bank_mask:0xf
    v_add_f32_dpp v97, v97, v97 quad_perm:[1,0,3,2] row_mask:0xf bank_mask:0xf
    v_add_f32_dpp v98, v98, v98 quad_perm:[1,0,3,2] row_mask:0xf bank_mask:0xf
    v_add_f32_dpp v99, v99, v99 quad_perm:[1,0,3,2] row_mask:0xf bank_mask:0xf
    v_add_f32_dpp v100, v100, v100 quad_perm:[1,0,3,2] row_mask:0xf bank_mask:0xf
    v_add_f32_dpp v101, v101, v101 quad_perm:[1,0,3,2] row_mask:0xf bank_mask:0xf
    v_add_f32_dpp v102, v102, v102 quad_perm:[1,0,3,2] row_mask:0xf bank_mask:0xf
    v_add_f32_dpp v103, v103, v103 quad_perm:[1,0,3,2] row_mask:0xf bank_mask:0xf
    v_add_f32_dpp v96, v96, v96 quad_perm:[2,3,0,1] row_mask:0xf bank_mask:0xf
    v_add_f32_dpp v97, v97, v97 quad_perm:[2,3,0,1] row_mask:0xf bank_mask:0xf
    v_add_f32_dpp v98, v98, v98 quad_perm:[2,3,0,1] row_mask:0xf bank_mask:0xf
    v_add_f32_dpp v99, v99, v99 quad_perm:[2,3,0,1] row_mask:0xf bank_mask:0xf
    v_add_f32_dpp v100, v100, v100 quad_perm:[2,3,0,1] row_mask:0xf bank_mask:0xf
    v_add_f32_dpp v101, v101, v101 quad_perm:[2,3,0,1] row_mask:0xf bank_mask:0xf
    v_add_f32_dpp v102, v102, v102 quad_perm:[2,3,0,1] row_mask:0xf bank_mask:0xf
    v_add_f32_dpp v103, v103, v103 quad_perm:[2,3,0,1] row_mask:0xf bank_mask:0xf
    v_add_f32_dpp v96, v96, v96 row_half_mirror row_mask:0xf bank_mask:0xf
    v_add_f32_dpp v97, v97, v97 row_half_mirror row_mask:0xf bank_mask:0xf
    v_add_f32_dpp v98, v98, v98 row_half_mirror row_mask:0xf bank_mask:0xf
    v_add_f32_dpp v99, v99, v99 row_half_mirror row_mask:0xf bank_mask:0xf
    v_add_f32_dpp v100, v100, v100 row_half_mirror row_mask:0xf bank_mask:0xf
    v_add_f32_dpp v101, v101, v101 row_half_mirror row_mask:0xf bank_mask:0xf
    v_add_f32_dpp v102, v102, v102 row_half_mirror row_mask:0xf bank_mask:0xf
    v_add_f32_dpp v103, v103, v103 row_half_mirror row_mask:0xf bank_mask:0xf
    v_add_f32_dpp v96, v96, v96 row_mirror row_mask:0xf bank_mask:0xf
    v_add_f32_dpp v97, v97, v97 row_mirror row_mask:0xf bank_mask:0xf
    v_add_f32_dpp v98, v98, v98 row_mirror row_mask:0xf bank_mask:0xf
    v_add_f32_dpp v99, v99, v99 row_mirror row_mask:0xf bank_mask:0xf
    v_add_f32_dpp v100, v100, v100 row_mirror row_mask:0xf bank_mask:0xf
    v_add_f32_dpp v101, v101, v101 row_mirror row_mask:0xf bank_mask:0xf
    v_add_f32_dpp v102, v102, v102 row_mirror row_mask:0xf bank_mask:0xf
    v_add_f32_dpp v103, v103, v103 row_mirror row_mask:0xf bank_mask:0xf
    v_mov_b32 v104, v96
    v_mov_b32 v105, v97
    v_mov_b32 v106, v98
    v_mov_b32 v107, v99
    v_mov_b32 v108, v100
    v_mov_b32 v109, v101
    v_mov_b32 v110, v102
    v_mov_b32 v111, v103
    v_permlane16_swap_b32 v96, v104
    v_permlane16_swap_b32 v97, v105
    v_permlane16_swap_b32 v98, v106
    v_permlane16_swap_b32 v99, v107
    v_permlane16_swap_b32 v100, v108
    v_permlane16_swap_b32 v101, v109
    v_permlane16_swap_b32 v102, v110
    v_permlane16_swap_b32 v103, v111
    v_add_f32 v96, v96, v104
    v_add_f32 v97, v97, v105
    v_add_f32 v98, v98, v106
    v_add_f32 v99, v99, v107
    v_add_f32 v100, v100, v108
    v_add_f32 v101, v101, v109
    v_add_f32 v102, v102, v110
    v_add_f32 v103, v103, v111
    v_mov_b32 v104, v96
    v_mov_b32 v105, v97
    v_mov_b32 v106, v98
    v_mov_b32 v107, v99
    v_mov_b32 v108, v100
    v_mov_b32 v109, v101
    v_mov_b32 v110, v102
    v_mov_b32 v111, v103
    v_permlane32_swap_b32 v96, v104
    v_permlane32_swap_b32 v97, v105
    v_permlane32_swap_b32 v98, v106
    v_permlane32_swap_b32 v99, v107
    v_permlane32_swap_b32 v100, v108
    v_permlane32_swap_b32 v101, v109
    v_permlane32_swap_b32 v102, v110
    v_permlane32_swap_b32 v103, v111
    v_add_f32 v96, v96, v104
    v_add_f32 v97, v97, v105
    v_add_f32 v98, v98, v106
    v_add_f32 v99, v99, v107
    v_add_f32 v100, v100, v108
    v_add_f32 v101, v101, v109
    v_add_f32 v102, v102, v110
    v_add_f32 v103, v103, v111
    v_mul_f32 v176, 0xbb000000, v96
    v_cmp_eq_u32 vcc, 4, v2
    s_nop 1
    v_cndmask_b32_e64 v15, v15, v100, vcc
    v_mul_f32 v180, 0xbb000000, v97
    v_cmp_eq_u32 vcc, 5, v2
    s_nop 1
    v_cndmask_b32_e64 v15, v15, v101, vcc
    v_mul_f32 v184, 0xbb000000, v98
    v_cmp_eq_u32 vcc, 6, v2
    s_nop 1
    v_cndmask_b32_e64 v15, v15, v102, vcc
    v_mul_f32 v188, 0xbb000000, v99
    v_cmp_eq_u32 vcc, 7, v2
    s_nop 1
    v_cndmask_b32_e64 v15, v15, v103, vcc
    v_pk_add_f32 v[64:65], v[64:65], v[176:177] op_sel_hi:[1,0]
    v_pk_add_f32 v[72:73], v[72:73], v[180:181] op_sel_hi:[1,0]
    v_pk_add_f32 v[80:81], v[80:81], v[184:185] op_sel_hi:[1,0]
    v_pk_add_f32 v[88:89], v[88:89], v[188:189] op_sel_hi:[1,0]
    v_pk_add_f32 v[66:67], v[66:67], v[176:177] op_sel_hi:[1,0]
    v_pk_add_f32 v[74:75], v[74:75], v[180:181] op_sel_hi:[1,0]
    v_pk_add_f32 v[82:83], v[82:83], v[184:185] op_sel_hi:[1,0]
    v_pk_add_f32 v[90:91], v[90:91], v[188:189] op_sel_hi:[1,0]
    v_pk_add_f32 v[68:69], v[68:69], v[176:177] op_sel_hi:[1,0]
    v_pk_add_f32 v[76:77], v[76:77], v[180:181] op_sel_hi:[1,0]
    v_pk_add_f32 v[84:85], v[84:85], v[184:185] op_sel_hi:[1,0]
    v_pk_add_f32 v[92:93], v[92:93], v[188:189] op_sel_hi:[1,0]
    v_pk_add_f32 v[70:71], v[70:71], v[176:177] op_sel_hi:[1,0]
    v_pk_add_f32 v[78:79], v[78:79], v[180:181] op_sel_hi:[1,0]
    v_pk_add_f32 v[86:87], v[86:87], v[184:185] op_sel_hi:[1,0]
    v_pk_add_f32 v[94:95], v[94:95], v[188:189] op_sel_hi:[1,0]
    v_pk_mul_f32 v[178:179], v[64:65], v[64:65]
    v_pk_mul_f32 v[182:183], v[72:73], v[72:73]
    v_pk_mul_f32 v[186:187], v[80:81], v[80:81]
    v_pk_mul_f32 v[190:191], v[88:89], v[88:89]
    v_pk_fma_f32 v[178:179], v[66:67], v[66:67], v[178:179]
    v_pk_fma_f32 v[182:183], v[74:75], v[74:75], v[182:183]
    v_pk_fma_f32 v[186:187], v[82:83], v[82:83], v[186:187]
    v_pk_fma_f32 v[190:191], v[90:91], v[90:91], v[190:191]
    v_pk_fma_f32 v[178:179], v[68:69], v[68:69], v[178:179]
    v_pk_fma_f32 v[182:183], v[76:77], v[76:77], v[182:183]
    v_pk_fma_f32 v[186:187], v[84:85], v[84:85], v[186:187]
    v_pk_fma_f32 v[190:191], v[92:93], v[92:93], v[190:191]
    v_pk_fma_f32 v[178:179], v[70:71], v[70:71], v[178:179]
    v_pk_fma_f32 v[182:183], v[78:79], v[78:79], v[182:183]
    v_pk_fma_f32 v[186:187], v[86:87], v[86:87], v[186:187]
    v_pk_fma_f32 v[190:191], v[94:95], v[94:95], v[190:191]
    v_add_f32 v96, v178, v179
    v_add_f32 v97, v182, v183
    v_add_f32 v98, v186, v187
    v_add_f32 v99, v190, v191
    v_add_f32_dpp v96, v96, v96 quad_perm:[1,0,3,2] row_mask:0xf bank_mask:0xf
    v_add_f32_dpp v97, v97, v97 quad_perm:[1,0,3,2] row_mask:0xf bank_mask:0xf
    v_add_f32_dpp v98, v98, v98 quad_perm:[1,0,3,2] row_mask:0xf bank_mask:0xf
    v_add_f32_dpp v99, v99, v99 quad_perm:[1,0,3,2] row_mask:0xf bank_mask:0xf
    v_add_f32_dpp v96, v96, v96 quad_perm:[2,3,0,1] row_mask:0xf bank_mask:0xf
    v_add_f32_dpp v97, v97, v97 quad_perm:[2,3,0,1] row_mask:0xf bank_mask:0xf
    v_add_f32_dpp v98, v98, v98 quad_perm:[2,3,0,1] row_mask:0xf bank_mask:0xf
    v_add_f32_dpp v99, v99, v99 quad_perm:[2,3,0,1] row_mask:0xf bank_mask:0xf
    v_add_f32_dpp v96, v96, v96 row_half_mirror row_mask:0xf bank_mask:0xf
    v_add_f32_dpp v97, v97, v97 row_half_mirror row_mask:0xf bank_mask:0xf
    v_add_f32_dpp v98, v98, v98 row_half_mirror row_mask:0xf bank_mask:0xf
    v_add_f32_dpp v99, v99, v99 row_half_mirror row_mask:0xf bank_mask:0xf
    v_add_f32_dpp v96, v96, v96 row_mirror row_mask:0xf bank_mask:0xf
    v_add_f32_dpp v97, v97, v97 row_mirror row_mask:0xf bank_mask:0xf
    v_add_f32_dpp v98, v98, v98 row_mirror row_mask:0xf bank_mask:0xf
    v_add_f32_dpp v99, v99, v99 row_mirror row_mask:0xf bank_mask:0xf
    v_mov_b32 v104, v96
    v_mov_b32 v105, v97
    v_mov_b32 v106, v98
    v_mov_b32 v107, v99
    v_permlane16_swap_b32 v96, v104
    v_permlane16_swap_b32 v97, v105
    v_permlane16_swap_b32 v98, v106
    v_permlane16_swap_b32 v99, v107
    v_add_f32 v96, v96, v104
    v_add_f32 v97, v97, v105
    v_add_f32 v98, v98, v106
    v_add_f32 v99, v99, v107
    v_mov_b32 v104, v96
    v_mov_b32 v105, v97
    v_mov_b32 v106, v98
    v_mov_b32 v107, v99
    v_permlane32_swap_b32 v96, v104
    v_permlane32_swap_b32 v97, v105
    v_permlane32_swap_b32 v98, v106
    v_permlane32_swap_b32 v99, v107
    v_add_f32 v96, v96, v104
    v_add_f32 v97, v97, v105
    v_add_f32 v98, v98, v106
    v_add_f32 v99, v99, v107
    v_mov_b32 v104, 0x3727c5ac
    v_fmamk_f32 v96, v96, 0x3b000000, v104
    v_fmamk_f32 v97, v97, 0x3b000000, v104
    v_fmamk_f32 v98, v98, 0x3b000000, v104
    v_fmamk_f32 v99, v99, 0x3b000000, v104
    v_rsq_f32 v176, v96
    v_rsq_f32 v180, v97
    v_rsq_f32 v184, v98
    v_rsq_f32 v188, v99
    v_pk_mul_f32 v[64:65], v[64:65], v[176:177] op_sel_hi:[1,0]
    v_pk_mul_f32 v[72:73], v[72:73], v[180:181] op_sel_hi:[1,0]
    v_pk_mul_f32 v[80:81], v[80:81], v[184:185] op_sel_hi:[1,0]
    v_pk_mul_f32 v[88:89], v[88:89], v[188:189] op_sel_hi:[1,0]
    v_pk_mul_f32 v[66:67], v[66:67], v[176:177] op_sel_hi:[1,0]
    v_pk_mul_f32 v[74:75], v[74:75], v[180:181] op_sel_hi:[1,0]
    v_pk_mul_f32 v[82:83], v[82:83], v[184:185] op_sel_hi:[1,0]
    v_pk_mul_f32 v[90:91], v[90:91], v[188:189] op_sel_hi:[1,0]
    v_pk_mul_f32 v[68:69], v[68:69], v[176:177] op_sel_hi:[1,0]
    v_pk_mul_f32 v[76:77], v[76:77], v[180:181] op_sel_hi:[1,0]
    v_pk_mul_f32 v[84:85], v[84:85], v[184:185] op_sel_hi:[1,0]
    v_pk_mul_f32 v[92:93], v[92:93], v[188:189] op_sel_hi:[1,0]
    v_pk_mul_f32 v[70:71], v[70:71], v[176:177] op_sel_hi:[1,0]
    v_pk_mul_f32 v[78:79], v[78:79], v[180:181] op_sel_hi:[1,0]
    v_pk_mul_f32 v[86:87], v[86:87], v[184:185] op_sel_hi:[1,0]
    v_pk_mul_f32 v[94:95], v[94:95], v[188:189] op_sel_hi:[1,0]
    v_cvt_pk_bf16_f32 v32, v64, v65
    v_cvt_pk_bf16_f32 v33, v66, v67
    v_cvt_pk_bf16_f32 v34, v68, v69
    v_cvt_pk_bf16_f32 v35, v70, v71
    ds_write_b128 v12, v[32:35] offset:17408
    v_cvt_pk_bf16_f32 v36, v72, v73
    v_cvt_pk_bf16_f32 v37, v74, v75
    v_cvt_pk_bf16_f32 v38, v76, v77
    v_cvt_pk_bf16_f32 v39, v78, v79
    ds_write_b128 v12, v[36:39] offset:18496
    v_cvt_pk_bf16_f32 v40, v80, v81
    v_cvt_pk_bf16_f32 v41, v82, v83
    v_cvt_pk_bf16_f32 v42, v84, v85
    v_cvt_pk_bf16_f32 v43, v86, v87
    ds_write_b128 v12, v[40:43] offset:26112
    v_cvt_pk_bf16_f32 v44, v88, v89
    v_cvt_pk_bf16_f32 v45, v90, v91
    v_cvt_pk_bf16_f32 v46, v92, v93
    v_cvt_pk_bf16_f32 v47, v94, v95
    ds_write_b128 v12, v[44:47] offset:27200
    s_waitcnt lgkmcnt(0)
    s_barrier
    ds_read_b64_tr_b16 v[112:113], v13 offset:17408
    ds_read_b64_tr_b16 v[114:115], v13 offset:21760
    ds_read_b64_tr_b16 v[116:117], v13 offset:17536
    ds_read_b64_tr_b16 v[118:119], v13 offset:21888
    ds_read_b64_tr_b16 v[120:121], v13 offset:26112
    ds_read_b64_tr_b16 v[122:123], v13 offset:30464
    ds_read_b64_tr_b16 v[124:125], v13 offset:26240
    ds_read_b64_tr_b16 v[126:127], v13 offset:30592
    s_waitcnt lgkmcnt(6)
    buffer_store_dwordx4 v[112:115], v5, s[8:11], s31 offen offset:2048 sc1
    s_waitcnt lgkmcnt(4)
    buffer_store_dwordx4 v[116:119], v5, s[8:11], s35 offen offset:2048 sc1
    s_waitcnt lgkmcnt(2)
    buffer_store_dwordx4 v[120:123], v5, s[8:11], s31 offen offset:3072 sc1
    s_waitcnt lgkmcnt(0)
    buffer_store_dwordx4 v[124:127], v5, s[8:11], s35 offen offset:3072 sc1
    v_mul_f32 v15, 0xbfb8aa3b, v15
    v_exp_f32 v15, v15
    s_nop 0
    v_add_f32 v15, 1.0, v15
    v_rcp_f32 v15, v15
    s_lshl_b32 s5, s33, 5
    s_lshl_b32 s6, s28, 3
    s_add_u32 s5, s5, s6
    s_add_u32 s5, s5, 10027008
    s_mov_b64 exec, 0xff
    buffer_store_dword v15, v14, s[8:11], s5 offen sc1
    s_mov_b64 exec, -1
    v_mov_b32 v1, 0
    v_cmp_eq_u32 vcc, 0, v2
    v_mov_b32 v169, 1073741824
    s_nop 0
    v_cndmask_b32 v169, v169, v1, vcc
    s_and_b32 s78, s3, 1
    s_and_b32 s6, s4, 3
    s_lshl_b32 s5, s6, 1
    s_add_u32 s76, s5, s78
    s_lshr_b32 s7, s4, 2
    s_mul_i32 s66, s7, 1
    s_add_u32 s66, s66, s5
    s_and_b32 s66, s66, 7
    s_mul_i32 s72, s6, 7
    s_lshr_b32 s72, s72, 2
    s_mul_i32 s5, s7, 1
    s_add_u32 s72, s72, s5
    s_sub_u32 s5, s72, 7
    s_cmp_ge_u32 s72, 7
    s_cselect_b32 s72, s5, s72
    s_lshr_b32 s5, s3, 1
    s_mul_i32 s77, s5, 7
    s_add_u32 s77, s77, s7
    s_lshl_b32 s79, s5, 3
    s_add_u32 s79, s79, s7
    s_lshl_b32 s67, s28, 13
    s_lshl_b32 s80, s76, 18
    s_lshl_b32 s5, s78, 17
    s_add_u32 s80, s80, s5
    s_lshl_b32 s7, s28, 12
    s_add_u32 s80, s80, s7
    s_xor_b32 s64, s80, 0x40000
    s_mul_i32 s65, s28, 114688
    s_mul_i32 s5, s78, 3670016
    s_add_u32 s65, s65, s5
    s_lshl_b32 s5, s77, 7
    s_add_u32 s65, s65, s5
    s_mul_i32 s73, s76, 294912
    s_add_u32 s73, s73, s7
    s_add_u32 s73, s73, 6291456
    s_mul_i32 s5, s78, 114688
    s_add_u32 s81, s73, s5
    s_add_u32 s70, s81, 294912
    s_sub_u32 s5, s81, 294912
    s_cmp_eq_u32 s78, 0
    s_cselect_b32 s70, s70, s5
    s_add_u32 s73, s73, 229376
    s_lshl_b32 s71, s28, 17
    s_mul_i32 s5, s78, 3670016
    s_add_u32 s71, s71, s5
    s_lshl_b32 s5, s79, 7
    s_add_u32 s71, s71, s5
    v_lshlrev_b32_e64 v136, 4, v173
    v_lshl_add_u32 v136, v174, 10, v136
    s_lshr_b32 s5, s28, 1
    s_lshl_b32 s5, s5, 9
    v_or_b32_e64 v136, s5, v136
    v_xor_b32 v137, 512, v136
    v_lshrrev_b32_e64 v1, 3, v2
    v_mul_u32_u24 v138, 3584, v1
    v_bfe_u32 v1, v2, 4, 1
    v_lshlrev_b32 v1, 2, v1
    v_and_b32 v139, 7, v2
    v_xor_b32_e64 v1, v1, v139
    v_lshl_add_u32 v138, v1, 4, v138
    v_add_u32 v139, 27648, v138
    v_add_u32 v140, 55296, v138
    v_add_u32 v141, 82944, v138
    v_bfe_u32 v1, v2, 2, 2
    v_lshl_add_u32 v1, v174, 3, v1
    v_lshlrev_b32_e64 v142, 7, v1
    v_bfe_u32 v1, v2, 3, 1
    v_lshl_add_u32 v142, v1, 6, v142
    v_bfe_u32 v1, v2, 4, 1
    v_lshl_add_u32 v142, v1, 4, v142
    v_and_b32_e64 v1, 1, v2
    v_lshl_add_u32 v142, v1, 5, v142
    v_bfe_u32 v1, v2, 1, 1
    v_lshl_add_u32 v142, v1, 3, v142
    s_and_b32 s5, s28, 1
    s_lshl_b32 s5, s5, 6
    v_xor_b32 v142, s5, v142
    v_add_u32 v142, s67, v142
    v_xor_b32_e64 v143, 64, v142
    v_add_u32 v244, 65536, v142
    v_add_u32 v245, 65536, v143
    v_bfe_u32 v152, v173, 2, 1
    v_lshlrev_b32 v152, 4, v152
    v_and_b32 v1, 3, v173
    v_add_u32 v152, v152, v1
    v_lshrrev_b32 v1, 3, v173
    v_lshl_add_u32 v152, v1, 2, v152
    v_lshlrev_b32_e64 v152, 4, v152
    v_lshl_add_u32 v152, v174, 10, v152
    s_lshr_b32 s5, s28, 1
    s_lshl_b32 s5, s5, 9
    v_or_b32_e64 v152, s5, v152
    v_xor_b32 v153, 512, v152
    v_lshrrev_b32_e64 v1, 3, v2
    v_mul_u32_u24 v154, 4096, v1
    v_bfe_u32 v1, v2, 4, 1
    v_lshlrev_b32 v1, 2, v1
    v_and_b32 v155, 7, v2
    v_xor_b32_e64 v1, v1, v155
    v_lshl_add_u32 v154, v1, 4, v154
    v_add_u32 v155, 31744, v154
    v_add_u32 v156, 63488, v154
    v_add_u32 v157, 95232, v154
    v_bfe_u32 v1, v2, 2, 2
    v_lshl_add_u32 v1, v174, 3, v1
    v_lshlrev_b32_e64 v158, 7, v1
    v_bfe_u32 v1, v2, 3, 1
    v_lshl_add_u32 v158, v1, 6, v158
    v_bfe_u32 v1, v2, 4, 1
    v_lshl_add_u32 v158, v1, 5, v158
    v_and_b32_e64 v1, 3, v2
    v_lshl_add_u32 v158, v1, 3, v158
    s_and_b32 s5, s28, 1
    s_lshl_b32 s5, s5, 6
    v_xor_b32 v158, s5, v158
    v_add_u32 v158, s67, v158
    v_xor_b32_e64 v159, 64, v158
    v_add_u32 v246, 102400, v158
    v_add_u32 v158, 36864, v158
    v_add_u32 v247, 102400, v159
    v_add_u32 v159, 36864, v159
    v_lshlrev_b32_e64 v160, 4, v173
    v_lshl_add_u32 v160, v174, 10, v160
    s_and_b32 s6, s28, 1
    s_lshl_b32 s7, s6, 9
    v_or_b32_e64 v160, s7, v160
    v_xor_b32 v161, 512, v160
    s_lshl_b32 s7, s6, 5
    v_or_b32 v162, s7, v173
    s_waitcnt vmcnt(10)
    v_readfirstlane_b32 s29, v170
    s_nop 0
    s_mul_i32 s29, s29, 0x9E3779B1
    s_add_u32 s29, s29, 0x7F4A7C15
    v_mov_b32 v170, s29
    s_add_u32 s31, s33, s28
    s_lshl_b32 s31, s31, 7
    s_add_u32 s31, s31, 10158080
    s_waitcnt vmcnt(0)
    s_barrier
    buffer_store_dword v170, v169, s[8:11], s31 offen sc1
    s_sub_u32 s99, s4, 16
    s_lshl_b32 s99, s99, 2
    s_add_u32 s99, s99, s28
    s_add_u32 s99, s99, 32
    s_mul_i32 s100, s99, 9363
    s_lshr_b32 s100, s100, 16
    s_mul_i32 s101, s100, 7
    s_sub_u32 s101, s99, s101
    s_and_b32 s98, s3, 1
    s_lshl_b32 s98, s98, 4
    s_add_u32 s98, s98, s100
    s_mul_i32 s98, s98, 229376
    s_lshr_b32 s100, s3, 1
    s_mul_i32 s100, s100, 7
    s_add_u32 s100, s100, s101
    s_lshl_b32 s100, s100, 7
    s_add_u32 s98, s98, s100
    s_cmp_ge_u32 s99, 112
    s_cselect_b32 s98, 1073741824, s98
    buffer_load_dword v175, v231, s[24:27], s98 offen
    s_sub_u32 s99, s4, 16
    s_lshl_b32 s99, s99, 2
    s_add_u32 s99, s99, s28
    s_add_u32 s99, s99, 64
    s_mul_i32 s100, s99, 9363
    s_lshr_b32 s100, s100, 16
    s_mul_i32 s101, s100, 7
    s_sub_u32 s101, s99, s101
    s_and_b32 s98, s3, 1
    s_lshl_b32 s98, s98, 4
    s_add_u32 s98, s98, s100
    s_mul_i32 s98, s98, 229376
    s_lshr_b32 s100, s3, 1
    s_mul_i32 s100, s100, 7
    s_add_u32 s100, s100, s101
    s_lshl_b32 s100, s100, 7
    s_add_u32 s98, s98, s100
    s_cmp_ge_u32 s99, 112
    s_cselect_b32 s98, 1073741824, s98
    buffer_load_dword v175, v231, s[24:27], s98 offen
    s_branch pre_g2
role_pf:
    v_mul_u32_u24 v231, 3584, v2
    v_lshlrev_b32 v232, 12, v2
    s_waitcnt lgkmcnt(0)
    buffer_load_dword v170, v230, s[8:11], 0 offen sc1
    v_lshlrev_b32 v12, 21, v3
    buffer_load_dword v175, v12, s[8:11], 0 offen offset:64
    buffer_load_dword v175, v12, s[44:47], 0 offen offset:64
    buffer_load_dword v175, v12, s[24:27], 0 offen offset:64
    buffer_load_dword v175, v12, s[60:63], 0 offen offset:64
    v_mul_u32_u24 v1, 3072, v2
    s_sub_u32 s5, s4, 24
    s_mul_i32 s5, s5, 393216
    s_and_b32 s6, s3, 1
    s_lshl_b32 s6, s6, 9
    s_add_u32 s5, s5, s6
    s_lshl_b32 s6, s28, 7
    s_add_u32 s5, s5, s6
    s_add_u32 s6, s5, 196608
    buffer_load_dword v175, v1, s[16:19], s6 offen
    buffer_load_dword v175, v1, s[16:19], s5 offen
    s_sub_u32 s99, s4, 24
    s_lshl_b32 s99, s99, 2
    s_add_u32 s99, s99, s28
    s_add_u32 s99, s99, 96
    s_mul_i32 s100, s99, 9363
    s_lshr_b32 s100, s100, 16
    s_mul_i32 s101, s100, 7
    s_sub_u32 s101, s99, s101
    s_and_b32 s98, s3, 1
    s_lshl_b32 s98, s98, 4
    s_add_u32 s98, s98, s100
    s_mul_i32 s98, s98, 229376
    s_lshr_b32 s100, s3, 1
    s_mul_i32 s100, s100, 7
    s_add_u32 s100, s100, s101
    s_lshl_b32 s100, s100, 7
    s_add_u32 s98, s98, s100
    s_cmp_ge_u32 s99, 112
    s_cselect_b32 s98, 1073741824, s98
    buffer_load_dword v175, v231, s[24:27], s98 offen
    v_mov_b32 v1, 0
    v_cmp_eq_u32 vcc, 0, v2
    v_mov_b32 v169, 1073741824
    s_nop 0
    v_cndmask_b32 v169, v169, v1, vcc
    s_and_b32 s78, s3, 1
    s_and_b32 s6, s4, 3
    s_lshl_b32 s5, s6, 1
    s_add_u32 s76, s5, s78
    s_lshr_b32 s7, s4, 2
    s_mul_i32 s66, s7, 1
    s_add_u32 s66, s66, s5
    s_and_b32 s66, s66, 7
    s_mul_i32 s72, s6, 7
    s_lshr_b32 s72, s72, 2
    s_mul_i32 s5, s7, 1
    s_add_u32 s72, s72, s5
    s_sub_u32 s5, s72, 7
    s_cmp_ge_u32 s72, 7
    s_cselect_b32 s72, s5, s72
    s_lshr_b32 s5, s3, 1
    s_mul_i32 s77, s5, 7
    s_add_u32 s77, s77, s7
    s_lshl_b32 s79, s5, 3
    s_add_u32 s79, s79, s7
    s_lshl_b32 s67, s28, 13
    s_lshl_b32 s80, s76, 18
    s_lshl_b32 s5, s78, 17
    s_add_u32 s80, s80, s5
    s_lshl_b32 s7, s28, 12
    s_add_u32 s80, s80, s7
    s_xor_b32 s64, s80, 0x40000
    s_mul_i32 s65, s28, 114688
    s_mul_i32 s5, s78, 3670016
    s_add_u32 s65, s65, s5
    s_lshl_b32 s5, s77, 7
    s_add_u32 s65, s65, s5
    s_mul_i32 s73, s76, 294912
    s_add_u32 s73, s73, s7
    s_add_u32 s73, s73, 6291456
    s_mul_i32 s5, s78, 114688
    s_add_u32 s81, s73, s5
    s_add_u32 s70, s81, 294912
    s_sub_u32 s5, s81, 294912
    s_cmp_eq_u32 s78, 0
    s_cselect_b32 s70, s70, s5
    s_add_u32 s73, s73, 229376
    s_lshl_b32 s71, s28, 17
    s_mul_i32 s5, s78, 3670016
    s_add_u32 s71, s71, s5
    s_lshl_b32 s5, s79, 7
    s_add_u32 s71, s71, s5
    v_lshlrev_b32 v136, 4, v173
    v_lshl_add_u32 v136, v174, 10, v136
    s_lshr_b32 s5, s28, 1
    s_lshl_b32 s5, s5, 9
    v_or_b32_e64 v136, s5, v136
    v_xor_b32 v137, 512, v136
    v_lshrrev_b32_e64 v1, 3, v2
    v_mul_u32_u24 v138, 3584, v1
    v_bfe_u32 v1, v2, 4, 1
    v_lshlrev_b32 v1, 2, v1
    v_and_b32 v139, 7, v2
    v_xor_b32_e64 v1, v1, v139
    v_lshl_add_u32 v138, v1, 4, v138
    v_add_u32 v139, 27648, v138
    v_add_u32 v140, 55296, v138
    v_add_u32 v141, 82944, v138
    v_bfe_u32 v1, v2, 2, 2
    v_lshl_add_u32 v1, v174, 3, v1
    v_lshlrev_b32_e64 v142, 7, v1
    v_bfe_u32 v1, v2, 3, 1
    v_lshl_add_u32 v142, v1, 6, v142
    v_bfe_u32 v1, v2, 4, 1
    v_lshl_add_u32 v142, v1, 4, v142
    v_and_b32_e64 v1, 1, v2
    v_lshl_add_u32 v142, v1, 5, v142
    v_bfe_u32 v1, v2, 1, 1
    v_lshl_add_u32 v142, v1, 3, v142
    s_and_b32 s5, s28, 1
    s_lshl_b32 s5, s5, 6
    v_xor_b32 v142, s5, v142
    v_add_u32 v142, s67, v142
    v_xor_b32_e64 v143, 64, v142
    v_add_u32 v244, 65536, v142
    v_add_u32 v245, 65536, v143
    v_bfe_u32 v152, v173, 2, 1
    v_lshlrev_b32 v152, 4, v152
    v_and_b32 v1, 3, v173
    v_add_u32 v152, v152, v1
    v_lshrrev_b32 v1, 3, v173
    v_lshl_add_u32 v152, v1, 2, v152
    v_lshlrev_b32_e64 v152, 4, v152
    v_lshl_add_u32 v152, v174, 10, v152
    s_lshr_b32 s5, s28, 1
    s_lshl_b32 s5, s5, 9
    v_or_b32_e64 v152, s5, v152
    v_xor_b32 v153, 512, v152
    v_lshrrev_b32_e64 v1, 3, v2
    v_mul_u32_u24 v154, 4096, v1
    v_bfe_u32 v1, v2, 4, 1
    v_lshlrev_b32 v1, 2, v1
    v_and_b32 v155, 7, v2
    v_xor_b32_e64 v1, v1, v155
    v_lshl_add_u32 v154, v1, 4, v154
    v_add_u32 v155, 31744, v154
    v_add_u32 v156, 63488, v154
    v_add_u32 v157, 95232, v154
    v_bfe_u32 v1, v2, 2, 2
    v_lshl_add_u32 v1, v174, 3, v1
    v_lshlrev_b32_e64 v158, 7, v1
    v_bfe_u32 v1, v2, 3, 1
    v_lshl_add_u32 v158, v1, 6, v158
    v_bfe_u32 v1, v2, 4, 1
    v_lshl_add_u32 v158, v1, 5, v158
    v_and_b32_e64 v1, 3, v2
    v_lshl_add_u32 v158, v1, 3, v158
    s_and_b32 s5, s28, 1
    s_lshl_b32 s5, s5, 6
    v_xor_b32 v158, s5, v158
    v_add_u32 v158, s67, v158
    v_xor_b32_e64 v159, 64, v158
    v_add_u32 v246, 102400, v158
    v_add_u32 v158, 36864, v158
    v_add_u32 v247, 102400, v159
    v_add_u32 v159, 36864, v159
    v_lshlrev_b32_e64 v160, 4, v173
    v_lshl_add_u32 v160, v174, 10, v160
    s_and_b32 s6, s28, 1
    s_lshl_b32 s7, s6, 9
    v_or_b32_e64 v160, s7, v160
    v_xor_b32 v161, 512, v160
    s_lshl_b32 s7, s6, 5
    v_or_b32 v162, s7, v173
    s_waitcnt vmcnt(7)
    v_readfirstlane_b32 s29, v170
    s_nop 0
    s_mul_i32 s29, s29, 0x9E3779B1
    s_add_u32 s29, s29, 0x7F4A7C15
    v_mov_b32 v170, s29
    s_sub_u32 s99, s4, 24
    s_lshl_b32 s99, s99, 2
    s_add_u32 s99, s99, s28
    s_add_u32 s99, s99, 0
    s_sub_u32 s98, s99, 28
    s_mul_i32 s100, s98, 10923
    s_lshr_b32 s100, s100, 16
    s_mul_i32 s101, s100, 6
    s_sub_u32 s101, s98, s101
    s_cmp_ge_u32 s101, 3
    s_addc_u32 s101, s101, 0
    s_and_b32 s98, s99, 1
    s_lshl_b32 s98, s98, 2
    s_add_u32 s98, s98, 3
    s_cmp_lt_u32 s99, 28
    s_cselect_b32 s101, s98, s101
    s_lshr_b32 s98, s99, 1
    s_cmp_lt_u32 s99, 28
    s_cselect_b32 s100, s98, s100
    s_and_b32 s98, s3, 1
    s_mul_i32 s98, s98, 14
    s_add_u32 s98, s98, s100
    s_lshl_b32 s98, s98, 18
    s_lshr_b32 s100, s3, 1
    s_lshl_b32 s100, s100, 3
    s_add_u32 s100, s100, s101
    s_lshl_b32 s100, s100, 7
    s_add_u32 s98, s98, s100
    s_cmp_ge_u32 s99, 112
    s_cselect_b32 s98, 1073741824, s98
    buffer_load_dword v175, v232, s[44:47], s98 offen
    s_sub_u32 s99, s4, 24
    s_lshl_b32 s99, s99, 2
    s_add_u32 s99, s99, s28
    s_add_u32 s99, s99, 16
    s_sub_u32 s98, s99, 28
    s_mul_i32 s100, s98, 10923
    s_lshr_b32 s100, s100, 16
    s_mul_i32 s101, s100, 6
    s_sub_u32 s101, s98, s101
    s_cmp_ge_u32 s101, 3
    s_addc_u32 s101, s101, 0
    s_and_b32 s98, s99, 1
    s_lshl_b32 s98, s98, 2
    s_add_u32 s98, s98, 3
    s_cmp_lt_u32 s99, 28
    s_cselect_b32 s101, s98, s101
    s_lshr_b32 s98, s99, 1
    s_cmp_lt_u32 s99, 28
    s_cselect_b32 s100, s98, s100
    s_and_b32 s98, s3, 1
    s_mul_i32 s98, s98, 14
    s_add_u32 s98, s98, s100
    s_lshl_b32 s98, s98, 18
    s_lshr_b32 s100, s3, 1
    s_lshl_b32 s100, s100, 3
    s_add_u32 s100, s100, s101
    s_lshl_b32 s100, s100, 7
    s_add_u32 s98, s98, s100
    s_cmp_ge_u32 s99, 112
    s_cselect_b32 s98, 1073741824, s98
    buffer_load_dword v175, v232, s[44:47], s98 offen
pre_g2:
    s_add_u32 s68, s66, 0
    s_and_b32 s68, s68, 7
    s_mul_i32 s68, s68, 458752
    s_add_u32 s68, s68, s65
    s_add_u32 m0, s67, 0
    s_nop 0
    buffer_load_dwordx4 v138, s[24:27], s68 offen offset:0 lds
    buffer_load_dwordx4 v139, s[24:27], s68 offen offset:1024 lds
    buffer_load_dwordx4 v140, s[24:27], s68 offen offset:2048 lds
    buffer_load_dwordx4 v141, s[24:27], s68 offen offset:3072 lds
    s_add_u32 s68, s66, 1
    s_and_b32 s68, s68, 7
    s_mul_i32 s68, s68, 458752
    s_add_u32 s68, s68, s65
    s_add_u32 m0, s67, 4096
    s_nop 0
    buffer_load_dwordx4 v138, s[24:27], s68 offen offset:0 lds
    buffer_load_dwordx4 v139, s[24:27], s68 offen offset:1024 lds
    buffer_load_dwordx4 v140, s[24:27], s68 offen offset:2048 lds
    buffer_load_dwordx4 v141, s[24:27], s68 offen offset:3072 lds
    s_add_u32 s68, s66, 2
    s_and_b32 s68, s68, 7
    s_mul_i32 s68, s68, 458752
    s_add_u32 s68, s68, s65
    s_add_u32 m0, s67, 32768
    s_nop 0
    buffer_load_dwordx4 v138, s[24:27], s68 offen offset:0 lds
    buffer_load_dwordx4 v139, s[24:27], s68 offen offset:1024 lds
    buffer_load_dwordx4 v140, s[24:27], s68 offen offset:2048 lds
    buffer_load_dwordx4 v141, s[24:27], s68 offen offset:3072 lds
    s_add_u32 s68, s66, 3
    s_and_b32 s68, s68, 7
    s_mul_i32 s68, s68, 458752
    s_add_u32 s68, s68, s65
    s_add_u32 m0, s67, 36864
    s_nop 0
    buffer_load_dwordx4 v138, s[24:27], s68 offen offset:0 lds
    buffer_load_dwordx4 v139, s[24:27], s68 offen offset:1024 lds
    buffer_load_dwordx4 v140, s[24:27], s68 offen offset:2048 lds
    buffer_load_dwordx4 v141, s[24:27], s68 offen offset:3072 lds
    v_lshlrev_b32 v1, 5, v174
    s_lshl_b32 s5, s77, 7
    s_and_b32 s6, s28, 1
    s_lshl_b32 s6, s6, 6
    s_add_u32 s32, s5, s6
    buffer_load_dwordx4 v[144:147], v1, s[48:51], s32 offen
    buffer_load_dwordx4 v[148:151], v1, s[48:51], s32 offen offset:16
    v_lshrrev_b32 v171, 2, v173
    v_lshlrev_b32 v171, 11, v171
    v_and_b32_e64 v1, 3, v2
    v_lshl_add_u32 v171, v1, 7, v171
    s_lshl_b32 s34, s28, 9
    s_add_u32 s34, s34, 10158080
    s_lshl_b32 s5, s78, 14
    s_add_u32 s34, s34, s5
    buffer_load_dword v172, v171, s[8:11], s34 offen sc1
    s_waitcnt vmcnt(0)
    v_cmp_ne_u32 vcc, s29, v172
    s_nop 1
    s_cbranch_vccnz slow_f1b
back_f1b:
    s_mov_b32 s43, 1073741824
    s_add_u32 s69, s66, 0
    s_and_b32 s69, s69, 7
    s_lshl_b32 s69, s69, 14
    s_add_u32 s69, s69, s64
    buffer_load_dwordx4 a[0:3], v136, s[8:11], s69 offen offset:0 sc1
    buffer_load_dwordx4 a[4:7], v137, s[8:11], s69 offen offset:0 sc1
    buffer_load_dwordx4 a[8:11], v136, s[8:11], s69 offen offset:2048 sc1
    buffer_load_dwordx4 a[12:15], v137, s[8:11], s69 offen offset:2048 sc1
    s_add_u32 s69, s66, 1
    s_and_b32 s69, s69, 7
    s_lshl_b32 s69, s69, 14
    s_add_u32 s69, s69, s64
    buffer_load_dwordx4 a[16:19], v136, s[8:11], s69 offen offset:0 sc1
    buffer_load_dwordx4 a[20:23], v137, s[8:11], s69 offen offset:0 sc1
    buffer_load_dwordx4 a[24:27], v136, s[8:11], s69 offen offset:2048 sc1
    buffer_load_dwordx4 a[28:31], v137, s[8:11], s69 offen offset:2048 sc1
    buffer_store_dword v170, v169, s[8:11], s43 offen sc1
    s_add_u32 s69, s66, 2
    s_and_b32 s69, s69, 7
    s_lshl_b32 s69, s69, 14
    s_add_u32 s69, s69, s64
    buffer_load_dwordx4 a[32:35], v136, s[8:11], s69 offen offset:0 sc1
    buffer_load_dwordx4 a[36:39], v137, s[8:11], s69 offen offset:0 sc1
    buffer_load_dwordx4 a[40:43], v136, s[8:11], s69 offen offset:2048 sc1
    buffer_load_dwordx4 a[44:47], v137, s[8:11], s69 offen offset:2048 sc1
    s_branch g2
role_q:
    s_and_b32 s39, s4, 3
    s_lshl_b32 s39, s39, 1
    s_add_u32 s39, s39, 1
    s_and_b32 s31, s3, 1
    s_lshl_b32 s31, s31, 2
    s_add_u32 s31, s31, s28
    s_lshl_b32 s36, s31, 7
    s_lshl_b32 s38, s28, 13
    s_add_u32 s38, s38, 16384
    v_mul_u32_u24 v128, 3072, v10
    v_bfe_u32 v1, v2, 4, 1
    v_lshlrev_b32 v1, 2, v1
    v_xor_b32_e64 v1, v1, v11
    v_lshl_add_u32 v128, v1, 4, v128
    v_add_u32 v129, 23552, v128
    v_add_u32 v130, 47104, v128
    v_add_u32 v131, 70656, v128
    s_waitcnt lgkmcnt(0)
    s_add_u32 s40, s39, 0
    s_and_b32 s40, s40, 7
    s_mul_i32 s41, s40, 196608
    s_add_u32 s41, s41, s36
    s_lshl_b32 s40, s40, 7
    s_add_u32 s40, s40, s34
    s_add_u32 m0, s37, 0
    s_nop 0
    buffer_load_dwordx4 v6, s[12:15], s40 offen offset:0 lds
    buffer_load_dwordx4 v7, s[12:15], s40 offen offset:1024 lds
    buffer_load_dwordx4 v8, s[12:15], s40 offen offset:2048 lds
    buffer_load_dwordx4 v9, s[12:15], s40 offen offset:3072 lds
    s_add_u32 m0, s38, 0
    s_nop 0
    buffer_load_dwordx4 v128, s[16:19], s41 offen offset:0 lds
    buffer_load_dwordx4 v129, s[16:19], s41 offen offset:1024 lds
    buffer_load_dwordx4 v130, s[16:19], s41 offen offset:2048 lds
    buffer_load_dwordx4 v131, s[16:19], s41 offen offset:3072 lds
    buffer_load_dword v170, v230, s[8:11], 0 offen sc1
    v_mov_b32 v1, 0
    v_cmp_eq_u32 vcc, 0, v2
    v_mov_b32 v169, 1073741824
    s_nop 0
    v_cndmask_b32 v169, v169, v1, vcc
    s_and_b32 s78, s3, 1
    s_and_b32 s6, s4, 3
    s_lshl_b32 s5, s6, 1
    s_add_u32 s76, s5, s78
    s_lshr_b32 s7, s4, 2
    s_mul_i32 s66, s7, 1
    s_add_u32 s66, s66, s5
    s_and_b32 s66, s66, 7
    s_mul_i32 s72, s6, 7
    s_lshr_b32 s72, s72, 2
    s_mul_i32 s5, s7, 1
    s_add_u32 s72, s72, s5
    s_sub_u32 s5, s72, 7
    s_cmp_ge_u32 s72, 7
    s_cselect_b32 s72, s5, s72
    s_lshr_b32 s5, s3, 1
    s_mul_i32 s77, s5, 7
    s_add_u32 s77, s77, s7
    s_lshl_b32 s79, s5, 3
    s_add_u32 s79, s79, s7
    s_lshl_b32 s67, s28, 13
    s_lshl_b32 s80, s76, 18
    s_lshl_b32 s5, s78, 17
    s_add_u32 s80, s80, s5
    s_lshl_b32 s7, s28, 12
    s_add_u32 s80, s80, s7
    s_xor_b32 s64, s80, 0x40000
    s_mul_i32 s65, s28, 114688
    s_mul_i32 s5, s78, 3670016
    s_add_u32 s65, s65, s5
    s_lshl_b32 s5, s77, 7
    s_add_u32 s65, s65, s5
    s_mul_i32 s73, s76, 294912
    s_add_u32 s73, s73, s7
    s_add_u32 s73, s73, 6291456
    s_mul_i32 s5, s78, 114688
    s_add_u32 s81, s73, s5
    s_add_u32 s70, s81, 294912
    s_sub_u32 s5, s81, 294912
    s_cmp_eq_u32 s78, 0
    s_cselect_b32 s70, s70, s5
    s_add_u32 s73, s73, 229376
    s_lshl_b32 s71, s28, 17
    s_mul_i32 s5, s78, 3670016
    s_add_u32 s71, s71, s5
    s_lshl_b32 s5, s79, 7
    s_add_u32 s71, s71, s5
    v_lshlrev_b32_e64 v136, 4, v173
    v_lshl_add_u32 v136, v174, 10, v136
    s_lshr_b32 s5, s28, 1
    s_lshl_b32 s5, s5, 9
    v_or_b32_e64 v136, s5, v136
    v_xor_b32 v137, 512, v136
    v_lshrrev_b32_e64 v1, 3, v2
    v_mul_u32_u24 v138, 3584, v1
    v_bfe_u32 v1, v2, 4, 1
    v_lshlrev_b32 v1, 2, v1
    v_and_b32 v139, 7, v2
    v_xor_b32_e64 v1, v1, v139
    v_lshl_add_u32 v138, v1, 4, v138
    v_add_u32 v139, 27648, v138
    v_add_u32 v140, 55296, v138
    v_add_u32 v141, 82944, v138
    v_bfe_u32 v1, v2, 2, 2
    v_lshl_add_u32 v1, v174, 3, v1
    v_lshlrev_b32_e64 v142, 7, v1
    v_bfe_u32 v1, v2, 3, 1
    v_lshl_add_u32 v142, v1, 6, v142
    v_bfe_u32 v1, v2, 4, 1
    v_lshl_add_u32 v142, v1, 4, v142
    v_and_b32_e64 v1, 1, v2
    v_lshl_add_u32 v142, v1, 5, v142
    v_bfe_u32 v1, v2, 1, 1
    v_lshl_add_u32 v142, v1, 3, v142
    s_and_b32 s5, s28, 1
    s_lshl_b32 s5, s5, 6
    v_xor_b32 v142, s5, v142
    v_add_u32 v142, s67, v142
    v_xor_b32_e64 v143, 64, v142
    v_add_u32 v244, 65536, v142
    v_add_u32 v245, 65536, v143
    v_bfe_u32 v152, v173, 2, 1
    v_lshlrev_b32 v152, 4, v152
    v_and_b32 v1, 3, v173
    v_add_u32 v152, v152, v1
    v_lshrrev_b32 v1, 3, v173
    v_lshl_add_u32 v152, v1, 2, v152
    v_lshlrev_b32_e64 v152, 4, v152
    v_lshl_add_u32 v152, v174, 10, v152
    s_lshr_b32 s5, s28, 1
    s_lshl_b32 s5, s5, 9
    v_or_b32_e64 v152, s5, v152
    v_xor_b32 v153, 512, v152
    v_lshrrev_b32_e64 v1, 3, v2
    v_mul_u32_u24 v154, 4096, v1
    v_bfe_u32 v1, v2, 4, 1
    v_lshlrev_b32 v1, 2, v1
    v_and_b32 v155, 7, v2
    v_xor_b32_e64 v1, v1, v155
    v_lshl_add_u32 v154, v1, 4, v154
    v_add_u32 v155, 31744, v154
    v_add_u32 v156, 63488, v154
    v_add_u32 v157, 95232, v154
    v_bfe_u32 v1, v2, 2, 2
    v_lshl_add_u32 v1, v174, 3, v1
    v_lshlrev_b32_e64 v158, 7, v1
    v_bfe_u32 v1, v2, 3, 1
    v_lshl_add_u32 v158, v1, 6, v158
    v_bfe_u32 v1, v2, 4, 1
    v_lshl_add_u32 v158, v1, 5, v158
    v_and_b32_e64 v1, 3, v2
    v_lshl_add_u32 v158, v1, 3, v158
    s_and_b32 s5, s28, 1
    s_lshl_b32 s5, s5, 6
    v_xor_b32 v158, s5, v158
    v_add_u32 v158, s67, v158
    v_xor_b32_e64 v159, 64, v158
    v_add_u32 v246, 102400, v158
    v_add_u32 v158, 36864, v158
    v_add_u32 v247, 102400, v159
    v_add_u32 v159, 36864, v159
    v_lshlrev_b32_e64 v160, 4, v173
    v_lshl_add_u32 v160, v174, 10, v160
    s_and_b32 s6, s28, 1
    s_lshl_b32 s7, s6, 9
    v_or_b32_e64 v160, s7, v160
    v_xor_b32 v161, 512, v160
    s_lshl_b32 s7, s6, 5
    v_or_b32 v162, s7, v173
    s_and_b32 s5, s28, 1
    s_lshl_b32 s5, s5, 6
    v_xor_b32_e64 v1, s5, v142
    v_add_u32 v132, 16384, v1
    v_xor_b32_e64 v133, 64, v132
    v_add_u32 v134, 65536, v1
    v_xor_b32_e64 v135, 64, v134
    v_add_u32 v136, 114688, v1
    v_xor_b32_e64 v137, 64, v136
    v_bfe_u32 v1, v2, 1, 3
    v_xor_b32 v1, v1, v174
    v_lshlrev_b32 v138, 7, v173
    v_lshl_add_u32 v138, v1, 4, v138
    v_xor_b32 v139, 32, v138
    v_xor_b32 v140, 64, v138
    v_xor_b32 v141, 96, v138
    v_add_u32 v142, 49152, v138
    v_add_u32 v143, 49152, v139
    v_add_u32 v144, 49152, v140
    v_add_u32 v145, 49152, v141
    v_add_u32 v146, 98304, v138
    v_add_u32 v147, 98304, v139
    v_add_u32 v148, 98304, v140
    v_add_u32 v149, 98304, v141
    s_add_u32 m0, s38, 4096
    s_add_u32 s41, s41, 98304
    buffer_load_dwordx4 v128, s[16:19], s41 offen offset:0 lds
    buffer_load_dwordx4 v129, s[16:19], s41 offen offset:1024 lds
    buffer_load_dwordx4 v130, s[16:19], s41 offen offset:2048 lds
    buffer_load_dwordx4 v131, s[16:19], s41 offen offset:3072 lds
    s_waitcnt vmcnt(5)
    s_barrier
    ds_read_b64_tr_b16 v[32:33], v132 offset:0
    ds_read_b64_tr_b16 v[34:35], v132 offset:512
    ds_read_b64_tr_b16 v[36:37], v133 offset:0
    ds_read_b64_tr_b16 v[38:39], v133 offset:512
    ds_read_b128 v[16:19], v138 offset:0
    ds_read_b128 v[20:23], v138 offset:4096
    ds_read_b128 v[24:27], v138 offset:8192
    ds_read_b128 v[28:31], v138 offset:12288
    s_waitcnt lgkmcnt(0)
    v_mfma_f32_32x32x16_bf16 v[64:79], v[32:35], v[16:19], 0
    ds_read_b64_tr_b16 v[56:57], v132 offset:2048
    ds_read_b64_tr_b16 v[58:59], v132 offset:2560
    v_mfma_f32_32x32x16_bf16 v[176:191], v[36:39], v[16:19], 0
    ds_read_b64_tr_b16 v[60:61], v133 offset:2048
    ds_read_b64_tr_b16 v[62:63], v133 offset:2560
    s_add_u32 s40, s39, 1
    s_and_b32 s40, s40, 7
    s_mul_i32 s41, s40, 196608
    s_add_u32 s41, s41, s36
    s_lshl_b32 s40, s40, 7
    s_add_u32 s40, s40, s34
    s_add_u32 m0, s37, 49152
    s_nop 0
    buffer_load_dwordx4 v6, s[12:15], s40 offen offset:0 lds
    v_mfma_f32_32x32x16_bf16 v[80:95], v[32:35], v[20:23], 0
    ds_read_b128 v[40:43], v139 offset:0
    ds_read_b128 v[44:47], v139 offset:4096
    v_mfma_f32_32x32x16_bf16 v[192:207], v[36:39], v[20:23], 0
    ds_read_b128 v[48:51], v139 offset:8192
    ds_read_b128 v[52:55], v139 offset:12288
    buffer_load_dwordx4 v7, s[12:15], s40 offen offset:1024 lds
    v_mfma_f32_32x32x16_bf16 v[96:111], v[32:35], v[24:27], 0
    v_mfma_f32_32x32x16_bf16 v[208:223], v[36:39], v[24:27], 0
    buffer_load_dwordx4 v8, s[12:15], s40 offen offset:2048 lds
    v_mfma_f32_32x32x16_bf16 v[112:127], v[32:35], v[28:31], 0
    v_mfma_f32_32x32x16_bf16 v[224:239], v[36:39], v[28:31], 0
    buffer_load_dwordx4 v9, s[12:15], s40 offen offset:3072 lds
    s_waitcnt vmcnt(4) lgkmcnt(0)
    v_mfma_f32_32x32x16_bf16 v[64:79], v[56:59], v[40:43], v[64:79]
    ds_read_b64_tr_b16 v[32:33], v132 offset:4096
    ds_read_b64_tr_b16 v[34:35], v132 offset:4608
    v_mfma_f32_32x32x16_bf16 v[176:191], v[60:63], v[40:43], v[176:191]
    ds_read_b64_tr_b16 v[36:37], v133 offset:4096
    ds_read_b64_tr_b16 v[38:39], v133 offset:4608
    s_add_u32 m0, s38, 49152
    s_nop 0
    buffer_load_dwordx4 v128, s[16:19], s41 offen offset:0 lds
    v_mfma_f32_32x32x16_bf16 v[80:95], v[56:59], v[44:47], v[80:95]
    ds_read_b128 v[16:19], v140 offset:0
    ds_read_b128 v[20:23], v140 offset:4096
    v_mfma_f32_32x32x16_bf16 v[192:207], v[60:63], v[44:47], v[192:207]
    ds_read_b128 v[24:27], v140 offset:8192
    ds_read_b128 v[28:31], v140 offset:12288
    buffer_load_dwordx4 v129, s[16:19], s41 offen offset:1024 lds
    v_mfma_f32_32x32x16_bf16 v[96:111], v[56:59], v[48:51], v[96:111]
    v_mfma_f32_32x32x16_bf16 v[208:223], v[60:63], v[48:51], v[208:223]
    buffer_load_dwordx4 v130, s[16:19], s41 offen offset:2048 lds
    v_mfma_f32_32x32x16_bf16 v[112:127], v[56:59], v[52:55], v[112:127]
    v_mfma_f32_32x32x16_bf16 v[224:239], v[60:63], v[52:55], v[224:239]
    buffer_load_dwordx4 v131, s[16:19], s41 offen offset:3072 lds
    s_waitcnt lgkmcnt(0)
    v_mfma_f32_32x32x16_bf16 v[64:79], v[32:35], v[16:19], v[64:79]
    ds_read_b64_tr_b16 v[56:57], v132 offset:6144
    ds_read_b64_tr_b16 v[58:59], v132 offset:6656
    v_mfma_f32_32x32x16_bf16 v[176:191], v[36:39], v[16:19], v[176:191]
    ds_read_b64_tr_b16 v[60:61], v133 offset:6144
    ds_read_b64_tr_b16 v[62:63], v133 offset:6656
    s_add_u32 m0, s38, 53248
    s_add_u32 s41, s41, 98304
    buffer_load_dwordx4 v128, s[16:19], s41 offen offset:0 lds
    v_mfma_f32_32x32x16_bf16 v[80:95], v[32:35], v[20:23], v[80:95]
    ds_read_b128 v[40:43], v141 offset:0
    ds_read_b128 v[44:47], v141 offset:4096
    v_mfma_f32_32x32x16_bf16 v[192:207], v[36:39], v[20:23], v[192:207]
    ds_read_b128 v[48:51], v141 offset:8192
    ds_read_b128 v[52:55], v141 offset:12288
    buffer_load_dwordx4 v129, s[16:19], s41 offen offset:1024 lds
    v_mfma_f32_32x32x16_bf16 v[96:111], v[32:35], v[24:27], v[96:111]
    v_mfma_f32_32x32x16_bf16 v[208:223], v[36:39], v[24:27], v[208:223]
    buffer_load_dwordx4 v130, s[16:19], s41 offen offset:2048 lds
    v_mfma_f32_32x32x16_bf16 v[112:127], v[32:35], v[28:31], v[112:127]
    v_mfma_f32_32x32x16_bf16 v[224:239], v[36:39], v[28:31], v[224:239]
    buffer_load_dwordx4 v131, s[16:19], s41 offen offset:3072 lds
    s_waitcnt vmcnt(4) lgkmcnt(0)
    s_barrier
    v_mfma_f32_32x32x16_bf16 v[64:79], v[56:59], v[40:43], v[64:79]
    ds_read_b64_tr_b16 v[32:33], v134 offset:0
    ds_read_b64_tr_b16 v[34:35], v134 offset:512
    v_mfma_f32_32x32x16_bf16 v[176:191], v[60:63], v[40:43], v[176:191]
    ds_read_b64_tr_b16 v[36:37], v135 offset:0
    ds_read_b64_tr_b16 v[38:39], v135 offset:512
    s_add_u32 s40, s39, 2
    s_and_b32 s40, s40, 7
    s_mul_i32 s41, s40, 196608
    s_add_u32 s41, s41, s36
    s_lshl_b32 s40, s40, 7
    s_add_u32 s40, s40, s34
    s_add_u32 m0, s37, 98304
    s_nop 0
    buffer_load_dwordx4 v6, s[12:15], s40 offen offset:0 lds
    v_mfma_f32_32x32x16_bf16 v[80:95], v[56:59], v[44:47], v[80:95]
    ds_read_b128 v[16:19], v142 offset:0
    ds_read_b128 v[20:23], v142 offset:4096
    v_mfma_f32_32x32x16_bf16 v[192:207], v[60:63], v[44:47], v[192:207]
    ds_read_b128 v[24:27], v142 offset:8192
    ds_read_b128 v[28:31], v142 offset:12288
    buffer_load_dwordx4 v7, s[12:15], s40 offen offset:1024 lds
    v_mfma_f32_32x32x16_bf16 v[96:111], v[56:59], v[48:51], v[96:111]
    v_mfma_f32_32x32x16_bf16 v[208:223], v[60:63], v[48:51], v[208:223]
    buffer_load_dwordx4 v8, s[12:15], s40 offen offset:2048 lds
    v_mfma_f32_32x32x16_bf16 v[112:127], v[56:59], v[52:55], v[112:127]
    v_mfma_f32_32x32x16_bf16 v[224:239], v[60:63], v[52:55], v[224:239]
    buffer_load_dwordx4 v9, s[12:15], s40 offen offset:3072 lds
    s_waitcnt lgkmcnt(0)
    v_mfma_f32_32x32x16_bf16 v[64:79], v[32:35], v[16:19], v[64:79]
    ds_read_b64_tr_b16 v[56:57], v134 offset:2048
    ds_read_b64_tr_b16 v[58:59], v134 offset:2560
    v_mfma_f32_32x32x16_bf16 v[176:191], v[36:39], v[16:19], v[176:191]
    ds_read_b64_tr_b16 v[60:61], v135 offset:2048
    ds_read_b64_tr_b16 v[62:63], v135 offset:2560
    s_add_u32 m0, s38, 98304
    s_nop 0
    buffer_load_dwordx4 v128, s[16:19], s41 offen offset:0 lds
    v_mfma_f32_32x32x16_bf16 v[80:95], v[32:35], v[20:23], v[80:95]
    ds_read_b128 v[40:43], v143 offset:0
    ds_read_b128 v[44:47], v143 offset:4096
    v_mfma_f32_32x32x16_bf16 v[192:207], v[36:39], v[20:23], v[192:207]
    ds_read_b128 v[48:51], v143 offset:8192
    ds_read_b128 v[52:55], v143 offset:12288
    buffer_load_dwordx4 v129, s[16:19], s41 offen offset:1024 lds
    v_mfma_f32_32x32x16_bf16 v[96:111], v[32:35], v[24:27], v[96:111]
    v_mfma_f32_32x32x16_bf16 v[208:223], v[36:39], v[24:27], v[208:223]
    buffer_load_dwordx4 v130, s[16:19], s41 offen offset:2048 lds
    v_mfma_f32_32x32x16_bf16 v[112:127], v[32:35], v[28:31], v[112:127]
    v_mfma_f32_32x32x16_bf16 v[224:239], v[36:39], v[28:31], v[224:239]
    buffer_load_dwordx4 v131, s[16:19], s41 offen offset:3072 lds
    s_waitcnt vmcnt(8) lgkmcnt(0)
    v_mfma_f32_32x32x16_bf16 v[64:79], v[56:59], v[40:43], v[64:79]
    ds_read_b64_tr_b16 v[32:33], v134 offset:4096
    ds_read_b64_tr_b16 v[34:35], v134 offset:4608
    v_mfma_f32_32x32x16_bf16 v[176:191], v[60:63], v[40:43], v[176:191]
    ds_read_b64_tr_b16 v[36:37], v135 offset:4096
    ds_read_b64_tr_b16 v[38:39], v135 offset:4608
    s_add_u32 m0, s38, 102400
    s_add_u32 s41, s41, 98304
    buffer_load_dwordx4 v128, s[16:19], s41 offen offset:0 lds
    v_mfma_f32_32x32x16_bf16 v[80:95], v[56:59], v[44:47], v[80:95]
    ds_read_b128 v[16:19], v144 offset:0
    ds_read_b128 v[20:23], v144 offset:4096
    v_mfma_f32_32x32x16_bf16 v[192:207], v[60:63], v[44:47], v[192:207]
    ds_read_b128 v[24:27], v144 offset:8192
    ds_read_b128 v[28:31], v144 offset:12288
    buffer_load_dwordx4 v129, s[16:19], s41 offen offset:1024 lds
    v_mfma_f32_32x32x16_bf16 v[96:111], v[56:59], v[48:51], v[96:111]
    v_mfma_f32_32x32x16_bf16 v[208:223], v[60:63], v[48:51], v[208:223]
    buffer_load_dwordx4 v130, s[16:19], s41 offen offset:2048 lds
    v_mfma_f32_32x32x16_bf16 v[112:127], v[56:59], v[52:55], v[112:127]
    v_mfma_f32_32x32x16_bf16 v[224:239], v[60:63], v[52:55], v[224:239]
    buffer_load_dwordx4 v131, s[16:19], s41 offen offset:3072 lds
    s_waitcnt lgkmcnt(0)
    v_mfma_f32_32x32x16_bf16 v[64:79], v[32:35], v[16:19], v[64:79]
    ds_read_b64_tr_b16 v[56:57], v134 offset:6144
    ds_read_b64_tr_b16 v[58:59], v134 offset:6656
    v_mfma_f32_32x32x16_bf16 v[176:191], v[36:39], v[16:19], v[176:191]
    ds_read_b64_tr_b16 v[60:61], v135 offset:6144
    ds_read_b64_tr_b16 v[62:63], v135 offset:6656
    s_add_u32 s40, s39, 3
    s_and_b32 s40, s40, 7
    s_mul_i32 s41, s40, 196608
    s_add_u32 s41, s41, s36
    s_lshl_b32 s40, s40, 7
    s_add_u32 s40, s40, s34
    s_add_u32 m0, s37, 0
    s_nop 0
    buffer_load_dwordx4 v6, s[12:15], s40 offen offset:0 lds
    v_mfma_f32_32x32x16_bf16 v[80:95], v[32:35], v[20:23], v[80:95]
    ds_read_b128 v[40:43], v145 offset:0
    ds_read_b128 v[44:47], v145 offset:4096
    v_mfma_f32_32x32x16_bf16 v[192:207], v[36:39], v[20:23], v[192:207]
    ds_read_b128 v[48:51], v145 offset:8192
    ds_read_b128 v[52:55], v145 offset:12288
    buffer_load_dwordx4 v7, s[12:15], s40 offen offset:1024 lds
    v_mfma_f32_32x32x16_bf16 v[96:111], v[32:35], v[24:27], v[96:111]
    v_mfma_f32_32x32x16_bf16 v[208:223], v[36:39], v[24:27], v[208:223]
    buffer_load_dwordx4 v8, s[12:15], s40 offen offset:2048 lds
    v_mfma_f32_32x32x16_bf16 v[112:127], v[32:35], v[28:31], v[112:127]
    v_mfma_f32_32x32x16_bf16 v[224:239], v[36:39], v[28:31], v[224:239]
    buffer_load_dwordx4 v9, s[12:15], s40 offen offset:3072 lds
    s_waitcnt vmcnt(8) lgkmcnt(0)
    s_barrier
    v_readfirstlane_b32 s29, v170
    s_nop 0
    s_mul_i32 s29, s29, 0x9E3779B1
    s_add_u32 s29, s29, 0x7F4A7C15
    v_mov_b32 v170, s29
    v_mfma_f32_32x32x16_bf16 v[64:79], v[56:59], v[40:43], v[64:79]
    ds_read_b64_tr_b16 v[32:33], v136 offset:0
    ds_read_b64_tr_b16 v[34:35], v136 offset:512
    v_mfma_f32_32x32x16_bf16 v[176:191], v[60:63], v[40:43], v[176:191]
    ds_read_b64_tr_b16 v[36:37], v137 offset:0
    ds_read_b64_tr_b16 v[38:39], v137 offset:512
    s_add_u32 m0, s38, 0
    s_nop 0
    buffer_load_dwordx4 v128, s[16:19], s41 offen offset:0 lds
    v_mfma_f32_32x32x16_bf16 v[80:95], v[56:59], v[44:47], v[80:95]
    ds_read_b128 v[16:19], v146 offset:0
    ds_read_b128 v[20:23], v146 offset:4096
    v_mfma_f32_32x32x16_bf16 v[192:207], v[60:63], v[44:47], v[192:207]
    ds_read_b128 v[24:27], v146 offset:8192
    ds_read_b128 v[28:31], v146 offset:12288
    buffer_load_dwordx4 v129, s[16:19], s41 offen offset:1024 lds
    v_mfma_f32_32x32x16_bf16 v[96:111], v[56:59], v[48:51], v[96:111]
    v_mfma_f32_32x32x16_bf16 v[208:223], v[60:63], v[48:51], v[208:223]
    buffer_load_dwordx4 v130, s[16:19], s41 offen offset:2048 lds
    v_mfma_f32_32x32x16_bf16 v[112:127], v[56:59], v[52:55], v[112:127]
    v_mfma_f32_32x32x16_bf16 v[224:239], v[60:63], v[52:55], v[224:239]
    buffer_load_dwordx4 v131, s[16:19], s41 offen offset:3072 lds
    s_waitcnt lgkmcnt(0)
    v_mfma_f32_32x32x16_bf16 v[64:79], v[32:35], v[16:19], v[64:79]
    ds_read_b64_tr_b16 v[56:57], v136 offset:2048
    ds_read_b64_tr_b16 v[58:59], v136 offset:2560
    v_mfma_f32_32x32x16_bf16 v[176:191], v[36:39], v[16:19], v[176:191]
    ds_read_b64_tr_b16 v[60:61], v137 offset:2048
    ds_read_b64_tr_b16 v[62:63], v137 offset:2560
    s_add_u32 m0, s38, 4096
    s_add_u32 s41, s41, 98304
    buffer_load_dwordx4 v128, s[16:19], s41 offen offset:0 lds
    v_mfma_f32_32x32x16_bf16 v[80:95], v[32:35], v[20:23], v[80:95]
    ds_read_b128 v[40:43], v147 offset:0
    ds_read_b128 v[44:47], v147 offset:4096
    v_mfma_f32_32x32x16_bf16 v[192:207], v[36:39], v[20:23], v[192:207]
    ds_read_b128 v[48:51], v147 offset:8192
    ds_read_b128 v[52:55], v147 offset:12288
    buffer_load_dwordx4 v129, s[16:19], s41 offen offset:1024 lds
    v_mfma_f32_32x32x16_bf16 v[96:111], v[32:35], v[24:27], v[96:111]
    v_mfma_f32_32x32x16_bf16 v[208:223], v[36:39], v[24:27], v[208:223]
    buffer_load_dwordx4 v130, s[16:19], s41 offen offset:2048 lds
    v_mfma_f32_32x32x16_bf16 v[112:127], v[32:35], v[28:31], v[112:127]
    v_mfma_f32_32x32x16_bf16 v[224:239], v[36:39], v[28:31], v[224:239]
    buffer_load_dwordx4 v131, s[16:19], s41 offen offset:3072 lds
    s_waitcnt vmcnt(12) lgkmcnt(0)
    v_mfma_f32_32x32x16_bf16 v[64:79], v[56:59], v[40:43], v[64:79]
    ds_read_b64_tr_b16 v[32:33], v136 offset:4096
    ds_read_b64_tr_b16 v[34:35], v136 offset:4608
    v_mfma_f32_32x32x16_bf16 v[176:191], v[60:63], v[40:43], v[176:191]
    ds_read_b64_tr_b16 v[36:37], v137 offset:4096
    ds_read_b64_tr_b16 v[38:39], v137 offset:4608
    s_add_u32 s40, s39, 4
    s_and_b32 s40, s40, 7
    s_mul_i32 s41, s40, 196608
    s_add_u32 s41, s41, s36
    s_lshl_b32 s40, s40, 7
    s_add_u32 s40, s40, s34
    s_add_u32 m0, s37, 49152
    s_nop 0
    buffer_load_dwordx4 v6, s[12:15], s40 offen offset:0 lds
    v_mfma_f32_32x32x16_bf16 v[80:95], v[56:59], v[44:47], v[80:95]
    ds_read_b128 v[16:19], v148 offset:0
    ds_read_b128 v[20:23], v148 offset:4096
    v_mfma_f32_32x32x16_bf16 v[192:207], v[60:63], v[44:47], v[192:207]
    ds_read_b128 v[24:27], v148 offset:8192
    ds_read_b128 v[28:31], v148 offset:12288
    buffer_load_dwordx4 v7, s[12:15], s40 offen offset:1024 lds
    v_mfma_f32_32x32x16_bf16 v[96:111], v[56:59], v[48:51], v[96:111]
    v_mfma_f32_32x32x16_bf16 v[208:223], v[60:63], v[48:51], v[208:223]
    buffer_load_dwordx4 v8, s[12:15], s40 offen offset:2048 lds
    v_mfma_f32_32x32x16_bf16 v[112:127], v[56:59], v[52:55], v[112:127]
    v_mfma_f32_32x32x16_bf16 v[224:239], v[60:63], v[52:55], v[224:239]
    buffer_load_dwordx4 v9, s[12:15], s40 offen offset:3072 lds
    s_waitcnt lgkmcnt(0)
    v_mfma_f32_32x32x16_bf16 v[64:79], v[32:35], v[16:19], v[64:79]
    ds_read_b64_tr_b16 v[56:57], v136 offset:6144
    ds_read_b64_tr_b16 v[58:59], v136 offset:6656
    v_mfma_f32_32x32x16_bf16 v[176:191], v[36:39], v[16:19], v[176:191]
    ds_read_b64_tr_b16 v[60:61], v137 offset:6144
    ds_read_b64_tr_b16 v[62:63], v137 offset:6656
    s_add_u32 m0, s38, 49152
    s_nop 0
    buffer_load_dwordx4 v128, s[16:19], s41 offen offset:0 lds
    v_mfma_f32_32x32x16_bf16 v[80:95], v[32:35], v[20:23], v[80:95]
    ds_read_b128 v[40:43], v149 offset:0
    ds_read_b128 v[44:47], v149 offset:4096
    v_mfma_f32_32x32x16_bf16 v[192:207], v[36:39], v[20:23], v[192:207]
    ds_read_b128 v[48:51], v149 offset:8192
    ds_read_b128 v[52:55], v149 offset:12288
    buffer_load_dwordx4 v129, s[16:19], s41 offen offset:1024 lds
    v_mfma_f32_32x32x16_bf16 v[96:111], v[32:35], v[24:27], v[96:111]
    v_mfma_f32_32x32x16_bf16 v[208:223], v[36:39], v[24:27], v[208:223]
    buffer_load_dwordx4 v130, s[16:19], s41 offen offset:2048 lds
    v_mfma_f32_32x32x16_bf16 v[112:127], v[32:35], v[28:31], v[112:127]
    v_mfma_f32_32x32x16_bf16 v[224:239], v[36:39], v[28:31], v[224:239]
    buffer_load_dwordx4 v131, s[16:19], s41 offen offset:3072 lds
    s_waitcnt vmcnt(12) lgkmcnt(0)
    s_barrier
    v_mfma_f32_32x32x16_bf16 v[64:79], v[56:59], v[40:43], v[64:79]
    ds_read_b64_tr_b16 v[32:33], v132 offset:0
    ds_read_b64_tr_b16 v[34:35], v132 offset:512
    v_mfma_f32_32x32x16_bf16 v[176:191], v[60:63], v[40:43], v[176:191]
    ds_read_b64_tr_b16 v[36:37], v133 offset:0
    ds_read_b64_tr_b16 v[38:39], v133 offset:512
    s_add_u32 m0, s38, 53248
    s_add_u32 s41, s41, 98304
    buffer_load_dwordx4 v128, s[16:19], s41 offen offset:0 lds
    v_mfma_f32_32x32x16_bf16 v[80:95], v[56:59], v[44:47], v[80:95]
    ds_read_b128 v[16:19], v138 offset:0
    ds_read_b128 v[20:23], v138 offset:4096
    v_mfma_f32_32x32x16_bf16 v[192:207], v[60:63], v[44:47], v[192:207]
    ds_read_b128 v[24:27], v138 offset:8192
    ds_read_b128 v[28:31], v138 offset:12288
    buffer_load_dwordx4 v129, s[16:19], s41 offen offset:1024 lds
    v_mfma_f32_32x32x16_bf16 v[96:111], v[56:59], v[48:51], v[96:111]
    v_mfma_f32_32x32x16_bf16 v[208:223], v[60:63], v[48:51], v[208:223]
    buffer_load_dwordx4 v130, s[16:19], s41 offen offset:2048 lds
    v_mfma_f32_32x32x16_bf16 v[112:127], v[56:59], v[52:55], v[112:127]
    v_mfma_f32_32x32x16_bf16 v[224:239], v[60:63], v[52:55], v[224:239]
    buffer_load_dwordx4 v131, s[16:19], s41 offen offset:3072 lds
    s_waitcnt lgkmcnt(0)
    v_mfma_f32_32x32x16_bf16 v[64:79], v[32:35], v[16:19], v[64:79]
    ds_read_b64_tr_b16 v[56:57], v132 offset:2048
    ds_read_b64_tr_b16 v[58:59], v132 offset:2560
    v_mfma_f32_32x32x16_bf16 v[176:191], v[36:39], v[16:19], v[176:191]
    ds_read_b64_tr_b16 v[60:61], v133 offset:2048
    ds_read_b64_tr_b16 v[62:63], v133 offset:2560
    s_add_u32 s40, s39, 5
    s_and_b32 s40, s40, 7
    s_mul_i32 s41, s40, 196608
    s_add_u32 s41, s41, s36
    s_lshl_b32 s40, s40, 7
    s_add_u32 s40, s40, s34
    s_add_u32 m0, s37, 98304
    s_nop 0
    buffer_load_dwordx4 v6, s[12:15], s40 offen offset:0 lds
    v_mfma_f32_32x32x16_bf16 v[80:95], v[32:35], v[20:23], v[80:95]
    ds_read_b128 v[40:43], v139 offset:0
    ds_read_b128 v[44:47], v139 offset:4096
    v_mfma_f32_32x32x16_bf16 v[192:207], v[36:39], v[20:23], v[192:207]
    ds_read_b128 v[48:51], v139 offset:8192
    ds_read_b128 v[52:55], v139 offset:12288
    buffer_load_dwordx4 v7, s[12:15], s40 offen offset:1024 lds
    v_mfma_f32_32x32x16_bf16 v[96:111], v[32:35], v[24:27], v[96:111]
    v_mfma_f32_32x32x16_bf16 v[208:223], v[36:39], v[24:27], v[208:223]
    buffer_load_dwordx4 v8, s[12:15], s40 offen offset:2048 lds
    v_mfma_f32_32x32x16_bf16 v[112:127], v[32:35], v[28:31], v[112:127]
    v_mfma_f32_32x32x16_bf16 v[224:239], v[36:39], v[28:31], v[224:239]
    buffer_load_dwordx4 v9, s[12:15], s40 offen offset:3072 lds
    s_waitcnt vmcnt(16) lgkmcnt(0)
    v_mfma_f32_32x32x16_bf16 v[64:79], v[56:59], v[40:43], v[64:79]
    ds_read_b64_tr_b16 v[32:33], v132 offset:4096
    ds_read_b64_tr_b16 v[34:35], v132 offset:4608
    v_mfma_f32_32x32x16_bf16 v[176:191], v[60:63], v[40:43], v[176:191]
    ds_read_b64_tr_b16 v[36:37], v133 offset:4096
    ds_read_b64_tr_b16 v[38:39], v133 offset:4608
    s_add_u32 m0, s38, 98304
    s_nop 0
    buffer_load_dwordx4 v128, s[16:19], s41 offen offset:0 lds
    v_mfma_f32_32x32x16_bf16 v[80:95], v[56:59], v[44:47], v[80:95]
    ds_read_b128 v[16:19], v140 offset:0
    ds_read_b128 v[20:23], v140 offset:4096
    v_mfma_f32_32x32x16_bf16 v[192:207], v[60:63], v[44:47], v[192:207]
    ds_read_b128 v[24:27], v140 offset:8192
    ds_read_b128 v[28:31], v140 offset:12288
    buffer_load_dwordx4 v129, s[16:19], s41 offen offset:1024 lds
    v_mfma_f32_32x32x16_bf16 v[96:111], v[56:59], v[48:51], v[96:111]
    v_mfma_f32_32x32x16_bf16 v[208:223], v[60:63], v[48:51], v[208:223]
    buffer_load_dwordx4 v130, s[16:19], s41 offen offset:2048 lds
    v_mfma_f32_32x32x16_bf16 v[112:127], v[56:59], v[52:55], v[112:127]
    v_mfma_f32_32x32x16_bf16 v[224:239], v[60:63], v[52:55], v[224:239]
    buffer_load_dwordx4 v131, s[16:19], s41 offen offset:3072 lds
    s_waitcnt lgkmcnt(0)
    v_mfma_f32_32x32x16_bf16 v[64:79], v[32:35], v[16:19], v[64:79]
    ds_read_b64_tr_b16 v[56:57], v132 offset:6144
    ds_read_b64_tr_b16 v[58:59], v132 offset:6656
    v_mfma_f32_32x32x16_bf16 v[176:191], v[36:39], v[16:19], v[176:191]
    ds_read_b64_tr_b16 v[60:61], v133 offset:6144
    ds_read_b64_tr_b16 v[62:63], v133 offset:6656
    s_add_u32 m0, s38, 102400
    s_add_u32 s41, s41, 98304
    buffer_load_dwordx4 v128, s[16:19], s41 offen offset:0 lds
    v_mfma_f32_32x32x16_bf16 v[80:95], v[32:35], v[20:23], v[80:95]
    ds_read_b128 v[40:43], v141 offset:0
    ds_read_b128 v[44:47], v141 offset:4096
    v_mfma_f32_32x32x16_bf16 v[192:207], v[36:39], v[20:23], v[192:207]
    ds_read_b128 v[48:51], v141 offset:8192
    ds_read_b128 v[52:55], v141 offset:12288
    buffer_load_dwordx4 v129, s[16:19], s41 offen offset:1024 lds
    v_mfma_f32_32x32x16_bf16 v[96:111], v[32:35], v[24:27], v[96:111]
    v_mfma_f32_32x32x16_bf16 v[208:223], v[36:39], v[24:27], v[208:223]
    buffer_load_dwordx4 v130, s[16:19], s41 offen offset:2048 lds
    v_mfma_f32_32x32x16_bf16 v[112:127], v[32:35], v[28:31], v[112:127]
    v_mfma_f32_32x32x16_bf16 v[224:239], v[36:39], v[28:31], v[224:239]
    buffer_load_dwordx4 v131, s[16:19], s41 offen offset:3072 lds
    s_waitcnt vmcnt(16) lgkmcnt(0)
    s_barrier
    v_mfma_f32_32x32x16_bf16 v[64:79], v[56:59], v[40:43], v[64:79]
    ds_read_b64_tr_b16 v[32:33], v134 offset:0
    ds_read_b64_tr_b16 v[34:35], v134 offset:512
    v_mfma_f32_32x32x16_bf16 v[176:191], v[60:63], v[40:43], v[176:191]
    ds_read_b64_tr_b16 v[36:37], v135 offset:0
    ds_read_b64_tr_b16 v[38:39], v135 offset:512
    s_add_u32 s40, s39, 6
    s_and_b32 s40, s40, 7
    s_mul_i32 s41, s40, 196608
    s_add_u32 s41, s41, s36
    s_lshl_b32 s40, s40, 7
    s_add_u32 s40, s40, s34
    s_add_u32 m0, s37, 0
    s_nop 0
    buffer_load_dwordx4 v6, s[12:15], s40 offen offset:0 lds
    v_mfma_f32_32x32x16_bf16 v[80:95], v[56:59], v[44:47], v[80:95]
    ds_read_b128 v[16:19], v142 offset:0
    ds_read_b128 v[20:23], v142 offset:4096
    v_mfma_f32_32x32x16_bf16 v[192:207], v[60:63], v[44:47], v[192:207]
    ds_read_b128 v[24:27], v142 offset:8192
    ds_read_b128 v[28:31], v142 offset:12288
    buffer_load_dwordx4 v7, s[12:15], s40 offen offset:1024 lds
    v_mfma_f32_32x32x16_bf16 v[96:111], v[56:59], v[48:51], v[96:111]
    v_mfma_f32_32x32x16_bf16 v[208:223], v[60:63], v[48:51], v[208:223]
    buffer_load_dwordx4 v8, s[12:15], s40 offen offset:2048 lds
    v_mfma_f32_32x32x16_bf16 v[112:127], v[56:59], v[52:55], v[112:127]
    v_mfma_f32_32x32x16_bf16 v[224:239], v[60:63], v[52:55], v[224:239]
    buffer_load_dwordx4 v9, s[12:15], s40 offen offset:3072 lds
    s_waitcnt lgkmcnt(0)
    v_mfma_f32_32x32x16_bf16 v[64:79], v[32:35], v[16:19], v[64:79]
    ds_read_b64_tr_b16 v[56:57], v134 offset:2048
    ds_read_b64_tr_b16 v[58:59], v134 offset:2560
    v_mfma_f32_32x32x16_bf16 v[176:191], v[36:39], v[16:19], v[176:191]
    ds_read_b64_tr_b16 v[60:61], v135 offset:2048
    ds_read_b64_tr_b16 v[62:63], v135 offset:2560
    s_add_u32 m0, s38, 0
    s_nop 0
    buffer_load_dwordx4 v128, s[16:19], s41 offen offset:0 lds
    v_mfma_f32_32x32x16_bf16 v[80:95], v[32:35], v[20:23], v[80:95]
    ds_read_b128 v[40:43], v143 offset:0
    ds_read_b128 v[44:47], v143 offset:4096
    v_mfma_f32_32x32x16_bf16 v[192:207], v[36:39], v[20:23], v[192:207]
    ds_read_b128 v[48:51], v143 offset:8192
    ds_read_b128 v[52:55], v143 offset:12288
    buffer_load_dwordx4 v129, s[16:19], s41 offen offset:1024 lds
    v_mfma_f32_32x32x16_bf16 v[96:111], v[32:35], v[24:27], v[96:111]
    v_mfma_f32_32x32x16_bf16 v[208:223], v[36:39], v[24:27], v[208:223]
    buffer_load_dwordx4 v130, s[16:19], s41 offen offset:2048 lds
    v_mfma_f32_32x32x16_bf16 v[112:127], v[32:35], v[28:31], v[112:127]
    v_mfma_f32_32x32x16_bf16 v[224:239], v[36:39], v[28:31], v[224:239]
    buffer_load_dwordx4 v131, s[16:19], s41 offen offset:3072 lds
    s_waitcnt vmcnt(20) lgkmcnt(0)
    v_mfma_f32_32x32x16_bf16 v[64:79], v[56:59], v[40:43], v[64:79]
    ds_read_b64_tr_b16 v[32:33], v134 offset:4096
    ds_read_b64_tr_b16 v[34:35], v134 offset:4608
    v_mfma_f32_32x32x16_bf16 v[176:191], v[60:63], v[40:43], v[176:191]
    ds_read_b64_tr_b16 v[36:37], v135 offset:4096
    ds_read_b64_tr_b16 v[38:39], v135 offset:4608
    s_add_u32 m0, s38, 4096
    s_add_u32 s41, s41, 98304
    buffer_load_dwordx4 v128, s[16:19], s41 offen offset:0 lds
    v_mfma_f32_32x32x16_bf16 v[80:95], v[56:59], v[44:47], v[80:95]
    ds_read_b128 v[16:19], v144 offset:0
    ds_read_b128 v[20:23], v144 offset:4096
    v_mfma_f32_32x32x16_bf16 v[192:207], v[60:63], v[44:47], v[192:207]
    ds_read_b128 v[24:27], v144 offset:8192
    ds_read_b128 v[28:31], v144 offset:12288
    buffer_load_dwordx4 v129, s[16:19], s41 offen offset:1024 lds
    v_mfma_f32_32x32x16_bf16 v[96:111], v[56:59], v[48:51], v[96:111]
    v_mfma_f32_32x32x16_bf16 v[208:223], v[60:63], v[48:51], v[208:223]
    buffer_load_dwordx4 v130, s[16:19], s41 offen offset:2048 lds
    v_mfma_f32_32x32x16_bf16 v[112:127], v[56:59], v[52:55], v[112:127]
    v_mfma_f32_32x32x16_bf16 v[224:239], v[60:63], v[52:55], v[224:239]
    buffer_load_dwordx4 v131, s[16:19], s41 offen offset:3072 lds
    s_waitcnt lgkmcnt(0)
    v_mfma_f32_32x32x16_bf16 v[64:79], v[32:35], v[16:19], v[64:79]
    ds_read_b64_tr_b16 v[56:57], v134 offset:6144
    ds_read_b64_tr_b16 v[58:59], v134 offset:6656
    v_mfma_f32_32x32x16_bf16 v[176:191], v[36:39], v[16:19], v[176:191]
    ds_read_b64_tr_b16 v[60:61], v135 offset:6144
    ds_read_b64_tr_b16 v[62:63], v135 offset:6656
    v_mfma_f32_32x32x16_bf16 v[80:95], v[32:35], v[20:23], v[80:95]
    ds_read_b128 v[40:43], v145 offset:0
    ds_read_b128 v[44:47], v145 offset:4096
    v_mfma_f32_32x32x16_bf16 v[192:207], v[36:39], v[20:23], v[192:207]
    ds_read_b128 v[48:51], v145 offset:8192
    ds_read_b128 v[52:55], v145 offset:12288
    v_mfma_f32_32x32x16_bf16 v[96:111], v[32:35], v[24:27], v[96:111]
    v_mfma_f32_32x32x16_bf16 v[208:223], v[36:39], v[24:27], v[208:223]
    v_mfma_f32_32x32x16_bf16 v[112:127], v[32:35], v[28:31], v[112:127]
    v_mfma_f32_32x32x16_bf16 v[224:239], v[36:39], v[28:31], v[224:239]
    s_waitcnt vmcnt(16) lgkmcnt(0)
    s_barrier
    v_mfma_f32_32x32x16_bf16 v[64:79], v[56:59], v[40:43], v[64:79]
    ds_read_b64_tr_b16 v[32:33], v136 offset:0
    ds_read_b64_tr_b16 v[34:35], v136 offset:512
    v_mfma_f32_32x32x16_bf16 v[176:191], v[60:63], v[40:43], v[176:191]
    ds_read_b64_tr_b16 v[36:37], v137 offset:0
    ds_read_b64_tr_b16 v[38:39], v137 offset:512
    s_add_u32 s40, s39, 7
    s_and_b32 s40, s40, 7
    s_mul_i32 s41, s40, 196608
    s_add_u32 s41, s41, s36
    s_lshl_b32 s40, s40, 7
    s_add_u32 s40, s40, s34
    s_add_u32 m0, s37, 49152
    s_nop 0
    buffer_load_dwordx4 v6, s[12:15], s40 offen offset:0 lds
    v_mfma_f32_32x32x16_bf16 v[80:95], v[56:59], v[44:47], v[80:95]
    ds_read_b128 v[16:19], v146 offset:0
    ds_read_b128 v[20:23], v146 offset:4096
    v_mfma_f32_32x32x16_bf16 v[192:207], v[60:63], v[44:47], v[192:207]
    ds_read_b128 v[24:27], v146 offset:8192
    ds_read_b128 v[28:31], v146 offset:12288
    buffer_load_dwordx4 v7, s[12:15], s40 offen offset:1024 lds
    v_mfma_f32_32x32x16_bf16 v[96:111], v[56:59], v[48:51], v[96:111]
    v_mfma_f32_32x32x16_bf16 v[208:223], v[60:63], v[48:51], v[208:223]
    buffer_load_dwordx4 v8, s[12:15], s40 offen offset:2048 lds
    v_mfma_f32_32x32x16_bf16 v[112:127], v[56:59], v[52:55], v[112:127]
    v_mfma_f32_32x32x16_bf16 v[224:239], v[60:63], v[52:55], v[224:239]
    buffer_load_dwordx4 v9, s[12:15], s40 offen offset:3072 lds
    s_waitcnt lgkmcnt(0)
    v_mfma_f32_32x32x16_bf16 v[64:79], v[32:35], v[16:19], v[64:79]
    ds_read_b64_tr_b16 v[56:57], v136 offset:2048
    ds_read_b64_tr_b16 v[58:59], v136 offset:2560
    v_mfma_f32_32x32x16_bf16 v[176:191], v[36:39], v[16:19], v[176:191]
    ds_read_b64_tr_b16 v[60:61], v137 offset:2048
    ds_read_b64_tr_b16 v[62:63], v137 offset:2560
    s_add_u32 m0, s38, 49152
    s_nop 0
    buffer_load_dwordx4 v128, s[16:19], s41 offen offset:0 lds
    v_mfma_f32_32x32x16_bf16 v[80:95], v[32:35], v[20:23], v[80:95]
    ds_read_b128 v[40:43], v147 offset:0
    ds_read_b128 v[44:47], v147 offset:4096
    v_mfma_f32_32x32x16_bf16 v[192:207], v[36:39], v[20:23], v[192:207]
    ds_read_b128 v[48:51], v147 offset:8192
    ds_read_b128 v[52:55], v147 offset:12288
    buffer_load_dwordx4 v129, s[16:19], s41 offen offset:1024 lds
    v_mfma_f32_32x32x16_bf16 v[96:111], v[32:35], v[24:27], v[96:111]
    v_mfma_f32_32x32x16_bf16 v[208:223], v[36:39], v[24:27], v[208:223]
    buffer_load_dwordx4 v130, s[16:19], s41 offen offset:2048 lds
    v_mfma_f32_32x32x16_bf16 v[112:127], v[32:35], v[28:31], v[112:127]
    v_mfma_f32_32x32x16_bf16 v[224:239], v[36:39], v[28:31], v[224:239]
    buffer_load_dwordx4 v131, s[16:19], s41 offen offset:3072 lds
    s_waitcnt vmcnt(20) lgkmcnt(0)
    v_mfma_f32_32x32x16_bf16 v[64:79], v[56:59], v[40:43], v[64:79]
    ds_read_b64_tr_b16 v[32:33], v136 offset:4096
    ds_read_b64_tr_b16 v[34:35], v136 offset:4608
    v_mfma_f32_32x32x16_bf16 v[176:191], v[60:63], v[40:43], v[176:191]
    ds_read_b64_tr_b16 v[36:37], v137 offset:4096
    ds_read_b64_tr_b16 v[38:39], v137 offset:4608
    s_add_u32 m0, s38, 53248
    s_add_u32 s41, s41, 98304
    buffer_load_dwordx4 v128, s[16:19], s41 offen offset:0 lds
    v_mfma_f32_32x32x16_bf16 v[80:95], v[56:59], v[44:47], v[80:95]
    ds_read_b128 v[16:19], v148 offset:0
    ds_read_b128 v[20:23], v148 offset:4096
    v_mfma_f32_32x32x16_bf16 v[192:207], v[60:63], v[44:47], v[192:207]
    ds_read_b128 v[24:27], v148 offset:8192
    ds_read_b128 v[28:31], v148 offset:12288
    buffer_load_dwordx4 v129, s[16:19], s41 offen offset:1024 lds
    v_mfma_f32_32x32x16_bf16 v[96:111], v[56:59], v[48:51], v[96:111]
    v_mfma_f32_32x32x16_bf16 v[208:223], v[60:63], v[48:51], v[208:223]
    buffer_load_dwordx4 v130, s[16:19], s41 offen offset:2048 lds
    v_mfma_f32_32x32x16_bf16 v[112:127], v[56:59], v[52:55], v[112:127]
    v_mfma_f32_32x32x16_bf16 v[224:239], v[60:63], v[52:55], v[224:239]
    buffer_load_dwordx4 v131, s[16:19], s41 offen offset:3072 lds
    s_waitcnt lgkmcnt(0)
    v_mfma_f32_32x32x16_bf16 v[64:79], v[32:35], v[16:19], v[64:79]
    ds_read_b64_tr_b16 v[56:57], v136 offset:6144
    ds_read_b64_tr_b16 v[58:59], v136 offset:6656
    v_mfma_f32_32x32x16_bf16 v[176:191], v[36:39], v[16:19], v[176:191]
    ds_read_b64_tr_b16 v[60:61], v137 offset:6144
    ds_read_b64_tr_b16 v[62:63], v137 offset:6656
    v_mfma_f32_32x32x16_bf16 v[80:95], v[32:35], v[20:23], v[80:95]
    ds_read_b128 v[40:43], v149 offset:0
    ds_read_b128 v[44:47], v149 offset:4096
    v_mfma_f32_32x32x16_bf16 v[192:207], v[36:39], v[20:23], v[192:207]
    ds_read_b128 v[48:51], v149 offset:8192
    ds_read_b128 v[52:55], v149 offset:12288
    v_mfma_f32_32x32x16_bf16 v[96:111], v[32:35], v[24:27], v[96:111]
    v_mfma_f32_32x32x16_bf16 v[208:223], v[36:39], v[24:27], v[208:223]
    v_mfma_f32_32x32x16_bf16 v[112:127], v[32:35], v[28:31], v[112:127]
    v_mfma_f32_32x32x16_bf16 v[224:239], v[36:39], v[28:31], v[224:239]
    s_waitcnt vmcnt(16) lgkmcnt(0)
    s_barrier
    s_lshl_b32 s33, s3, 2
    s_add_u32 s33, s33, s4
    s_sub_u32 s33, s33, 28
    v_lshlrev_b32 v12, 10, v4
    v_lshl_add_u32 v12, v3, 4, v12
    s_lshl_b32 s64, s28, 8
    s_lshl_b32 s5, s33, 14
    s_add_u32 s64, s64, s5
    s_add_u32 s66, s37, 147456
    v_mfma_f32_32x32x16_bf16 v[64:79], v[56:59], v[40:43], v[64:79]
    ds_read_b64_tr_b16 v[32:33], v132 offset:0
    ds_read_b64_tr_b16 v[34:35], v132 offset:512
    v_mfma_f32_32x32x16_bf16 v[176:191], v[60:63], v[40:43], v[176:191]
    ds_read_b64_tr_b16 v[36:37], v133 offset:0
    ds_read_b64_tr_b16 v[38:39], v133 offset:512
    s_add_u32 m0, s66, 0
    s_add_u32 s65, s64, 0
    buffer_load_dwordx4 v12, s[60:63], s65 offen lds
    v_mfma_f32_32x32x16_bf16 v[80:95], v[56:59], v[44:47], v[80:95]
    ds_read_b128 v[16:19], v138 offset:0
    ds_read_b128 v[20:23], v138 offset:4096
    v_mfma_f32_32x32x16_bf16 v[192:207], v[60:63], v[44:47], v[192:207]
    ds_read_b128 v[24:27], v138 offset:8192
    ds_read_b128 v[28:31], v138 offset:12288
    s_add_u32 m0, s66, 1024
    s_add_u32 s65, s64, 4096
    buffer_load_dwordx4 v12, s[60:63], s65 offen lds
    v_mfma_f32_32x32x16_bf16 v[96:111], v[56:59], v[48:51], v[96:111]
    v_mfma_f32_32x32x16_bf16 v[208:223], v[60:63], v[48:51], v[208:223]
    s_add_u32 m0, s66, 2048
    s_add_u32 s65, s64, 8192
    buffer_load_dwordx4 v12, s[60:63], s65 offen lds
    v_mfma_f32_32x32x16_bf16 v[112:127], v[56:59], v[52:55], v[112:127]
    v_mfma_f32_32x32x16_bf16 v[224:239], v[60:63], v[52:55], v[224:239]
    s_add_u32 m0, s66, 3072
    s_add_u32 s65, s64, 12288
    buffer_load_dwordx4 v12, s[60:63], s65 offen lds
    s_waitcnt lgkmcnt(0)
    v_mfma_f32_32x32x16_bf16 v[64:79], v[32:35], v[16:19], v[64:79]
    ds_read_b64_tr_b16 v[56:57], v132 offset:2048
    ds_read_b64_tr_b16 v[58:59], v132 offset:2560
    v_mfma_f32_32x32x16_bf16 v[176:191], v[36:39], v[16:19], v[176:191]
    ds_read_b64_tr_b16 v[60:61], v133 offset:2048
    ds_read_b64_tr_b16 v[62:63], v133 offset:2560
    v_mfma_f32_32x32x16_bf16 v[80:95], v[32:35], v[20:23], v[80:95]
    ds_read_b128 v[40:43], v139 offset:0
    ds_read_b128 v[44:47], v139 offset:4096
    v_mfma_f32_32x32x16_bf16 v[192:207], v[36:39], v[20:23], v[192:207]
    ds_read_b128 v[48:51], v139 offset:8192
    ds_read_b128 v[52:55], v139 offset:12288
    v_mfma_f32_32x32x16_bf16 v[96:111], v[32:35], v[24:27], v[96:111]
    v_mfma_f32_32x32x16_bf16 v[208:223], v[36:39], v[24:27], v[208:223]
    v_mfma_f32_32x32x16_bf16 v[112:127], v[32:35], v[28:31], v[112:127]
    v_mfma_f32_32x32x16_bf16 v[224:239], v[36:39], v[28:31], v[224:239]
    s_waitcnt vmcnt(16) lgkmcnt(0)
    v_mfma_f32_32x32x16_bf16 v[64:79], v[56:59], v[40:43], v[64:79]
    ds_read_b64_tr_b16 v[32:33], v132 offset:4096
    ds_read_b64_tr_b16 v[34:35], v132 offset:4608
    v_mfma_f32_32x32x16_bf16 v[176:191], v[60:63], v[40:43], v[176:191]
    ds_read_b64_tr_b16 v[36:37], v133 offset:4096
    ds_read_b64_tr_b16 v[38:39], v133 offset:4608
    v_mfma_f32_32x32x16_bf16 v[80:95], v[56:59], v[44:47], v[80:95]
    ds_read_b128 v[16:19], v140 offset:0
    ds_read_b128 v[20:23], v140 offset:4096
    v_mfma_f32_32x32x16_bf16 v[192:207], v[60:63], v[44:47], v[192:207]
    ds_read_b128 v[24:27], v140 offset:8192
    ds_read_b128 v[28:31], v140 offset:12288
    v_mfma_f32_32x32x16_bf16 v[96:111], v[56:59], v[48:51], v[96:111]
    v_mfma_f32_32x32x16_bf16 v[208:223], v[60:63], v[48:51], v[208:223]
    v_mfma_f32_32x32x16_bf16 v[112:127], v[56:59], v[52:55], v[112:127]
    v_mfma_f32_32x32x16_bf16 v[224:239], v[60:63], v[52:55], v[224:239]
    s_waitcnt lgkmcnt(0)
    v_mfma_f32_32x32x16_bf16 v[64:79], v[32:35], v[16:19], v[64:79]
    ds_read_b64_tr_b16 v[56:57], v132 offset:6144
    ds_read_b64_tr_b16 v[58:59], v132 offset:6656
    v_mfma_f32_32x32x16_bf16 v[176:191], v[36:39], v[16:19], v[176:191]
    ds_read_b64_tr_b16 v[60:61], v133 offset:6144
    ds_read_b64_tr_b16 v[62:63], v133 offset:6656
    v_mfma_f32_32x32x16_bf16 v[80:95], v[32:35], v[20:23], v[80:95]
    ds_read_b128 v[40:43], v141 offset:0
    ds_read_b128 v[44:47], v141 offset:4096
    v_mfma_f32_32x32x16_bf16 v[192:207], v[36:39], v[20:23], v[192:207]
    ds_read_b128 v[48:51], v141 offset:8192
    ds_read_b128 v[52:55], v141 offset:12288
    v_mfma_f32_32x32x16_bf16 v[96:111], v[32:35], v[24:27], v[96:111]
    v_mfma_f32_32x32x16_bf16 v[208:223], v[36:39], v[24:27], v[208:223]
    v_mfma_f32_32x32x16_bf16 v[112:127], v[32:35], v[28:31], v[112:127]
    v_mfma_f32_32x32x16_bf16 v[224:239], v[36:39], v[28:31], v[224:239]
    s_waitcnt vmcnt(8) lgkmcnt(0)
    s_barrier
    v_mfma_f32_32x32x16_bf16 v[64:79], v[56:59], v[40:43], v[64:79]
    ds_read_b64_tr_b16 v[32:33], v134 offset:0
    ds_read_b64_tr_b16 v[34:35], v134 offset:512
    v_mfma_f32_32x32x16_bf16 v[176:191], v[60:63], v[40:43], v[176:191]
    ds_read_b64_tr_b16 v[36:37], v135 offset:0
    ds_read_b64_tr_b16 v[38:39], v135 offset:512
    v_mfma_f32_32x32x16_bf16 v[80:95], v[56:59], v[44:47], v[80:95]
    ds_read_b128 v[16:19], v142 offset:0
    ds_read_b128 v[20:23], v142 offset:4096
    v_mfma_f32_32x32x16_bf16 v[192:207], v[60:63], v[44:47], v[192:207]
    ds_read_b128 v[24:27], v142 offset:8192
    ds_read_b128 v[28:31], v142 offset:12288
    v_mfma_f32_32x32x16_bf16 v[96:111], v[56:59], v[48:51], v[96:111]
    v_mfma_f32_32x32x16_bf16 v[208:223], v[60:63], v[48:51], v[208:223]
    v_mfma_f32_32x32x16_bf16 v[112:127], v[56:59], v[52:55], v[112:127]
    v_mfma_f32_32x32x16_bf16 v[224:239], v[60:63], v[52:55], v[224:239]
    s_waitcnt lgkmcnt(0)
    v_mfma_f32_32x32x16_bf16 v[64:79], v[32:35], v[16:19], v[64:79]
    ds_read_b64_tr_b16 v[56:57], v134 offset:2048
    ds_read_b64_tr_b16 v[58:59], v134 offset:2560
    v_mfma_f32_32x32x16_bf16 v[176:191], v[36:39], v[16:19], v[176:191]
    ds_read_b64_tr_b16 v[60:61], v135 offset:2048
    ds_read_b64_tr_b16 v[62:63], v135 offset:2560
    v_mfma_f32_32x32x16_bf16 v[80:95], v[32:35], v[20:23], v[80:95]
    ds_read_b128 v[40:43], v143 offset:0
    ds_read_b128 v[44:47], v143 offset:4096
    v_mfma_f32_32x32x16_bf16 v[192:207], v[36:39], v[20:23], v[192:207]
    ds_read_b128 v[48:51], v143 offset:8192
    ds_read_b128 v[52:55], v143 offset:12288
    v_mfma_f32_32x32x16_bf16 v[96:111], v[32:35], v[24:27], v[96:111]
    v_mfma_f32_32x32x16_bf16 v[208:223], v[36:39], v[24:27], v[208:223]
    v_mfma_f32_32x32x16_bf16 v[112:127], v[32:35], v[28:31], v[112:127]
    v_mfma_f32_32x32x16_bf16 v[224:239], v[36:39], v[28:31], v[224:239]
    s_waitcnt vmcnt(4) lgkmcnt(0)
    v_mfma_f32_32x32x16_bf16 v[64:79], v[56:59], v[40:43], v[64:79]
    ds_read_b64_tr_b16 v[32:33], v134 offset:4096
    ds_read_b64_tr_b16 v[34:35], v134 offset:4608
    v_mfma_f32_32x32x16_bf16 v[176:191], v[60:63], v[40:43], v[176:191]
    ds_read_b64_tr_b16 v[36:37], v135 offset:4096
    ds_read_b64_tr_b16 v[38:39], v135 offset:4608
    v_mfma_f32_32x32x16_bf16 v[80:95], v[56:59], v[44:47], v[80:95]
    ds_read_b128 v[16:19], v144 offset:0
    ds_read_b128 v[20:23], v144 offset:4096
    v_mfma_f32_32x32x16_bf16 v[192:207], v[60:63], v[44:47], v[192:207]
    ds_read_b128 v[24:27], v144 offset:8192
    ds_read_b128 v[28:31], v144 offset:12288
    v_mfma_f32_32x32x16_bf16 v[96:111], v[56:59], v[48:51], v[96:111]
    v_mfma_f32_32x32x16_bf16 v[208:223], v[60:63], v[48:51], v[208:223]
    v_mfma_f32_32x32x16_bf16 v[112:127], v[56:59], v[52:55], v[112:127]
    v_mfma_f32_32x32x16_bf16 v[224:239], v[60:63], v[52:55], v[224:239]
    s_waitcnt lgkmcnt(0)
    v_mfma_f32_32x32x16_bf16 v[64:79], v[32:35], v[16:19], v[64:79]
    ds_read_b64_tr_b16 v[56:57], v134 offset:6144
    ds_read_b64_tr_b16 v[58:59], v134 offset:6656
    v_mfma_f32_32x32x16_bf16 v[176:191], v[36:39], v[16:19], v[176:191]
    ds_read_b64_tr_b16 v[60:61], v135 offset:6144
    ds_read_b64_tr_b16 v[62:63], v135 offset:6656
    v_mfma_f32_32x32x16_bf16 v[80:95], v[32:35], v[20:23], v[80:95]
    ds_read_b128 v[40:43], v145 offset:0
    ds_read_b128 v[44:47], v145 offset:4096
    v_mfma_f32_32x32x16_bf16 v[192:207], v[36:39], v[20:23], v[192:207]
    ds_read_b128 v[48:51], v145 offset:8192
    ds_read_b128 v[52:55], v145 offset:12288
    v_mfma_f32_32x32x16_bf16 v[96:111], v[32:35], v[24:27], v[96:111]
    v_mfma_f32_32x32x16_bf16 v[208:223], v[36:39], v[24:27], v[208:223]
    v_mfma_f32_32x32x16_bf16 v[112:127], v[32:35], v[28:31], v[112:127]
    v_mfma_f32_32x32x16_bf16 v[224:239], v[36:39], v[28:31], v[224:239]
    s_waitcnt lgkmcnt(0)
    v_mfma_f32_32x32x16_bf16 v[64:79], v[56:59], v[40:43], v[64:79]
    v_mfma_f32_32x32x16_bf16 v[176:191], v[60:63], v[40:43], v[176:191]
    v_mfma_f32_32x32x16_bf16 v[80:95], v[56:59], v[44:47], v[80:95]
    v_mfma_f32_32x32x16_bf16 v[192:207], v[60:63], v[44:47], v[192:207]
    v_mfma_f32_32x32x16_bf16 v[96:111], v[56:59], v[48:51], v[96:111]
    v_mfma_f32_32x32x16_bf16 v[208:223], v[60:63], v[48:51], v[208:223]
    v_mfma_f32_32x32x16_bf16 v[112:127], v[56:59], v[52:55], v[112:127]
    v_mfma_f32_32x32x16_bf16 v[224:239], v[60:63], v[52:55], v[224:239]
    v_mov_b32 v128, 0x3fb8aa3b
    v_mov_b32 v129, 0x3fb8aa3b
    v_mov_b32 v130, 0x358637bd
    v_mov_b32 v131, 0x358637bd
    v_lshlrev_b32_e64 v171, 12, v4
    v_lshl_add_u32 v171, v3, 7, v171
    s_lshl_b32 s42, s31, 14
    s_add_u32 s42, s42, 10223616
    buffer_load_dword v172, v171, s[8:11], s42 offen sc1
    s_lshl_b32 s5, s30, 11
    s_add_u32 s5, s5, 10158080
    s_lshl_b32 s6, s33, 12
    s_add_u32 s6, s6, 10223616
    v_mov_b32 v254, s5
    v_mov_b32 v255, s6
    v_and_b32 v1, 1, v4
    v_cmp_eq_u32 vcc, 0, v1
    s_nop 1
    v_cndmask_b32_e64 v254, v255, v254, vcc
    v_lshl_add_u32 v254, v3, 7, v254
    buffer_load_dword v255, v254, s[8:11], 0 offen sc1
    v_pk_mul_f32 v[48:49], v[64:65], v[128:129]
    v_pk_mul_f32 v[50:51], v[66:67], v[128:129]
    v_pk_mul_f32 v[52:53], v[68:69], v[128:129]
    v_pk_mul_f32 v[54:55], v[70:71], v[128:129]
    v_pk_mul_f32 v[56:57], v[72:73], v[128:129]
    v_pk_mul_f32 v[58:59], v[74:75], v[128:129]
    v_pk_mul_f32 v[60:61], v[76:77], v[128:129]
    v_pk_mul_f32 v[62:63], v[78:79], v[128:129]
    v_exp_f32_e64 v48, v48 clamp
    v_max_f32_e64 v64, 0, v64
    v_exp_f32_e64 v49, v49 clamp
    v_max_f32_e64 v65, 0, v65
    v_exp_f32_e64 v50, v50 clamp
    v_max_f32_e64 v66, 0, v66
    v_exp_f32_e64 v51, v51 clamp
    v_max_f32_e64 v67, 0, v67
    v_exp_f32_e64 v52, v52 clamp
    v_max_f32_e64 v68, 0, v68
    v_exp_f32_e64 v53, v53 clamp
    v_max_f32_e64 v69, 0, v69
    v_exp_f32_e64 v54, v54 clamp
    v_max_f32_e64 v70, 0, v70
    v_exp_f32_e64 v55, v55 clamp
    v_max_f32_e64 v71, 0, v71
    v_exp_f32_e64 v56, v56 clamp
    v_max_f32_e64 v72, 0, v72
    v_exp_f32_e64 v57, v57 clamp
    v_max_f32_e64 v73, 0, v73
    v_exp_f32_e64 v58, v58 clamp
    v_max_f32_e64 v74, 0, v74
    v_exp_f32_e64 v59, v59 clamp
    v_max_f32_e64 v75, 0, v75
    v_exp_f32_e64 v60, v60 clamp
    v_max_f32_e64 v76, 0, v76
    v_exp_f32_e64 v61, v61 clamp
    v_max_f32_e64 v77, 0, v77
    v_exp_f32_e64 v62, v62 clamp
    v_max_f32_e64 v78, 0, v78
    v_exp_f32_e64 v63, v63 clamp
    v_max_f32_e64 v79, 0, v79
    v_pk_add_f32 v[64:65], v[64:65], v[48:49]
    v_pk_add_f32 v[66:67], v[66:67], v[50:51]
    v_pk_add_f32 v[68:69], v[68:69], v[52:53]
    v_pk_add_f32 v[70:71], v[70:71], v[54:55]
    v_pk_add_f32 v[72:73], v[72:73], v[56:57]
    v_pk_add_f32 v[74:75], v[74:75], v[58:59]
    v_pk_add_f32 v[76:77], v[76:77], v[60:61]
    v_pk_add_f32 v[78:79], v[78:79], v[62:63]
    v_pk_mul_f32 v[48:49], v[80:81], v[128:129]
    v_pk_mul_f32 v[50:51], v[82:83], v[128:129]
    v_pk_mul_f32 v[52:53], v[84:85], v[128:129]
    v_pk_mul_f32 v[54:55], v[86:87], v[128:129]
    v_pk_mul_f32 v[56:57], v[88:89], v[128:129]
    v_pk_mul_f32 v[58:59], v[90:91], v[128:129]
    v_pk_mul_f32 v[60:61], v[92:93], v[128:129]
    v_pk_mul_f32 v[62:63], v[94:95], v[128:129]
    v_exp_f32_e64 v48, v48 clamp
    v_max_f32_e64 v80, 0, v80
    v_exp_f32_e64 v49, v49 clamp
    v_max_f32_e64 v81, 0, v81
    v_exp_f32_e64 v50, v50 clamp
    v_max_f32_e64 v82, 0, v82
    v_exp_f32_e64 v51, v51 clamp
    v_max_f32_e64 v83, 0, v83
    v_exp_f32_e64 v52, v52 clamp
    v_max_f32_e64 v84, 0, v84
    v_exp_f32_e64 v53, v53 clamp
    v_max_f32_e64 v85, 0, v85
    v_exp_f32_e64 v54, v54 clamp
    v_max_f32_e64 v86, 0, v86
    v_exp_f32_e64 v55, v55 clamp
    v_max_f32_e64 v87, 0, v87
    v_exp_f32_e64 v56, v56 clamp
    v_max_f32_e64 v88, 0, v88
    v_exp_f32_e64 v57, v57 clamp
    v_max_f32_e64 v89, 0, v89
    v_exp_f32_e64 v58, v58 clamp
    v_max_f32_e64 v90, 0, v90
    v_exp_f32_e64 v59, v59 clamp
    v_max_f32_e64 v91, 0, v91
    v_exp_f32_e64 v60, v60 clamp
    v_max_f32_e64 v92, 0, v92
    v_exp_f32_e64 v61, v61 clamp
    v_max_f32_e64 v93, 0, v93
    v_exp_f32_e64 v62, v62 clamp
    v_max_f32_e64 v94, 0, v94
    v_exp_f32_e64 v63, v63 clamp
    v_max_f32_e64 v95, 0, v95
    v_pk_add_f32 v[80:81], v[80:81], v[48:49]
    v_pk_add_f32 v[82:83], v[82:83], v[50:51]
    v_pk_add_f32 v[84:85], v[84:85], v[52:53]
    v_pk_add_f32 v[86:87], v[86:87], v[54:55]
    v_pk_add_f32 v[88:89], v[88:89], v[56:57]
    v_pk_add_f32 v[90:91], v[90:91], v[58:59]
    v_pk_add_f32 v[92:93], v[92:93], v[60:61]
    v_pk_add_f32 v[94:95], v[94:95], v[62:63]
    v_pk_mul_f32 v[48:49], v[96:97], v[128:129]
    v_pk_mul_f32 v[50:51], v[98:99], v[128:129]
    v_pk_mul_f32 v[52:53], v[100:101], v[128:129]
    v_pk_mul_f32 v[54:55], v[102:103], v[128:129]
    v_pk_mul_f32 v[56:57], v[104:105], v[128:129]
    v_pk_mul_f32 v[58:59], v[106:107], v[128:129]
    v_pk_mul_f32 v[60:61], v[108:109], v[128:129]
    v_pk_mul_f32 v[62:63], v[110:111], v[128:129]
    v_exp_f32_e64 v48, v48 clamp
    v_max_f32_e64 v96, 0, v96
    v_exp_f32_e64 v49, v49 clamp
    v_max_f32_e64 v97, 0, v97
    v_exp_f32_e64 v50, v50 clamp
    v_max_f32_e64 v98, 0, v98
    v_exp_f32_e64 v51, v51 clamp
    v_max_f32_e64 v99, 0, v99
    v_exp_f32_e64 v52, v52 clamp
    v_max_f32_e64 v100, 0, v100
    v_exp_f32_e64 v53, v53 clamp
    v_max_f32_e64 v101, 0, v101
    v_exp_f32_e64 v54, v54 clamp
    v_max_f32_e64 v102, 0, v102
    v_exp_f32_e64 v55, v55 clamp
    v_max_f32_e64 v103, 0, v103
    v_exp_f32_e64 v56, v56 clamp
    v_max_f32_e64 v104, 0, v104
    v_exp_f32_e64 v57, v57 clamp
    v_max_f32_e64 v105, 0, v105
    v_exp_f32_e64 v58, v58 clamp
    v_max_f32_e64 v106, 0, v106
    v_exp_f32_e64 v59, v59 clamp
    v_max_f32_e64 v107, 0, v107
    v_exp_f32_e64 v60, v60 clamp
    v_max_f32_e64 v108, 0, v108
    v_exp_f32_e64 v61, v61 clamp
    v_max_f32_e64 v109, 0, v109
    v_exp_f32_e64 v62, v62 clamp
    v_max_f32_e64 v110, 0, v110
    v_exp_f32_e64 v63, v63 clamp
    v_max_f32_e64 v111, 0, v111
    v_pk_add_f32 v[96:97], v[96:97], v[48:49]
    v_pk_add_f32 v[98:99], v[98:99], v[50:51]
    v_pk_add_f32 v[100:101], v[100:101], v[52:53]
    v_pk_add_f32 v[102:103], v[102:103], v[54:55]
    v_pk_add_f32 v[104:105], v[104:105], v[56:57]
    v_pk_add_f32 v[106:107], v[106:107], v[58:59]
    v_pk_add_f32 v[108:109], v[108:109], v[60:61]
    v_pk_add_f32 v[110:111], v[110:111], v[62:63]
    v_pk_mul_f32 v[48:49], v[112:113], v[128:129]
    v_pk_mul_f32 v[50:51], v[114:115], v[128:129]
    v_pk_mul_f32 v[52:53], v[116:117], v[128:129]
    v_pk_mul_f32 v[54:55], v[118:119], v[128:129]
    v_pk_mul_f32 v[56:57], v[120:121], v[128:129]
    v_pk_mul_f32 v[58:59], v[122:123], v[128:129]
    v_pk_mul_f32 v[60:61], v[124:125], v[128:129]
    v_pk_mul_f32 v[62:63], v[126:127], v[128:129]
    v_exp_f32_e64 v48, v48 clamp
    v_max_f32_e64 v112, 0, v112
    v_exp_f32_e64 v49, v49 clamp
    v_max_f32_e64 v113, 0, v113
    v_exp_f32_e64 v50, v50 clamp
    v_max_f32_e64 v114, 0, v114
    v_exp_f32_e64 v51, v51 clamp
    v_max_f32_e64 v115, 0, v115
    v_exp_f32_e64 v52, v52 clamp
    v_max_f32_e64 v116, 0, v116
    v_exp_f32_e64 v53, v53 clamp
    v_max_f32_e64 v117, 0, v117
    v_exp_f32_e64 v54, v54 clamp
    v_max_f32_e64 v118, 0, v118
    v_exp_f32_e64 v55, v55 clamp
    v_max_f32_e64 v119, 0, v119
    v_exp_f32_e64 v56, v56 clamp
    v_max_f32_e64 v120, 0, v120
    v_exp_f32_e64 v57, v57 clamp
    v_max_f32_e64 v121, 0, v121
    v_exp_f32_e64 v58, v58 clamp
    v_max_f32_e64 v122, 0, v122
    v_exp_f32_e64 v59, v59 clamp
    v_max_f32_e64 v123, 0, v123
    v_exp_f32_e64 v60, v60 clamp
    v_max_f32_e64 v124, 0, v124
    v_exp_f32_e64 v61, v61 clamp
    v_max_f32_e64 v125, 0, v125
    v_exp_f32_e64 v62, v62 clamp
    v_max_f32_e64 v126, 0, v126
    v_exp_f32_e64 v63, v63 clamp
    v_max_f32_e64 v127, 0, v127
    v_pk_add_f32 v[112:113], v[112:113], v[48:49]
    v_pk_add_f32 v[114:115], v[114:115], v[50:51]
    v_pk_add_f32 v[116:117], v[116:117], v[52:53]
    v_pk_add_f32 v[118:119], v[118:119], v[54:55]
    v_pk_add_f32 v[120:121], v[120:121], v[56:57]
    v_pk_add_f32 v[122:123], v[122:123], v[58:59]
    v_pk_add_f32 v[124:125], v[124:125], v[60:61]
    v_pk_add_f32 v[126:127], v[126:127], v[62:63]
    v_pk_mul_f32 v[48:49], v[176:177], v[128:129]
    v_pk_mul_f32 v[50:51], v[178:179], v[128:129]
    v_pk_mul_f32 v[52:53], v[180:181], v[128:129]
    v_pk_mul_f32 v[54:55], v[182:183], v[128:129]
    v_pk_mul_f32 v[56:57], v[184:185], v[128:129]
    v_pk_mul_f32 v[58:59], v[186:187], v[128:129]
    v_pk_mul_f32 v[60:61], v[188:189], v[128:129]
    v_pk_mul_f32 v[62:63], v[190:191], v[128:129]
    v_exp_f32_e64 v48, v48 clamp
    v_max_f32_e64 v176, 0, v176
    v_exp_f32_e64 v49, v49 clamp
    v_max_f32_e64 v177, 0, v177
    v_exp_f32_e64 v50, v50 clamp
    v_max_f32_e64 v178, 0, v178
    v_exp_f32_e64 v51, v51 clamp
    v_max_f32_e64 v179, 0, v179
    v_exp_f32_e64 v52, v52 clamp
    v_max_f32_e64 v180, 0, v180
    v_exp_f32_e64 v53, v53 clamp
    v_max_f32_e64 v181, 0, v181
    v_exp_f32_e64 v54, v54 clamp
    v_max_f32_e64 v182, 0, v182
    v_exp_f32_e64 v55, v55 clamp
    v_max_f32_e64 v183, 0, v183
    v_exp_f32_e64 v56, v56 clamp
    v_max_f32_e64 v184, 0, v184
    v_exp_f32_e64 v57, v57 clamp
    v_max_f32_e64 v185, 0, v185
    v_exp_f32_e64 v58, v58 clamp
    v_max_f32_e64 v186, 0, v186
    v_exp_f32_e64 v59, v59 clamp
    v_max_f32_e64 v187, 0, v187
    v_exp_f32_e64 v60, v60 clamp
    v_max_f32_e64 v188, 0, v188
    v_exp_f32_e64 v61, v61 clamp
    v_max_f32_e64 v189, 0, v189
    v_exp_f32_e64 v62, v62 clamp
    v_max_f32_e64 v190, 0, v190
    v_exp_f32_e64 v63, v63 clamp
    v_max_f32_e64 v191, 0, v191
    v_pk_add_f32 v[176:177], v[176:177], v[48:49]
    v_pk_add_f32 v[178:179], v[178:179], v[50:51]
    v_pk_add_f32 v[180:181], v[180:181], v[52:53]
    v_pk_add_f32 v[182:183], v[182:183], v[54:55]
    v_pk_add_f32 v[184:185], v[184:185], v[56:57]
    v_pk_add_f32 v[186:187], v[186:187], v[58:59]
    v_pk_add_f32 v[188:189], v[188:189], v[60:61]
    v_pk_add_f32 v[190:191], v[190:191], v[62:63]
    v_pk_mul_f32 v[48:49], v[192:193], v[128:129]
    v_pk_mul_f32 v[50:51], v[194:195], v[128:129]
    v_pk_mul_f32 v[52:53], v[196:197], v[128:129]
    v_pk_mul_f32 v[54:55], v[198:199], v[128:129]
    v_pk_mul_f32 v[56:57], v[200:201], v[128:129]
    v_pk_mul_f32 v[58:59], v[202:203], v[128:129]
    v_pk_mul_f32 v[60:61], v[204:205], v[128:129]
    v_pk_mul_f32 v[62:63], v[206:207], v[128:129]
    v_exp_f32_e64 v48, v48 clamp
    v_max_f32_e64 v192, 0, v192
    v_exp_f32_e64 v49, v49 clamp
    v_max_f32_e64 v193, 0, v193
    v_exp_f32_e64 v50, v50 clamp
    v_max_f32_e64 v194, 0, v194
    v_exp_f32_e64 v51, v51 clamp
    v_max_f32_e64 v195, 0, v195
    v_exp_f32_e64 v52, v52 clamp
    v_max_f32_e64 v196, 0, v196
    v_exp_f32_e64 v53, v53 clamp
    v_max_f32_e64 v197, 0, v197
    v_exp_f32_e64 v54, v54 clamp
    v_max_f32_e64 v198, 0, v198
    v_exp_f32_e64 v55, v55 clamp
    v_max_f32_e64 v199, 0, v199
    v_exp_f32_e64 v56, v56 clamp
    v_max_f32_e64 v200, 0, v200
    v_exp_f32_e64 v57, v57 clamp
    v_max_f32_e64 v201, 0, v201
    v_exp_f32_e64 v58, v58 clamp
    v_max_f32_e64 v202, 0, v202
    v_exp_f32_e64 v59, v59 clamp
    v_max_f32_e64 v203, 0, v203
    v_exp_f32_e64 v60, v60 clamp
    v_max_f32_e64 v204, 0, v204
    v_exp_f32_e64 v61, v61 clamp
    v_max_f32_e64 v205, 0, v205
    v_exp_f32_e64 v62, v62 clamp
    v_max_f32_e64 v206, 0, v206
    v_exp_f32_e64 v63, v63 clamp
    v_max_f32_e64 v207, 0, v207
    v_pk_add_f32 v[192:193], v[192:193], v[48:49]
    v_pk_add_f32 v[194:195], v[194:195], v[50:51]
    v_pk_add_f32 v[196:197], v[196:197], v[52:53]
    v_pk_add_f32 v[198:199], v[198:199], v[54:55]
    v_pk_add_f32 v[200:201], v[200:201], v[56:57]
    v_pk_add_f32 v[202:203], v[202:203], v[58:59]
    v_pk_add_f32 v[204:205], v[204:205], v[60:61]
    v_pk_add_f32 v[206:207], v[206:207], v[62:63]
    s_waitcnt vmcnt(1)
    v_cmp_ne_u32 vcc, s29, v172
    s_nop 1
    s_cbranch_vccnz slow_f2
back_f2:
    s_lshl_b32 s40, s31, 12
    s_add_u32 s40, s40, 9961472
    buffer_load_dwordx4 v[16:19], v5, s[8:11], s40 offen offset:0 sc1
    buffer_load_dwordx4 v[20:23], v5, s[8:11], s40 offen offset:1024 sc1
    buffer_load_dwordx4 v[24:27], v5, s[8:11], s40 offen offset:2048 sc1
    buffer_load_dwordx4 v[28:31], v5, s[8:11], s40 offen offset:3072 sc1
    s_waitcnt vmcnt(4)
    v_cmp_ne_u32 vcc, s29, v255
    s_nop 1
    s_cbranch_vccnz slow_f2b
back_f2b:
    s_lshl_b32 s32, s33, 15
    s_add_u32 s32, s32, s37
    s_add_u32 s32, s32, 8912896
    buffer_load_dwordx4 v[136:139], v5, s[8:11], s32 offen offset:0 sc1
    buffer_load_dwordx4 v[140:143], v5, s[8:11], s32 offen offset:1024 sc1
    buffer_load_dwordx4 v[144:147], v5, s[8:11], s32 offen offset:2048 sc1
    buffer_load_dwordx4 v[148:151], v5, s[8:11], s32 offen offset:3072 sc1
    v_lshlrev_b32 v133, 2, v173
    s_lshl_b32 s42, s30, 9
    s_add_u32 s42, s42, 10027008
    buffer_load_dword v8, v133, s[8:11], s42 offen offset:0 sc1
    buffer_load_dword v9, v133, s[8:11], s42 offen offset:128 sc1
    buffer_load_dword v10, v133, s[8:11], s42 offen offset:256 sc1
    buffer_load_dword v11, v133, s[8:11], s42 offen offset:384 sc1
    v_pk_mul_f32 v[48:49], v[208:209], v[128:129]
    v_pk_mul_f32 v[50:51], v[210:211], v[128:129]
    v_pk_mul_f32 v[52:53], v[212:213], v[128:129]
    v_pk_mul_f32 v[54:55], v[214:215], v[128:129]
    v_pk_mul_f32 v[56:57], v[216:217], v[128:129]
    v_pk_mul_f32 v[58:59], v[218:219], v[128:129]
    v_pk_mul_f32 v[60:61], v[220:221], v[128:129]
    v_pk_mul_f32 v[62:63], v[222:223], v[128:129]
    v_exp_f32_e64 v48, v48 clamp
    v_max_f32 v208, 0, v208
    v_exp_f32_e64 v49, v49 clamp
    v_max_f32_e64 v209, 0, v209
    v_exp_f32_e64 v50, v50 clamp
    v_max_f32_e64 v210, 0, v210
    v_exp_f32_e64 v51, v51 clamp
    v_max_f32_e64 v211, 0, v211
    v_exp_f32_e64 v52, v52 clamp
    v_max_f32_e64 v212, 0, v212
    v_exp_f32_e64 v53, v53 clamp
    v_max_f32_e64 v213, 0, v213
    v_exp_f32_e64 v54, v54 clamp
    v_max_f32_e64 v214, 0, v214
    v_exp_f32_e64 v55, v55 clamp
    v_max_f32_e64 v215, 0, v215
    v_exp_f32_e64 v56, v56 clamp
    v_max_f32_e64 v216, 0, v216
    v_exp_f32_e64 v57, v57 clamp
    v_max_f32_e64 v217, 0, v217
    v_exp_f32_e64 v58, v58 clamp
    v_max_f32_e64 v218, 0, v218
    v_exp_f32_e64 v59, v59 clamp
    v_max_f32_e64 v219, 0, v219
    v_exp_f32_e64 v60, v60 clamp
    v_max_f32_e64 v220, 0, v220
    v_exp_f32_e64 v61, v61 clamp
    v_max_f32_e64 v221, 0, v221
    v_exp_f32_e64 v62, v62 clamp
    v_max_f32_e64 v222, 0, v222
    v_exp_f32_e64 v63, v63 clamp
    v_max_f32_e64 v223, 0, v223
    v_pk_add_f32 v[208:209], v[208:209], v[48:49]
    v_pk_add_f32 v[210:211], v[210:211], v[50:51]
    v_pk_add_f32 v[212:213], v[212:213], v[52:53]
    v_pk_add_f32 v[214:215], v[214:215], v[54:55]
    v_pk_add_f32 v[216:217], v[216:217], v[56:57]
    v_pk_add_f32 v[218:219], v[218:219], v[58:59]
    v_pk_add_f32 v[220:221], v[220:221], v[60:61]
    v_pk_add_f32 v[222:223], v[222:223], v[62:63]
    v_pk_mul_f32 v[48:49], v[224:225], v[128:129]
    v_pk_mul_f32 v[50:51], v[226:227], v[128:129]
    v_pk_mul_f32 v[52:53], v[228:229], v[128:129]
    v_pk_mul_f32 v[54:55], v[230:231], v[128:129]
    v_pk_mul_f32 v[56:57], v[232:233], v[128:129]
    v_pk_mul_f32 v[58:59], v[234:235], v[128:129]
    v_pk_mul_f32 v[60:61], v[236:237], v[128:129]
    v_pk_mul_f32 v[62:63], v[238:239], v[128:129]
    v_exp_f32_e64 v48, v48 clamp
    v_max_f32_e64 v224, 0, v224
    v_exp_f32_e64 v49, v49 clamp
    v_max_f32_e64 v225, 0, v225
    v_exp_f32_e64 v50, v50 clamp
    v_max_f32_e64 v226, 0, v226
    v_exp_f32_e64 v51, v51 clamp
    v_max_f32_e64 v227, 0, v227
    v_exp_f32_e64 v52, v52 clamp
    v_max_f32_e64 v228, 0, v228
    v_exp_f32_e64 v53, v53 clamp
    v_max_f32_e64 v229, 0, v229
    v_exp_f32_e64 v54, v54 clamp
    v_max_f32_e64 v230, 0, v230
    v_exp_f32_e64 v55, v55 clamp
    v_max_f32_e64 v231, 0, v231
    v_exp_f32_e64 v56, v56 clamp
    v_max_f32_e64 v232, 0, v232
    v_exp_f32_e64 v57, v57 clamp
    v_max_f32_e64 v233, 0, v233
    v_exp_f32_e64 v58, v58 clamp
    v_max_f32_e64 v234, 0, v234
    v_exp_f32_e64 v59, v59 clamp
    v_max_f32_e64 v235, 0, v235
    v_exp_f32_e64 v60, v60 clamp
    v_max_f32_e64 v236, 0, v236
    v_exp_f32_e64 v61, v61 clamp
    v_max_f32_e64 v237, 0, v237
    v_exp_f32_e64 v62, v62 clamp
    v_max_f32_e64 v238, 0, v238
    v_exp_f32_e64 v63, v63 clamp
    v_max_f32_e64 v239, 0, v239
    v_pk_add_f32 v[224:225], v[224:225], v[48:49]
    v_pk_add_f32 v[226:227], v[226:227], v[50:51]
    v_pk_add_f32 v[228:229], v[228:229], v[52:53]
    v_pk_add_f32 v[230:231], v[230:231], v[54:55]
    v_pk_add_f32 v[232:233], v[232:233], v[56:57]
    v_pk_add_f32 v[234:235], v[234:235], v[58:59]
    v_pk_add_f32 v[236:237], v[236:237], v[60:61]
    v_pk_add_f32 v[238:239], v[238:239], v[62:63]
    s_waitcnt vmcnt(8)
    v_pk_add_f32 v[16:17], v[16:17], v[24:25]
    v_pk_add_f32 v[18:19], v[18:19], v[26:27]
    v_pk_add_f32 v[20:21], v[20:21], v[28:29]
    v_pk_add_f32 v[22:23], v[22:23], v[30:31]
    v_pk_add_f32 v[16:17], v[16:17], v[20:21]
    v_pk_add_f32 v[18:19], v[18:19], v[22:23]
    v_mov_b32 v20, v16
    v_mov_b32 v21, v17
    v_mov_b32 v22, v18
    v_mov_b32 v23, v19
    v_permlane16_swap_b32 v16, v20
    v_permlane16_swap_b32 v17, v21
    v_permlane16_swap_b32 v18, v22
    v_permlane16_swap_b32 v19, v23
    v_add_f32 v16, v16, v20
    v_add_f32 v17, v17, v21
    v_add_f32 v18, v18, v22
    v_add_f32 v19, v19, v23
    v_mov_b32 v20, v16
    v_mov_b32 v21, v17
    v_mov_b32 v22, v18
    v_mov_b32 v23, v19
    v_permlane32_swap_b32 v16, v20
    v_permlane32_swap_b32 v17, v21
    v_permlane32_swap_b32 v18, v22
    v_permlane32_swap_b32 v19, v23
    v_add_f32 v16, v16, v20
    v_add_f32 v17, v17, v21
    v_add_f32 v18, v18, v22
    v_add_f32 v19, v19, v23
    v_lshlrev_b32 v134, 4, v0
    ds_write_b128 v134, v[16:19] offset:4096
    s_lshl_b32 s5, s28, 10
    v_lshlrev_b32 v134, 6, v174
    v_add_u32 v134, s5, v134
    s_waitcnt lgkmcnt(0)
    ds_read_b128 v[16:19], v134 offset:4096
    ds_read_b128 v[20:23], v134 offset:4112
    ds_read_b128 v[24:27], v134 offset:4128
    ds_read_b128 v[28:31], v134 offset:4144
    ds_read_b128 v[32:35], v134 offset:4224
    ds_read_b128 v[36:39], v134 offset:4240
    ds_read_b128 v[40:43], v134 offset:4256
    ds_read_b128 v[44:47], v134 offset:4272
    s_waitcnt lgkmcnt(0)
    v_add_f32 v132, 1.0, v16
    v_add_f32 v133, 1.0, v32
    v_add_f32 v132, v132, v17
    v_add_f32 v133, v133, v33
    v_add_f32 v132, v132, v18
    v_add_f32 v133, v133, v34
    v_add_f32 v132, v132, v19
    v_add_f32 v133, v133, v35
    v_add_f32 v132, v132, v20
    v_add_f32 v133, v133, v36
    v_add_f32 v132, v132, v21
    v_add_f32 v133, v133, v37
    v_add_f32 v132, v132, v22
    v_add_f32 v133, v133, v38
    v_add_f32 v132, v132, v23
    v_add_f32 v133, v133, v39
    v_add_f32 v132, v132, v24
    v_add_f32 v133, v133, v40
    v_add_f32 v132, v132, v25
    v_add_f32 v133, v133, v41
    v_add_f32 v132, v132, v26
    v_add_f32 v133, v133, v42
    v_add_f32 v132, v132, v27
    v_add_f32 v133, v133, v43
    v_add_f32 v132, v132, v28
    v_add_f32 v133, v133, v44
    v_add_f32 v132, v132, v29
    v_add_f32 v133, v133, v45
    v_add_f32 v132, v132, v30
    v_add_f32 v133, v133, v46
    v_add_f32 v132, v132, v31
    v_add_f32 v133, v133, v47
    v_mul_f32 v132, v130, v132
    v_mul_f32 v133, v130, v133
    s_lshl_b32 s5, s33, 7
    s_add_u32 s5, s5, 10354688
    s_cmp_eq_u32 s28, 0
    s_cselect_b32 s39, s5, 1073741824
    v_lshlrev_b32_e64 v134, 11, v174
    v_lshl_add_u32 v134, v173, 4, v134
    s_lshl_b32 s40, s30, 17
    s_lshl_b32 s5, s31, 13
    s_add_u32 s40, s40, s5
    s_add_u32 s40, s40, 4194304
    s_waitcnt vmcnt(0)
    v_pk_mul_f32 v[248:249], v[64:65], v[16:17]
    v_pk_mul_f32 v[250:251], v[66:67], v[18:19]
    v_pk_fma_f32 v[248:249], v[68:69], v[20:21], v[248:249]
    v_pk_fma_f32 v[250:251], v[70:71], v[22:23], v[250:251]
    v_pk_fma_f32 v[248:249], v[72:73], v[24:25], v[248:249]
    v_pk_fma_f32 v[250:251], v[74:75], v[26:27], v[250:251]
    v_pk_fma_f32 v[248:249], v[76:77], v[28:29], v[248:249]
    v_pk_fma_f32 v[250:251], v[78:79], v[30:31], v[250:251]
    v_pk_add_f32 v[248:249], v[248:249], v[250:251]
    v_add_f32 v248, v248, v132
    v_add_f32 v248, v248, v249
    v_rcp_f32 v248, v248
    s_add_u32 s35, s40, 0
    v_mul_f32 v248, v248, v8
    v_mul_f32 v249, v130, v248
    v_pk_fma_f32 v[64:65], v[64:65], v[248:249], v[248:249] op_sel:[0,0,1] op_sel_hi:[1,0,1]
    v_pk_fma_f32 v[66:67], v[66:67], v[248:249], v[248:249] op_sel:[0,0,1] op_sel_hi:[1,0,1]
    v_pk_fma_f32 v[68:69], v[68:69], v[248:249], v[248:249] op_sel:[0,0,1] op_sel_hi:[1,0,1]
    v_pk_fma_f32 v[70:71], v[70:71], v[248:249], v[248:249] op_sel:[0,0,1] op_sel_hi:[1,0,1]
    v_pk_fma_f32 v[72:73], v[72:73], v[248:249], v[248:249] op_sel:[0,0,1] op_sel_hi:[1,0,1]
    v_pk_fma_f32 v[74:75], v[74:75], v[248:249], v[248:249] op_sel:[0,0,1] op_sel_hi:[1,0,1]
    v_pk_fma_f32 v[76:77], v[76:77], v[248:249], v[248:249] op_sel:[0,0,1] op_sel_hi:[1,0,1]
    v_pk_fma_f32 v[78:79], v[78:79], v[248:249], v[248:249] op_sel:[0,0,1] op_sel_hi:[1,0,1]
    v_cvt_pk_bf16_f32 v64, v64, v65
    v_cvt_pk_bf16_f32 v65, v66, v67
    v_cvt_pk_bf16_f32 v66, v68, v69
    v_cvt_pk_bf16_f32 v67, v70, v71
    v_cvt_pk_bf16_f32 v68, v72, v73
    v_cvt_pk_bf16_f32 v69, v74, v75
    v_cvt_pk_bf16_f32 v70, v76, v77
    v_cvt_pk_bf16_f32 v71, v78, v79
    buffer_store_dwordx4 v[64:67], v134, s[8:11], s35 offen offset:0 sc1
    buffer_store_dwordx4 v[68:71], v134, s[8:11], s35 offen offset:1024 sc1
    v_pk_mul_f32 v[248:249], v[80:81], v[16:17]
    v_pk_mul_f32 v[250:251], v[82:83], v[18:19]
    v_pk_fma_f32 v[248:249], v[84:85], v[20:21], v[248:249]
    v_pk_fma_f32 v[250:251], v[86:87], v[22:23], v[250:251]
    v_pk_fma_f32 v[248:249], v[88:89], v[24:25], v[248:249]
    v_pk_fma_f32 v[250:251], v[90:91], v[26:27], v[250:251]
    v_pk_fma_f32 v[248:249], v[92:93], v[28:29], v[248:249]
    v_pk_fma_f32 v[250:251], v[94:95], v[30:31], v[250:251]
    v_pk_add_f32 v[248:249], v[248:249], v[250:251]
    v_add_f32 v248, v248, v132
    v_add_f32 v248, v248, v249
    v_rcp_f32 v248, v248
    s_add_u32 s35, s40, 0
    v_mul_f32 v248, v248, v9
    v_mul_f32 v249, v130, v248
    v_pk_fma_f32 v[80:81], v[80:81], v[248:249], v[248:249] op_sel:[0,0,1] op_sel_hi:[1,0,1]
    v_pk_fma_f32 v[82:83], v[82:83], v[248:249], v[248:249] op_sel:[0,0,1] op_sel_hi:[1,0,1]
    v_pk_fma_f32 v[84:85], v[84:85], v[248:249], v[248:249] op_sel:[0,0,1] op_sel_hi:[1,0,1]
    v_pk_fma_f32 v[86:87], v[86:87], v[248:249], v[248:249] op_sel:[0,0,1] op_sel_hi:[1,0,1]
    v_pk_fma_f32 v[88:89], v[88:89], v[248:249], v[248:249] op_sel:[0,0,1] op_sel_hi:[1,0,1]
    v_pk_fma_f32 v[90:91], v[90:91], v[248:249], v[248:249] op_sel:[0,0,1] op_sel_hi:[1,0,1]
    v_pk_fma_f32 v[92:93], v[92:93], v[248:249], v[248:249] op_sel:[0,0,1] op_sel_hi:[1,0,1]
    v_pk_fma_f32 v[94:95], v[94:95], v[248:249], v[248:249] op_sel:[0,0,1] op_sel_hi:[1,0,1]
    v_cvt_pk_bf16_f32 v80, v80, v81
    v_cvt_pk_bf16_f32 v81, v82, v83
    v_cvt_pk_bf16_f32 v82, v84, v85
    v_cvt_pk_bf16_f32 v83, v86, v87
    v_cvt_pk_bf16_f32 v84, v88, v89
    v_cvt_pk_bf16_f32 v85, v90, v91
    v_cvt_pk_bf16_f32 v86, v92, v93
    v_cvt_pk_bf16_f32 v87, v94, v95
    buffer_store_dwordx4 v[80:83], v134, s[8:11], s35 offen offset:512 sc1
    buffer_store_dwordx4 v[84:87], v134, s[8:11], s35 offen offset:1536 sc1
    v_pk_add_f32 v[136:137], v[136:137], v[140:141]
    v_pk_add_f32 v[144:145], v[144:145], v[148:149]
    v_pk_add_f32 v[138:139], v[138:139], v[142:143]
    v_pk_add_f32 v[146:147], v[146:147], v[150:151]
    v_pk_add_f32 v[136:137], v[136:137], v[144:145]
    v_pk_add_f32 v[138:139], v[138:139], v[146:147]
    v_lshlrev_b32_e64 v7, 4, v0
    ds_write_b128 v7, v[136:139]
    v_lshrrev_b32 v14, 2, v2
    v_lshlrev_b32 v14, 8, v14
    v_and_b32_e64 v15, 3, v2
    v_lshl_add_u32 v14, v15, 3, v14
    v_add_u32_e64 v14, s66, v14
    v_pk_mul_f32 v[248:249], v[96:97], v[16:17]
    v_pk_mul_f32 v[250:251], v[98:99], v[18:19]
    v_pk_fma_f32 v[248:249], v[100:101], v[20:21], v[248:249]
    v_pk_fma_f32 v[250:251], v[102:103], v[22:23], v[250:251]
    v_pk_fma_f32 v[248:249], v[104:105], v[24:25], v[248:249]
    v_pk_fma_f32 v[250:251], v[106:107], v[26:27], v[250:251]
    v_pk_fma_f32 v[248:249], v[108:109], v[28:29], v[248:249]
    v_pk_fma_f32 v[250:251], v[110:111], v[30:31], v[250:251]
    v_pk_add_f32 v[248:249], v[248:249], v[250:251]
    v_add_f32 v248, v248, v132
    v_add_f32 v248, v248, v249
    v_rcp_f32_e64 v248, v248
    s_add_u32 s35, s40, 65536
    v_mul_f32 v248, v248, v10
    v_mul_f32 v249, v130, v248
    v_pk_fma_f32 v[96:97], v[96:97], v[248:249], v[248:249] op_sel:[0,0,1] op_sel_hi:[1,0,1]
    v_pk_fma_f32 v[98:99], v[98:99], v[248:249], v[248:249] op_sel:[0,0,1] op_sel_hi:[1,0,1]
    v_pk_fma_f32 v[100:101], v[100:101], v[248:249], v[248:249] op_sel:[0,0,1] op_sel_hi:[1,0,1]
    v_pk_fma_f32 v[102:103], v[102:103], v[248:249], v[248:249] op_sel:[0,0,1] op_sel_hi:[1,0,1]
    v_pk_fma_f32 v[104:105], v[104:105], v[248:249], v[248:249] op_sel:[0,0,1] op_sel_hi:[1,0,1]
    v_pk_fma_f32 v[106:107], v[106:107], v[248:249], v[248:249] op_sel:[0,0,1] op_sel_hi:[1,0,1]
    v_pk_fma_f32 v[108:109], v[108:109], v[248:249], v[248:249] op_sel:[0,0,1] op_sel_hi:[1,0,1]
    v_pk_fma_f32 v[110:111], v[110:111], v[248:249], v[248:249] op_sel:[0,0,1] op_sel_hi:[1,0,1]
    v_cvt_pk_bf16_f32 v96, v96, v97
    v_cvt_pk_bf16_f32 v97, v98, v99
    v_cvt_pk_bf16_f32 v98, v100, v101
    v_cvt_pk_bf16_f32 v99, v102, v103
    v_cvt_pk_bf16_f32 v100, v104, v105
    v_cvt_pk_bf16_f32 v101, v106, v107
    v_cvt_pk_bf16_f32 v102, v108, v109
    v_cvt_pk_bf16_f32 v103, v110, v111
    buffer_store_dwordx4 v[96:99], v134, s[8:11], s35 offen offset:0 sc1
    buffer_store_dwordx4 v[100:103], v134, s[8:11], s35 offen offset:1024 sc1
    s_waitcnt lgkmcnt(0)
    s_barrier
    ds_read_b128 v[136:139], v5 offset:0
    ds_read_b128 v[140:143], v5 offset:1024
    ds_read_b128 v[144:147], v5 offset:2048
    ds_read_b128 v[148:151], v5 offset:3072
    v_pk_mul_f32 v[248:249], v[112:113], v[16:17]
    v_pk_mul_f32 v[250:251], v[114:115], v[18:19]
    v_pk_fma_f32 v[248:249], v[116:117], v[20:21], v[248:249]
    v_pk_fma_f32 v[250:251], v[118:119], v[22:23], v[250:251]
    v_pk_fma_f32 v[248:249], v[120:121], v[24:25], v[248:249]
    v_pk_fma_f32 v[250:251], v[122:123], v[26:27], v[250:251]
    v_pk_fma_f32 v[248:249], v[124:125], v[28:29], v[248:249]
    v_pk_fma_f32 v[250:251], v[126:127], v[30:31], v[250:251]
    v_pk_add_f32 v[248:249], v[248:249], v[250:251]
    v_add_f32 v248, v248, v132
    v_add_f32 v248, v248, v249
    v_rcp_f32_e64 v248, v248
    s_add_u32 s35, s40, 65536
    v_mul_f32 v248, v248, v11
    v_mul_f32 v249, v130, v248
    v_pk_fma_f32 v[112:113], v[112:113], v[248:249], v[248:249] op_sel:[0,0,1] op_sel_hi:[1,0,1]
    v_pk_fma_f32 v[114:115], v[114:115], v[248:249], v[248:249] op_sel:[0,0,1] op_sel_hi:[1,0,1]
    v_pk_fma_f32 v[116:117], v[116:117], v[248:249], v[248:249] op_sel:[0,0,1] op_sel_hi:[1,0,1]
    v_pk_fma_f32 v[118:119], v[118:119], v[248:249], v[248:249] op_sel:[0,0,1] op_sel_hi:[1,0,1]
    v_pk_fma_f32 v[120:121], v[120:121], v[248:249], v[248:249] op_sel:[0,0,1] op_sel_hi:[1,0,1]
    v_pk_fma_f32 v[122:123], v[122:123], v[248:249], v[248:249] op_sel:[0,0,1] op_sel_hi:[1,0,1]
    v_pk_fma_f32 v[124:125], v[124:125], v[248:249], v[248:249] op_sel:[0,0,1] op_sel_hi:[1,0,1]
    v_pk_fma_f32 v[126:127], v[126:127], v[248:249], v[248:249] op_sel:[0,0,1] op_sel_hi:[1,0,1]
    v_cvt_pk_bf16_f32 v112, v112, v113
    v_cvt_pk_bf16_f32 v113, v114, v115
    v_cvt_pk_bf16_f32 v114, v116, v117
    v_cvt_pk_bf16_f32 v115, v118, v119
    v_cvt_pk_bf16_f32 v116, v120, v121
    v_cvt_pk_bf16_f32 v117, v122, v123
    v_cvt_pk_bf16_f32 v118, v124, v125
    v_cvt_pk_bf16_f32 v119, v126, v127
    buffer_store_dwordx4 v[112:115], v134, s[8:11], s35 offen offset:512 sc1
    buffer_store_dwordx4 v[116:119], v134, s[8:11], s35 offen offset:1536 sc1
    ds_read_b64_tr_b16 v[48:49], v14 offset:0
    ds_read_b64_tr_b16 v[50:51], v14 offset:32
    ds_read_b64_tr_b16 v[52:53], v14 offset:64
    ds_read_b64_tr_b16 v[54:55], v14 offset:96
    ds_read_b64_tr_b16 v[56:57], v14 offset:128
    ds_read_b64_tr_b16 v[58:59], v14 offset:160
    ds_read_b64_tr_b16 v[60:61], v14 offset:192
    ds_read_b64_tr_b16 v[62:63], v14 offset:224
    s_waitcnt lgkmcnt(8)
    v_pk_add_f32 v[136:137], v[136:137], v[140:141]
    v_pk_add_f32 v[144:145], v[144:145], v[148:149]
    v_pk_add_f32 v[138:139], v[138:139], v[142:143]
    v_pk_add_f32 v[146:147], v[146:147], v[150:151]
    v_pk_add_f32 v[136:137], v[136:137], v[144:145]
    v_pk_add_f32 v[138:139], v[138:139], v[146:147]
    v_cvt_pk_bf16_f32 v12, v136, v137
    v_cvt_pk_bf16_f32 v13, v138, v139
    v_lshrrev_b32 v14, 1, v4
    v_lshlrev_b32_e64 v14, 10, v14
    v_lshl_add_u32 v14, v3, 4, v14
    v_and_b32_e64 v15, 1, v4
    v_lshl_add_u32 v14, v15, 8, v14
    s_mul_i32 s64, s28, 589824
    s_lshl_b32 s5, s33, 11
    s_add_u32 s64, s64, s5
    s_add_u32 s64, s64, 6520832
    s_add_u32 s65, s64, 294912
    s_waitcnt lgkmcnt(0)
    v_mfma_f32_16x16x16_bf16 v[136:139], v[12:13], v[48:49], 0
    v_mfma_f32_16x16x16_bf16 v[140:143], v[12:13], v[50:51], 0
    v_mfma_f32_16x16x16_bf16 v[144:147], v[12:13], v[52:53], 0
    v_mfma_f32_16x16x16_bf16 v[148:151], v[12:13], v[54:55], 0
    s_nop 4
    v_cvt_pk_bf16_f32 v48, v136, v137
    v_cvt_pk_bf16_f32 v49, v138, v139
    v_cvt_pk_bf16_f32 v50, v140, v141
    v_cvt_pk_bf16_f32 v51, v142, v143
    v_cvt_pk_bf16_f32 v52, v144, v145
    v_cvt_pk_bf16_f32 v53, v146, v147
    v_cvt_pk_bf16_f32 v54, v148, v149
    v_cvt_pk_bf16_f32 v55, v150, v151
    v_permlane16_swap_b32 v48, v50
    v_permlane16_swap_b32 v49, v51
    buffer_store_dwordx4 v[48:51], v14, s[8:11], s64 offen offset:0 sc1
    v_permlane16_swap_b32 v52, v54
    v_permlane16_swap_b32 v53, v55
    buffer_store_dwordx4 v[52:55], v14, s[8:11], s64 offen offset:512 sc1
    v_mfma_f32_16x16x16_bf16 v[136:139], v[12:13], v[56:57], 0
    v_mfma_f32_16x16x16_bf16 v[140:143], v[12:13], v[58:59], 0
    v_mfma_f32_16x16x16_bf16 v[144:147], v[12:13], v[60:61], 0
    v_mfma_f32_16x16x16_bf16 v[148:151], v[12:13], v[62:63], 0
    s_nop 4
    v_cvt_pk_bf16_f32 v56, v136, v137
    v_cvt_pk_bf16_f32 v57, v138, v139
    v_cvt_pk_bf16_f32 v58, v140, v141
    v_cvt_pk_bf16_f32 v59, v142, v143
    v_cvt_pk_bf16_f32 v60, v144, v145
    v_cvt_pk_bf16_f32 v61, v146, v147
    v_cvt_pk_bf16_f32 v62, v148, v149
    v_cvt_pk_bf16_f32 v63, v150, v151
    v_permlane16_swap_b32 v56, v58
    v_permlane16_swap_b32 v57, v59
    buffer_store_dwordx4 v[56:59], v14, s[8:11], s65 offen offset:0 sc1
    v_permlane16_swap_b32 v60, v62
    v_permlane16_swap_b32 v61, v63
    buffer_store_dwordx4 v[60:63], v14, s[8:11], s65 offen offset:512 sc1
    v_pk_mul_f32 v[248:249], v[176:177], v[32:33]
    v_pk_mul_f32 v[250:251], v[178:179], v[34:35]
    v_pk_fma_f32 v[248:249], v[180:181], v[36:37], v[248:249]
    v_pk_fma_f32 v[250:251], v[182:183], v[38:39], v[250:251]
    v_pk_fma_f32 v[248:249], v[184:185], v[40:41], v[248:249]
    v_pk_fma_f32 v[250:251], v[186:187], v[42:43], v[250:251]
    v_pk_fma_f32 v[248:249], v[188:189], v[44:45], v[248:249]
    v_pk_fma_f32 v[250:251], v[190:191], v[46:47], v[250:251]
    v_pk_add_f32 v[248:249], v[248:249], v[250:251]
    v_add_f32 v248, v248, v133
    v_add_f32 v248, v248, v249
    v_rcp_f32 v248, v248
    s_add_u32 s35, s40, 4096
    v_mul_f32 v248, v248, v8
    v_mul_f32 v249, v130, v248
    v_pk_fma_f32 v[176:177], v[176:177], v[248:249], v[248:249] op_sel:[0,0,1] op_sel_hi:[1,0,1]
    v_pk_fma_f32 v[178:179], v[178:179], v[248:249], v[248:249] op_sel:[0,0,1] op_sel_hi:[1,0,1]
    v_pk_fma_f32 v[180:181], v[180:181], v[248:249], v[248:249] op_sel:[0,0,1] op_sel_hi:[1,0,1]
    v_pk_fma_f32 v[182:183], v[182:183], v[248:249], v[248:249] op_sel:[0,0,1] op_sel_hi:[1,0,1]
    v_pk_fma_f32 v[184:185], v[184:185], v[248:249], v[248:249] op_sel:[0,0,1] op_sel_hi:[1,0,1]
    v_pk_fma_f32 v[186:187], v[186:187], v[248:249], v[248:249] op_sel:[0,0,1] op_sel_hi:[1,0,1]
    v_pk_fma_f32 v[188:189], v[188:189], v[248:249], v[248:249] op_sel:[0,0,1] op_sel_hi:[1,0,1]
    v_pk_fma_f32 v[190:191], v[190:191], v[248:249], v[248:249] op_sel:[0,0,1] op_sel_hi:[1,0,1]
    v_cvt_pk_bf16_f32 v176, v176, v177
    v_cvt_pk_bf16_f32 v177, v178, v179
    v_cvt_pk_bf16_f32 v178, v180, v181
    v_cvt_pk_bf16_f32 v179, v182, v183
    v_cvt_pk_bf16_f32 v180, v184, v185
    v_cvt_pk_bf16_f32 v181, v186, v187
    v_cvt_pk_bf16_f32 v182, v188, v189
    v_cvt_pk_bf16_f32 v183, v190, v191
    buffer_store_dwordx4 v[176:179], v134, s[8:11], s35 offen offset:0 sc1
    buffer_store_dwordx4 v[180:183], v134, s[8:11], s35 offen offset:1024 sc1
    v_pk_mul_f32 v[248:249], v[192:193], v[32:33]
    v_pk_mul_f32 v[250:251], v[194:195], v[34:35]
    v_pk_fma_f32 v[248:249], v[196:197], v[36:37], v[248:249]
    v_pk_fma_f32 v[250:251], v[198:199], v[38:39], v[250:251]
    v_pk_fma_f32 v[248:249], v[200:201], v[40:41], v[248:249]
    v_pk_fma_f32 v[250:251], v[202:203], v[42:43], v[250:251]
    v_pk_fma_f32 v[248:249], v[204:205], v[44:45], v[248:249]
    v_pk_fma_f32 v[250:251], v[206:207], v[46:47], v[250:251]
    v_pk_add_f32 v[248:249], v[248:249], v[250:251]
    v_add_f32 v248, v248, v133
    v_add_f32 v248, v248, v249
    v_rcp_f32_e64 v248, v248
    s_add_u32 s35, s40, 4096
    v_mul_f32 v248, v248, v9
    v_mul_f32 v249, v130, v248
    v_pk_fma_f32 v[192:193], v[192:193], v[248:249], v[248:249] op_sel:[0,0,1] op_sel_hi:[1,0,1]
    v_pk_fma_f32 v[194:195], v[194:195], v[248:249], v[248:249] op_sel:[0,0,1] op_sel_hi:[1,0,1]
    v_pk_fma_f32 v[196:197], v[196:197], v[248:249], v[248:249] op_sel:[0,0,1] op_sel_hi:[1,0,1]
    v_pk_fma_f32 v[198:199], v[198:199], v[248:249], v[248:249] op_sel:[0,0,1] op_sel_hi:[1,0,1]
    v_pk_fma_f32 v[200:201], v[200:201], v[248:249], v[248:249] op_sel:[0,0,1] op_sel_hi:[1,0,1]
    v_pk_fma_f32 v[202:203], v[202:203], v[248:249], v[248:249] op_sel:[0,0,1] op_sel_hi:[1,0,1]
    v_pk_fma_f32 v[204:205], v[204:205], v[248:249], v[248:249] op_sel:[0,0,1] op_sel_hi:[1,0,1]
    v_pk_fma_f32 v[206:207], v[206:207], v[248:249], v[248:249] op_sel:[0,0,1] op_sel_hi:[1,0,1]
    v_cvt_pk_bf16_f32 v192, v192, v193
    v_cvt_pk_bf16_f32 v193, v194, v195
    v_cvt_pk_bf16_f32 v194, v196, v197
    v_cvt_pk_bf16_f32 v195, v198, v199
    v_cvt_pk_bf16_f32 v196, v200, v201
    v_cvt_pk_bf16_f32 v197, v202, v203
    v_cvt_pk_bf16_f32 v198, v204, v205
    v_cvt_pk_bf16_f32 v199, v206, v207
    buffer_store_dwordx4 v[192:195], v134, s[8:11], s35 offen offset:512 sc1
    buffer_store_dwordx4 v[196:199], v134, s[8:11], s35 offen offset:1536 sc1
    v_pk_mul_f32 v[248:249], v[208:209], v[32:33]
    v_pk_mul_f32 v[250:251], v[210:211], v[34:35]
    v_pk_fma_f32 v[248:249], v[212:213], v[36:37], v[248:249]
    v_pk_fma_f32 v[250:251], v[214:215], v[38:39], v[250:251]
    v_pk_fma_f32 v[248:249], v[216:217], v[40:41], v[248:249]
    v_pk_fma_f32 v[250:251], v[218:219], v[42:43], v[250:251]
    v_pk_fma_f32 v[248:249], v[220:221], v[44:45], v[248:249]
    v_pk_fma_f32 v[250:251], v[222:223], v[46:47], v[250:251]
    v_pk_add_f32 v[248:249], v[248:249], v[250:251]
    v_add_f32 v248, v248, v133
    v_add_f32 v248, v248, v249
    v_rcp_f32_e64 v248, v248
    s_add_u32 s35, s40, 69632
    v_mul_f32 v248, v248, v10
    v_mul_f32 v249, v130, v248
    v_pk_fma_f32 v[208:209], v[208:209], v[248:249], v[248:249] op_sel:[0,0,1] op_sel_hi:[1,0,1]
    v_pk_fma_f32 v[210:211], v[210:211], v[248:249], v[248:249] op_sel:[0,0,1] op_sel_hi:[1,0,1]
    v_pk_fma_f32 v[212:213], v[212:213], v[248:249], v[248:249] op_sel:[0,0,1] op_sel_hi:[1,0,1]
    v_pk_fma_f32 v[214:215], v[214:215], v[248:249], v[248:249] op_sel:[0,0,1] op_sel_hi:[1,0,1]
    v_pk_fma_f32 v[216:217], v[216:217], v[248:249], v[248:249] op_sel:[0,0,1] op_sel_hi:[1,0,1]
    v_pk_fma_f32 v[218:219], v[218:219], v[248:249], v[248:249] op_sel:[0,0,1] op_sel_hi:[1,0,1]
    v_pk_fma_f32 v[220:221], v[220:221], v[248:249], v[248:249] op_sel:[0,0,1] op_sel_hi:[1,0,1]
    v_pk_fma_f32 v[222:223], v[222:223], v[248:249], v[248:249] op_sel:[0,0,1] op_sel_hi:[1,0,1]
    v_cvt_pk_bf16_f32 v208, v208, v209
    v_cvt_pk_bf16_f32 v209, v210, v211
    v_cvt_pk_bf16_f32 v210, v212, v213
    v_cvt_pk_bf16_f32 v211, v214, v215
    v_cvt_pk_bf16_f32 v212, v216, v217
    v_cvt_pk_bf16_f32 v213, v218, v219
    v_cvt_pk_bf16_f32 v214, v220, v221
    v_cvt_pk_bf16_f32 v215, v222, v223
    buffer_store_dwordx4 v[208:211], v134, s[8:11], s35 offen offset:0 sc1
    buffer_store_dwordx4 v[212:215], v134, s[8:11], s35 offen offset:1024 sc1
    v_pk_mul_f32 v[248:249], v[224:225], v[32:33]
    v_pk_mul_f32 v[250:251], v[226:227], v[34:35]
    v_pk_fma_f32 v[248:249], v[228:229], v[36:37], v[248:249]
    v_pk_fma_f32 v[250:251], v[230:231], v[38:39], v[250:251]
    v_pk_fma_f32 v[248:249], v[232:233], v[40:41], v[248:249]
    v_pk_fma_f32 v[250:251], v[234:235], v[42:43], v[250:251]
    v_pk_fma_f32 v[248:249], v[236:237], v[44:45], v[248:249]
    v_pk_fma_f32 v[250:251], v[238:239], v[46:47], v[250:251]
    v_pk_add_f32 v[248:249], v[248:249], v[250:251]
    v_add_f32 v248, v248, v133
    v_add_f32 v248, v248, v249
    v_rcp_f32_e64 v248, v248
    s_add_u32 s35, s40, 69632
    v_mul_f32 v248, v248, v11
    v_mul_f32 v249, v130, v248
    v_pk_fma_f32 v[224:225], v[224:225], v[248:249], v[248:249] op_sel:[0,0,1] op_sel_hi:[1,0,1]
    v_pk_fma_f32 v[226:227], v[226:227], v[248:249], v[248:249] op_sel:[0,0,1] op_sel_hi:[1,0,1]
    v_pk_fma_f32 v[228:229], v[228:229], v[248:249], v[248:249] op_sel:[0,0,1] op_sel_hi:[1,0,1]
    v_pk_fma_f32 v[230:231], v[230:231], v[248:249], v[248:249] op_sel:[0,0,1] op_sel_hi:[1,0,1]
    v_pk_fma_f32 v[232:233], v[232:233], v[248:249], v[248:249] op_sel:[0,0,1] op_sel_hi:[1,0,1]
    v_pk_fma_f32 v[234:235], v[234:235], v[248:249], v[248:249] op_sel:[0,0,1] op_sel_hi:[1,0,1]
    v_pk_fma_f32 v[236:237], v[236:237], v[248:249], v[248:249] op_sel:[0,0,1] op_sel_hi:[1,0,1]
    v_pk_fma_f32 v[238:239], v[238:239], v[248:249], v[248:249] op_sel:[0,0,1] op_sel_hi:[1,0,1]
    v_cvt_pk_bf16_f32 v224, v224, v225
    v_cvt_pk_bf16_f32 v225, v226, v227
    v_cvt_pk_bf16_f32 v226, v228, v229
    v_cvt_pk_bf16_f32 v227, v230, v231
    v_cvt_pk_bf16_f32 v228, v232, v233
    v_cvt_pk_bf16_f32 v229, v234, v235
    v_cvt_pk_bf16_f32 v230, v236, v237
    v_cvt_pk_bf16_f32 v231, v238, v239
    buffer_store_dwordx4 v[224:227], v134, s[8:11], s35 offen offset:512 sc1
    buffer_store_dwordx4 v[228:231], v134, s[8:11], s35 offen offset:1536 sc1
    s_lshl_b32 s40, s30, 3
    s_add_u32 s40, s40, s31
    s_lshl_b32 s40, s40, 7
    s_add_u32 s40, s40, 10551296
    s_waitcnt vmcnt(8)
    s_barrier
    buffer_store_dword v170, v169, s[8:11], s39 offen sc1
    s_add_u32 s74, s72, 0
    s_cmp_ge_u32 s74, 7
    s_cselect_b32 s6, 7, 0
    s_sub_u32 s74, s74, s6
    s_mul_i32 s74, s74, 524288
    s_add_u32 s74, s74, s71
    s_add_u32 m0, s67, 131072
    s_nop 0
    buffer_load_dwordx4 v154, s[44:47], s74 offen offset:0 lds
    buffer_load_dwordx4 v155, s[44:47], s74 offen offset:1024 lds
    buffer_load_dwordx4 v156, s[44:47], s74 offen offset:2048 lds
    buffer_load_dwordx4 v157, s[44:47], s74 offen offset:3072 lds
    s_add_u32 s74, s72, 1
    s_cmp_ge_u32 s74, 7
    s_cselect_b32 s6, 7, 0
    s_sub_u32 s74, s74, s6
    s_mul_i32 s74, s74, 524288
    s_add_u32 s74, s74, s71
    s_add_u32 m0, s67, 135168
    s_nop 0
    buffer_load_dwordx4 v154, s[44:47], s74 offen offset:0 lds
    buffer_load_dwordx4 v155, s[44:47], s74 offen offset:1024 lds
    s_waitcnt vmcnt(7)
    buffer_store_dword v170, v169, s[8:11], s40 offen sc1
    buffer_load_dwordx4 v156, s[44:47], s74 offen offset:2048 lds
    buffer_load_dwordx4 v157, s[44:47], s74 offen offset:3072 lds
    s_add_u32 s74, s72, 2
    s_cmp_ge_u32 s74, 7
    s_cselect_b32 s6, 7, 0
    s_sub_u32 s74, s74, s6
    s_mul_i32 s74, s74, 524288
    s_add_u32 s74, s74, s71
    s_add_u32 m0, s67, 36864
    s_nop 0
    buffer_load_dwordx4 v154, s[44:47], s74 offen offset:0 lds
    buffer_load_dwordx4 v155, s[44:47], s74 offen offset:1024 lds
    buffer_load_dwordx4 v156, s[44:47], s74 offen offset:2048 lds
    buffer_load_dwordx4 v157, s[44:47], s74 offen offset:3072 lds
    s_add_u32 s74, s72, 3
    s_cmp_ge_u32 s74, 7
    s_cselect_b32 s6, 7, 0
    s_sub_u32 s74, s74, s6
    s_mul_i32 s74, s74, 524288
    s_add_u32 s74, s74, s71
    s_add_u32 m0, s67, 65536
    s_nop 0
    buffer_load_dwordx4 v154, s[44:47], s74 offen offset:0 lds
    buffer_load_dwordx4 v155, s[44:47], s74 offen offset:1024 lds
    buffer_load_dwordx4 v156, s[44:47], s74 offen offset:2048 lds
    buffer_load_dwordx4 v157, s[44:47], s74 offen offset:3072 lds
    s_add_u32 s74, s72, 4
    s_cmp_ge_u32 s74, 7
    s_cselect_b32 s6, 7, 0
    s_sub_u32 s74, s74, s6
    s_mul_i32 s74, s74, 524288
    s_add_u32 s74, s74, s71
    s_add_u32 m0, s67, 69632
    s_nop 0
    buffer_load_dwordx4 v154, s[44:47], s74 offen offset:0 lds
    buffer_load_dwordx4 v155, s[44:47], s74 offen offset:1024 lds
    buffer_load_dwordx4 v156, s[44:47], s74 offen offset:2048 lds
    buffer_load_dwordx4 v157, s[44:47], s74 offen offset:3072 lds
    s_add_u32 s74, s72, 5
    s_cmp_ge_u32 s74, 7
    s_cselect_b32 s6, 7, 0
    s_sub_u32 s74, s74, s6
    s_mul_i32 s74, s74, 524288
    s_add_u32 s74, s74, s71
    s_add_u32 m0, s67, 98304
    s_nop 0
    buffer_load_dwordx4 v154, s[44:47], s74 offen offset:0 lds
    buffer_load_dwordx4 v155, s[44:47], s74 offen offset:1024 lds
    buffer_load_dwordx4 v156, s[44:47], s74 offen offset:2048 lds
    buffer_load_dwordx4 v157, s[44:47], s74 offen offset:3072 lds
    s_add_u32 s74, s72, 6
    s_cmp_ge_u32 s74, 7
    s_cselect_b32 s6, 7, 0
    s_sub_u32 s74, s74, s6
    s_mul_i32 s74, s74, 524288
    s_add_u32 s74, s74, s71
    s_add_u32 m0, s67, 102400
    s_nop 0
    buffer_load_dwordx4 v154, s[44:47], s74 offen offset:0 lds
    buffer_load_dwordx4 v155, s[44:47], s74 offen offset:1024 lds
    buffer_load_dwordx4 v156, s[44:47], s74 offen offset:2048 lds
    buffer_load_dwordx4 v157, s[44:47], s74 offen offset:3072 lds
    v_bfe_u32 v171, v2, 1, 2
    v_and_b32_e64 v1, 1, v2
    v_lshl_add_u32 v1, v171, 3, v1
    s_lshl_b32 s5, s28, 1
    v_add_u32 v1, s5, v1
    v_lshlrev_b32 v1, 7, v1
    v_lshlrev_b32 v171, 8, v171
    s_lshr_b32 s5, s79, 1
    s_lshl_b32 s5, s5, 3
    s_lshr_b32 s6, s28, 1
    s_add_u32 s5, s5, s6
    s_lshl_b32 s5, s5, 7
    s_add_u32 s5, s5, 196608
    v_add_u32 v171, s5, v171
    v_and_b32 v172, 8, v2
    v_cmp_eq_u32 vcc, 0, v172
    s_nop 1
    v_cndmask_b32 v171, v171, v1, vcc
    s_mov_b32 s34, 10354688
    s_lshl_b32 s38, s79, 16
    s_lshl_b32 s5, s28, 12
    s_add_u32 s38, s38, s5
    s_add_u32 s38, s38, 4194304
    buffer_load_dword v172, v171, s[8:11], s34 offen sc1
    s_waitcnt vmcnt(0)
    v_cmp_ne_u32 vcc, s29, v172
    s_nop 1
    s_cbranch_vccnz slow_f3s
back_f3s:
    s_lshr_b32 s36, s4, 2
    s_add_u32 s36, s36, s4
    s_add_u32 s36, s36, 0
    s_and_b32 s36, s36, 3
    s_lshl_b32 s36, s36, 14
    s_add_u32 s37, s36, s38
    s_add_u32 s36, s36, s73
    buffer_load_dwordx4 a[128:131], v152, s[8:11], s36 offen offset:0 sc1
    buffer_load_dwordx4 a[192:195], v160, s[8:11], s37 offen offset:0 sc1
    buffer_load_dwordx4 a[132:135], v153, s[8:11], s36 offen offset:0 sc1
    buffer_load_dwordx4 a[196:199], v161, s[8:11], s37 offen offset:0 sc1
    buffer_load_dwordx4 a[136:139], v152, s[8:11], s36 offen offset:2048 sc1
    buffer_load_dwordx4 a[200:203], v160, s[8:11], s37 offen offset:2048 sc1
    buffer_load_dwordx4 a[140:143], v153, s[8:11], s36 offen offset:2048 sc1
    buffer_load_dwordx4 a[204:207], v161, s[8:11], s37 offen offset:2048 sc1
    s_lshr_b32 s36, s4, 2
    s_add_u32 s36, s36, s4
    s_add_u32 s36, s36, 1
    s_and_b32 s36, s36, 3
    s_lshl_b32 s36, s36, 14
    s_add_u32 s37, s36, s38
    s_add_u32 s36, s36, s73
    buffer_load_dwordx4 a[144:147], v152, s[8:11], s36 offen offset:0 sc1
    buffer_load_dwordx4 a[208:211], v160, s[8:11], s37 offen offset:0 sc1
    buffer_load_dwordx4 a[148:151], v153, s[8:11], s36 offen offset:0 sc1
    buffer_load_dwordx4 a[212:215], v161, s[8:11], s37 offen offset:0 sc1
    buffer_load_dwordx4 a[152:155], v152, s[8:11], s36 offen offset:2048 sc1
    buffer_load_dwordx4 a[216:219], v160, s[8:11], s37 offen offset:2048 sc1
    buffer_load_dwordx4 a[156:159], v153, s[8:11], s36 offen offset:2048 sc1
    buffer_load_dwordx4 a[220:223], v161, s[8:11], s37 offen offset:2048 sc1
    s_lshr_b32 s36, s4, 2
    s_add_u32 s36, s36, s4
    s_add_u32 s36, s36, 2
    s_and_b32 s36, s36, 3
    s_lshl_b32 s36, s36, 14
    s_add_u32 s37, s36, s38
    s_add_u32 s36, s36, s73
    buffer_load_dwordx4 a[160:163], v152, s[8:11], s36 offen offset:0 sc1
    buffer_load_dwordx4 a[224:227], v160, s[8:11], s37 offen offset:0 sc1
    buffer_load_dwordx4 a[164:167], v153, s[8:11], s36 offen offset:0 sc1
    buffer_load_dwordx4 a[228:231], v161, s[8:11], s37 offen offset:0 sc1
    buffer_load_dwordx4 a[168:171], v152, s[8:11], s36 offen offset:2048 sc1
    buffer_load_dwordx4 a[232:235], v160, s[8:11], s37 offen offset:2048 sc1
    buffer_load_dwordx4 a[172:175], v153, s[8:11], s36 offen offset:2048 sc1
    buffer_load_dwordx4 a[236:239], v161, s[8:11], s37 offen offset:2048 sc1
    s_lshr_b32 s36, s4, 2
    s_add_u32 s36, s36, s4
    s_add_u32 s36, s36, 3
    s_and_b32 s36, s36, 3
    s_lshl_b32 s36, s36, 14
    s_add_u32 s37, s36, s38
    s_add_u32 s36, s36, s73
    buffer_load_dwordx4 a[176:179], v152, s[8:11], s36 offen offset:0 sc1
    buffer_load_dwordx4 a[240:243], v160, s[8:11], s37 offen offset:0 sc1
    buffer_load_dwordx4 a[180:183], v153, s[8:11], s36 offen offset:0 sc1
    buffer_load_dwordx4 a[244:247], v161, s[8:11], s37 offen offset:0 sc1
    buffer_load_dwordx4 a[184:187], v152, s[8:11], s36 offen offset:2048 sc1
    buffer_load_dwordx4 a[248:251], v160, s[8:11], s37 offen offset:2048 sc1
    buffer_load_dwordx4 a[188:191], v153, s[8:11], s36 offen offset:2048 sc1
    buffer_load_dwordx4 a[252:255], v161, s[8:11], s37 offen offset:2048 sc1
    v_lshlrev_b32 v163, 2, v162
    v_xor_b32 v164, 128, v163
    v_lshlrev_b32 v165, 1, v162
    s_lshl_b32 s36, s79, 8
    s_add_u32 s36, s36, 10027008
    s_lshl_b32 s37, s79, 7
    buffer_load_dword v166, v163, s[8:11], s36 offen sc1
    buffer_load_dword v252, v164, s[8:11], s36 offen sc1
    buffer_load_ushort v168, v165, s[52:55], s37 offen
    s_waitcnt vmcnt(0) lgkmcnt(0)
    s_branch join
slow_f1:
        s_waitcnt vmcnt(0)
        buffer_store_dword v170, v169, s[8:11], s43 offen sc1
        s_mov_b32 s7, 0
slowl_f1:
        s_mov_b64 exec, vcc
        buffer_load_dword v172, v171, s[8:11], s34 offen sc1
        s_add_u32 s7, s7, 1
        s_cmp_ge_u32 s7, 0x40000
        s_waitcnt vmcnt(0)
        s_cbranch_scc1 slowx_f1
        v_cmp_ne_u32 vcc, s29, v172
        s_nop 1
        s_cbranch_vccnz slowl_f1
slowx_f1:
        s_mov_b64 exec, -1
        s_branch back_f1
slow_f6a:
        s_mov_b32 s7, 0
slowl_f6a:
        s_mov_b64 exec, vcc
        buffer_load_dword v172, v171, s[8:11], s101 offen sc1
        s_add_u32 s7, s7, 1
        s_cmp_ge_u32 s7, 0x40000
        s_waitcnt vmcnt(0)
        s_cbranch_scc1 slowx_f6a
        v_cmp_ne_u32 vcc, s29, v172
        s_nop 1
        s_cbranch_vccnz slowl_f6a
slowx_f6a:
        s_mov_b64 exec, -1
        s_branch back_f6a
slow_f3:
        s_mov_b32 s7, 0
slowl_f3:
        s_mov_b64 exec, vcc
        buffer_load_dword v172, v171, s[8:11], s34 offen sc1
        s_add_u32 s7, s7, 1
        s_cmp_ge_u32 s7, 0x40000
        s_waitcnt vmcnt(0)
        s_cbranch_scc1 slowx_f3
        v_cmp_ne_u32 vcc, s29, v172
        s_nop 1
        s_cbranch_vccnz slowl_f3
slowx_f3:
        s_mov_b64 exec, -1
        s_branch back_f3
slow_f4:
        s_mov_b32 s7, 0
slowl_f4:
        s_mov_b64 exec, vcc
        buffer_load_dword v172, v171, s[8:11], s34 offen sc1
        s_add_u32 s7, s7, 1
        s_cmp_ge_u32 s7, 0x40000
        s_waitcnt vmcnt(0)
        s_cbranch_scc1 slowx_f4
        v_cmp_ne_u32 vcc, s29, v172
        s_nop 1
        s_cbranch_vccnz slowl_f4
slowx_f4:
        s_mov_b64 exec, -1
        s_branch back_f4
slow_fe:
        s_mov_b32 s7, 0
slowl_fe:
        s_mov_b64 exec, vcc
        buffer_load_dword v255, v254, s[8:11], s39 offen sc1
        s_add_u32 s7, s7, 1
        s_cmp_ge_u32 s7, 0x40000
        s_waitcnt vmcnt(0)
        s_cbranch_scc1 slowx_fe
        v_cmp_ne_u32 vcc, s29, v255
        s_nop 1
        s_cbranch_vccnz slowl_fe
slowx_fe:
        s_mov_b64 exec, -1
        s_branch back_fe
slow_f6b:
        s_mov_b32 s7, 0
slowl_f6b:
        s_mov_b64 exec, vcc
        buffer_load_dword v172, v171, s[8:11], s101 offen sc1
        s_add_u32 s7, s7, 1
        s_cmp_ge_u32 s7, 0x40000
        s_waitcnt vmcnt(0)
        s_cbranch_scc1 slowx_f6b
        v_cmp_ne_u32 vcc, s29, v172
        s_nop 1
        s_cbranch_vccnz slowl_f6b
slowx_f6b:
        s_mov_b64 exec, -1
        s_branch back_f6b
slow_f1b:
        s_mov_b32 s7, 0
slowl_f1b:
        s_mov_b64 exec, vcc
        buffer_load_dword v172, v171, s[8:11], s34 offen sc1
        s_add_u32 s7, s7, 1
        s_cmp_ge_u32 s7, 0x40000
        s_waitcnt vmcnt(0)
        s_cbranch_scc1 slowx_f1b
        v_cmp_ne_u32 vcc, s29, v172
        s_nop 1
        s_cbranch_vccnz slowl_f1b
slowx_f1b:
        s_mov_b64 exec, -1
        s_branch back_f1b
slow_f2:
        s_mov_b32 s7, 0
slowl_f2:
        s_mov_b64 exec, vcc
        buffer_load_dword v172, v171, s[8:11], s42 offen sc1
        s_add_u32 s7, s7, 1
        s_cmp_ge_u32 s7, 0x40000
        s_waitcnt vmcnt(0)
        s_cbranch_scc1 slowx_f2
        v_cmp_ne_u32 vcc, s29, v172
        s_nop 1
        s_cbranch_vccnz slowl_f2
slowx_f2:
        s_mov_b64 exec, -1
        s_branch back_f2
slow_f2b:
        s_mov_b32 s7, 0
slowl_f2b:
        s_mov_b64 exec, vcc
        buffer_load_dword v255, v254, s[8:11], 0 offen sc1
        s_add_u32 s7, s7, 1
        s_cmp_ge_u32 s7, 0x40000
        s_waitcnt vmcnt(0)
        s_cbranch_scc1 slowx_f2b
        v_cmp_ne_u32 vcc, s29, v255
        s_nop 1
        s_cbranch_vccnz slowl_f2b
slowx_f2b:
        s_mov_b64 exec, -1
        s_branch back_f2b
slow_f3s:
        s_mov_b32 s7, 0
slowl_f3s:
        s_mov_b64 exec, vcc
        buffer_load_dword v172, v171, s[8:11], s34 offen sc1
        s_add_u32 s7, s7, 1
        s_cmp_ge_u32 s7, 0x40000
        s_waitcnt vmcnt(0)
        s_cbranch_scc1 slowx_f3s
        v_cmp_ne_u32 vcc, s29, v172
        s_nop 1
        s_cbranch_vccnz slowl_f3s
slowx_f3s:
        s_mov_b64 exec, -1
        s_branch back_f3s
code_end:
.section .rodata,"a"
.p2align 6
.amdhsa_kernel gated_mix__linear_attn_block__mixer_token_mlp__prompt_kernel
  .amdhsa_next_free_vgpr 512
  .amdhsa_next_free_sgpr 102
  .amdhsa_accum_offset 256
  .amdhsa_group_segment_fixed_size 0
  .amdhsa_kernarg_size 96
  .amdhsa_user_sgpr_count 2
  .amdhsa_user_sgpr_kernarg_segment_ptr 1
  .amdhsa_system_sgpr_workgroup_id_x 1
.end_amdhsa_kernel
```
